```python
import torch

def _softmax(x, axis=-1):
    return torch.softmax(x, dim=axis)
def _gelu(x):
    return torch.nn.functional.gelu(x, approximate="tanh")
def _silu(x):
    return torch.nn.functional.silu(x)
def _sigmoid(x):
    return torch.sigmoid(x)
def _layernorm(x, axis=-1, eps=1e-5):
    m = x.mean(dim=axis, keepdim=True)
    v = x.var(dim=axis, keepdim=True, unbiased=False)
    return (x - m) / torch.sqrt(v + eps)
def _scatter_add(tgt, idx, src, axis=0):
    return tgt.clone().index_add_(axis, idx, src)
def _segment_sum(src, seg, n):
    out = torch.zeros((n,) + src.shape[1:], dtype=src.dtype)
    return out.index_add_(0, seg, src)
def _pad(x, pw):
    flat = tuple(v for pair in reversed(pw) for v in pair)
    return torch.nn.functional.pad(x, flat)

kernel_name = 'recurrent_scan__sliding_block__glu_gated_glu__prompt'

def setup_inputs():

    _w = (lambda a: (lambda t: t.to(torch.bfloat16) if t.is_floating_point() else t)(torch.as_tensor(a)))
    def _A_setup():
        B, S, D = 1, 2048, 576
        return {
            "x": _w((lambda *s: torch.randn(*s, dtype=torch.bfloat16) * 0.05)(B, S, D)),
            "wqkv": _w((lambda *s: torch.randn(*s, dtype=torch.bfloat16) * 0.05)(D, 3 * D)),
            "wo": _w((lambda *s: torch.randn(*s, dtype=torch.bfloat16) * 0.05)(D, D)),
        }
    _A_in = _A_setup()

    def _B_setup():
        B, S, D, F = 1, 2048, 576, 4608
        return {
            "x": _w((lambda *s: torch.randn(*s, dtype=torch.bfloat16) * 0.05)(B, S, D)),
            "w_gate": _w((lambda *s: torch.randn(*s, dtype=torch.bfloat16) * 0.05)(D, F)),
            "w_up": _w((lambda *s: torch.randn(*s, dtype=torch.bfloat16) * 0.05)(D, F)),
            "w_down": _w((lambda *s: torch.randn(*s, dtype=torch.bfloat16) * 0.05)(F, D)),
        }
    _B_in = _B_setup()

    return {
        "A_x": _A_in["x"],
        "A_wqkv": _A_in["wqkv"],
        "A_wo": _A_in["wo"],
        "B_x": _B_in["x"],
        "B_w_gate": _B_in["w_gate"],
        "B_w_up": _B_in["w_up"],
        "B_w_down": _B_in["w_down"],
    }

def reference(A_x, A_wqkv, A_wo, B_x, B_w_gate, B_w_up, B_w_down):
    def _A_ref(x, wqkv, wo):
        B, S, D = x.shape
        H = 32; Dh = D // H; W = 256
        qkv = (lambda x, *d: x.permute(*d))((x @ wqkv).reshape(B, S, 3, H, Dh), 2, 0, 3, 1, 4)
        q, k, v = qkv[0], qkv[1], qkv[2]
        scores = torch.einsum("bhqd,bhkd->bhqk", q, k) * (Dh ** -0.5)
        idx = torch.arange(S)
        mask = (idx[:, None] - idx[None, :] >= 0) & (idx[:, None] - idx[None, :] < W)
        scores = torch.where(mask[None, None], scores, -1e9)
        p = _softmax(scores, axis=-1)
        o = torch.einsum("bhqk,bhkd->bhqd", p, v)
        return (lambda x, *d: x.permute(*d))(o, 0, 2, 1, 3).reshape(B, S, D) @ wo

    def _B_ref(x, w_gate, w_up, w_down):
        g = torch.einsum("bsd,df->bsf", x, w_gate)
        u = torch.einsum("bsd,df->bsf", x, w_up)
        h = _sigmoid(g) * u
        return torch.einsum("bsf,fd->bsd", h, w_down)

    x = A_x
    xn = _layernorm(x, axis=-1)
    s = _A_ref(xn, A_wqkv, A_wo)
    g = _silu(_B_ref(xn, B_w_gate, B_w_up, B_w_down))
    return x + s * g
```

```asm
; @launch kernel=k0_kernel grid=(256,1,1) block=(128,1,1) lds=8192
; @launch kernel=k1_kernel grid=(256,1,1) block=(256,1,1) lds=155648
; @launch kernel=k2_kernel grid=(256,1,1) block=(640,1,1) lds=94272
.amdgcn_target "amdgcn-amd-amdhsa--gfx950"
.text
.globl k0_kernel
.p2align 8
.type k0_kernel,@function
k0_kernel:
    s_cmp_ge_u32 s2, 256
    s_cbranch_scc1 K0_END
    s_load_dwordx16 s[4:19], s[0:1], 0
    s_load_dwordx4 s[20:23], s[0:1], 64
    s_getpc_b64 s[52:53]
K0_PC:
    s_mov_b32 s54, K0_CODE_END-K0_PC
    s_mov_b32 s55, 0x00020000
    v_lshlrev_b32 v15, 7, v0
    buffer_load_dword v15, v15, s[52:55], 0 offen
    v_lshrrev_b32 v2, 6, v0
    s_nop 0
    v_readfirstlane_b32 s40, v2
    s_cmp_lg_u32 s40, 0
    s_cbranch_scc1 K0_WO
    s_and_b32 s40, s2, 7
    s_lshr_b32 s41, s2, 3
    s_lshl_b32 s42, s40, 5
    s_add_u32 s42, s42, s41
    s_mul_i32 s43, s42, 9216
    v_lshrrev_b32 v2, 3, v0
    v_and_b32 v3, 7, v0
    v_mul_u32_u24 v4, 1152, v2
    v_lshl_add_u32 v4, v3, 4, v4
    s_mov_b32 s44, 0x3f803f80
    s_waitcnt lgkmcnt(0)
    s_mov_b32 s24, s4
    s_mov_b32 s25, s5
    s_mov_b32 s26, 2359296
    s_mov_b32 s27, 0x00020000
    buffer_load_dwordx4 v[32:35], v4, s[24:27], s43 offen offset:0
    buffer_load_dwordx4 v[36:39], v4, s[24:27], s43 offen offset:128
    buffer_load_dwordx4 v[40:43], v4, s[24:27], s43 offen offset:256
    buffer_load_dwordx4 v[44:47], v4, s[24:27], s43 offen offset:384
    buffer_load_dwordx4 v[48:51], v4, s[24:27], s43 offen offset:512
    buffer_load_dwordx4 v[52:55], v4, s[24:27], s43 offen offset:640
    buffer_load_dwordx4 v[56:59], v4, s[24:27], s43 offen offset:768
    buffer_load_dwordx4 v[60:63], v4, s[24:27], s43 offen offset:896
    buffer_load_dwordx4 v[64:67], v4, s[24:27], s43 offen offset:1024
    s_mov_b32 s32, s12
    s_mov_b32 s33, s13
    s_mov_b32 s34, 5308416
    s_mov_b32 s35, 0x00020000
    s_mov_b32 s36, s14
    s_mov_b32 s37, s15
    s_mov_b32 s38, 5308416
    s_mov_b32 s39, 0x00020000
    v_lshrrev_b32 v5, 5, v0
    s_lshl_b32 s45, s40, 1
    v_add_u32 v5, s45, v5
    v_lshrrev_b32 v6, 1, v5
    v_mul_u32_u24 v6, 9, v6
    v_and_b32 v5, 1, v5
    v_mad_u32_u24 v6, v5, 5, v6
    v_lshlrev_b32 v6, 7, v6
    s_mul_i32 s46, s41, 18
    v_and_b32 v7, 15, v0
    v_add_u32 v8, s46, v7
    v_mul_u32_u24 v8, 9216, v8
    v_add_u32 v8, v8, v6
    v_and_b32 v7, 1, v0
    v_add_u32 v9, s46, v7
    v_add_u32 v9, 16, v9
    v_mul_u32_u24 v9, 9216, v9
    v_add_u32 v9, v9, v6
    buffer_load_dword v10, v8, s[32:35], 0 offen
    buffer_load_dword v11, v9, s[32:35], 0 offen
    buffer_load_dword v12, v8, s[36:39], 0 offen
    buffer_load_dword v13, v9, s[36:39], 0 offen
    s_add_u32 s28, s22, 12582912
    s_addc_u32 s29, s23, 0
    s_mov_b32 s30, 2359296
    s_mov_b32 s31, 0x00020000
    s_lshr_b32 s47, s42, 1
    s_mul_i32 s47, s47, 18432
    s_and_b32 s48, s42, 1
    s_lshl_b32 s48, s48, 7
    s_add_u32 s47, s47, s48
    v_lshlrev_b32 v14, 8, v3
    v_lshl_add_u32 v14, v2, 4, v14
    v_mov_b32 v16, 0
    v_mov_b32 v17, 0
    v_mov_b32 v18, 0
    v_mov_b32 v19, 0
    s_waitcnt vmcnt(12)
    v_dot2_f32_bf16 v16, v32, s44, v16
    v_dot2_f32_bf16 v17, v33, s44, v17
    v_dot2_f32_bf16 v18, v34, s44, v18
    v_dot2_f32_bf16 v19, v35, s44, v19
    s_waitcnt vmcnt(11)
    v_dot2_f32_bf16 v16, v36, s44, v16
    v_dot2_f32_bf16 v17, v37, s44, v17
    v_dot2_f32_bf16 v18, v38, s44, v18
    v_dot2_f32_bf16 v19, v39, s44, v19
    s_waitcnt vmcnt(10)
    v_dot2_f32_bf16 v16, v40, s44, v16
    v_dot2_f32_bf16 v17, v41, s44, v17
    v_dot2_f32_bf16 v18, v42, s44, v18
    v_dot2_f32_bf16 v19, v43, s44, v19
    s_waitcnt vmcnt(9)
    v_dot2_f32_bf16 v16, v44, s44, v16
    v_dot2_f32_bf16 v17, v45, s44, v17
    v_dot2_f32_bf16 v18, v46, s44, v18
    v_dot2_f32_bf16 v19, v47, s44, v19
    s_waitcnt vmcnt(8)
    v_dot2_f32_bf16 v16, v48, s44, v16
    v_dot2_f32_bf16 v17, v49, s44, v17
    v_dot2_f32_bf16 v18, v50, s44, v18
    v_dot2_f32_bf16 v19, v51, s44, v19
    s_waitcnt vmcnt(7)
    v_dot2_f32_bf16 v16, v52, s44, v16
    v_dot2_f32_bf16 v17, v53, s44, v17
    v_dot2_f32_bf16 v18, v54, s44, v18
    v_dot2_f32_bf16 v19, v55, s44, v19
    s_waitcnt vmcnt(6)
    v_dot2_f32_bf16 v16, v56, s44, v16
    v_dot2_f32_bf16 v17, v57, s44, v17
    v_dot2_f32_bf16 v18, v58, s44, v18
    v_dot2_f32_bf16 v19, v59, s44, v19
    s_waitcnt vmcnt(5)
    v_dot2_f32_bf16 v16, v60, s44, v16
    v_dot2_f32_bf16 v17, v61, s44, v17
    v_dot2_f32_bf16 v18, v62, s44, v18
    v_dot2_f32_bf16 v19, v63, s44, v19
    s_waitcnt vmcnt(4)
    v_dot2_f32_bf16 v16, v64, s44, v16
    v_dot2_f32_bf16 v17, v65, s44, v17
    v_dot2_f32_bf16 v18, v66, s44, v18
    v_dot2_f32_bf16 v19, v67, s44, v19
    s_nop 3
    v_add_f32 v16, v16, v17
    v_add_f32 v18, v18, v19
    v_add_f32 v16, v16, v18
    s_nop 1
    v_add_f32_dpp v16, v16, v16 quad_perm:[1,0,3,2] row_mask:0xf bank_mask:0xf
    s_nop 1
    v_add_f32_dpp v16, v16, v16 quad_perm:[2,3,0,1] row_mask:0xf bank_mask:0xf
    s_nop 1
    v_add_f32_dpp v16, v16, v16 row_half_mirror row_mask:0xf bank_mask:0xf
    v_mul_f32 v16, 0x3ae38e39, v16
    v_sub_f32 v18, 0, v16
    v_mov_b32 v19, v18
    v_mov_b32 v17, v16
    v_cvt_pk_bf16_f32 v17, v17, v17
    v_lshlrev_b32 v17, 16, v17
    v_sub_f32 v20, 0, v17
    v_mov_b32 v21, v20
    v_mov_b32 v22, 0
    v_mov_b32 v23, 0
    v_mov_b32 v24, 0
    v_mov_b32 v25, 0
    v_lshlrev_b32 v72, 16, v32
    v_and_b32 v73, 0xffff0000, v32
    v_lshlrev_b32 v74, 16, v33
    v_and_b32 v75, 0xffff0000, v33
    v_lshlrev_b32 v76, 16, v34
    v_and_b32 v77, 0xffff0000, v34
    v_lshlrev_b32 v78, 16, v35
    v_and_b32 v79, 0xffff0000, v35
    v_lshlrev_b32 v80, 16, v36
    v_and_b32 v81, 0xffff0000, v36
    v_lshlrev_b32 v82, 16, v37
    v_and_b32 v83, 0xffff0000, v37
    v_lshlrev_b32 v84, 16, v38
    v_and_b32 v85, 0xffff0000, v38
    v_lshlrev_b32 v86, 16, v39
    v_and_b32 v87, 0xffff0000, v39
    v_lshlrev_b32 v88, 16, v40
    v_and_b32 v89, 0xffff0000, v40
    v_lshlrev_b32 v90, 16, v41
    v_and_b32 v91, 0xffff0000, v41
    v_lshlrev_b32 v92, 16, v42
    v_and_b32 v93, 0xffff0000, v42
    v_lshlrev_b32 v94, 16, v43
    v_and_b32 v95, 0xffff0000, v43
    v_lshlrev_b32 v96, 16, v44
    v_and_b32 v97, 0xffff0000, v44
    v_lshlrev_b32 v98, 16, v45
    v_and_b32 v99, 0xffff0000, v45
    v_lshlrev_b32 v100, 16, v46
    v_and_b32 v101, 0xffff0000, v46
    v_lshlrev_b32 v102, 16, v47
    v_and_b32 v103, 0xffff0000, v47
    v_lshlrev_b32 v104, 16, v48
    v_and_b32 v105, 0xffff0000, v48
    v_lshlrev_b32 v106, 16, v49
    v_and_b32 v107, 0xffff0000, v49
    v_lshlrev_b32 v108, 16, v50
    v_and_b32 v109, 0xffff0000, v50
    v_lshlrev_b32 v110, 16, v51
    v_and_b32 v111, 0xffff0000, v51
    v_lshlrev_b32 v112, 16, v52
    v_and_b32 v113, 0xffff0000, v52
    v_lshlrev_b32 v114, 16, v53
    v_and_b32 v115, 0xffff0000, v53
    v_lshlrev_b32 v116, 16, v54
    v_and_b32 v117, 0xffff0000, v54
    v_lshlrev_b32 v118, 16, v55
    v_and_b32 v119, 0xffff0000, v55
    v_lshlrev_b32 v120, 16, v56
    v_and_b32 v121, 0xffff0000, v56
    v_lshlrev_b32 v122, 16, v57
    v_and_b32 v123, 0xffff0000, v57
    v_lshlrev_b32 v124, 16, v58
    v_and_b32 v125, 0xffff0000, v58
    v_lshlrev_b32 v126, 16, v59
    v_and_b32 v127, 0xffff0000, v59
    v_lshlrev_b32 v128, 16, v60
    v_and_b32 v129, 0xffff0000, v60
    v_lshlrev_b32 v130, 16, v61
    v_and_b32 v131, 0xffff0000, v61
    v_lshlrev_b32 v132, 16, v62
    v_and_b32 v133, 0xffff0000, v62
    v_lshlrev_b32 v134, 16, v63
    v_and_b32 v135, 0xffff0000, v63
    v_lshlrev_b32 v136, 16, v64
    v_and_b32 v137, 0xffff0000, v64
    v_lshlrev_b32 v138, 16, v65
    v_and_b32 v139, 0xffff0000, v65
    v_lshlrev_b32 v140, 16, v66
    v_and_b32 v141, 0xffff0000, v66
    v_lshlrev_b32 v142, 16, v67
    v_and_b32 v143, 0xffff0000, v67
    v_pk_add_f32 v[26:27], v[72:73], v[18:19]
    v_pk_add_f32 v[72:73], v[72:73], v[20:21]
    v_pk_fma_f32 v[22:23], v[26:27], v[26:27], v[22:23]
    v_cvt_pk_bf16_f32 v32, v72, v73
    v_pk_add_f32 v[28:29], v[74:75], v[18:19]
    v_pk_add_f32 v[74:75], v[74:75], v[20:21]
    v_pk_fma_f32 v[24:25], v[28:29], v[28:29], v[24:25]
    v_cvt_pk_bf16_f32 v33, v74, v75
    v_pk_add_f32 v[30:31], v[76:77], v[18:19]
    v_pk_add_f32 v[76:77], v[76:77], v[20:21]
    v_pk_fma_f32 v[22:23], v[30:31], v[30:31], v[22:23]
    v_cvt_pk_bf16_f32 v34, v76, v77
    v_pk_add_f32 v[26:27], v[78:79], v[18:19]
    v_pk_add_f32 v[78:79], v[78:79], v[20:21]
    v_pk_fma_f32 v[24:25], v[26:27], v[26:27], v[24:25]
    v_cvt_pk_bf16_f32 v35, v78, v79
    v_pk_add_f32 v[28:29], v[80:81], v[18:19]
    v_pk_add_f32 v[80:81], v[80:81], v[20:21]
    v_pk_fma_f32 v[22:23], v[28:29], v[28:29], v[22:23]
    v_cvt_pk_bf16_f32 v36, v80, v81
    v_pk_add_f32 v[30:31], v[82:83], v[18:19]
    v_pk_add_f32 v[82:83], v[82:83], v[20:21]
    v_pk_fma_f32 v[24:25], v[30:31], v[30:31], v[24:25]
    v_cvt_pk_bf16_f32 v37, v82, v83
    v_pk_add_f32 v[26:27], v[84:85], v[18:19]
    v_pk_add_f32 v[84:85], v[84:85], v[20:21]
    v_pk_fma_f32 v[22:23], v[26:27], v[26:27], v[22:23]
    v_cvt_pk_bf16_f32 v38, v84, v85
    v_pk_add_f32 v[28:29], v[86:87], v[18:19]
    v_pk_add_f32 v[86:87], v[86:87], v[20:21]
    v_pk_fma_f32 v[24:25], v[28:29], v[28:29], v[24:25]
    v_cvt_pk_bf16_f32 v39, v86, v87
    v_pk_add_f32 v[30:31], v[88:89], v[18:19]
    v_pk_add_f32 v[88:89], v[88:89], v[20:21]
    v_pk_fma_f32 v[22:23], v[30:31], v[30:31], v[22:23]
    v_cvt_pk_bf16_f32 v40, v88, v89
    v_pk_add_f32 v[26:27], v[90:91], v[18:19]
    v_pk_add_f32 v[90:91], v[90:91], v[20:21]
    v_pk_fma_f32 v[24:25], v[26:27], v[26:27], v[24:25]
    v_cvt_pk_bf16_f32 v41, v90, v91
    v_pk_add_f32 v[28:29], v[92:93], v[18:19]
    v_pk_add_f32 v[92:93], v[92:93], v[20:21]
    v_pk_fma_f32 v[22:23], v[28:29], v[28:29], v[22:23]
    v_cvt_pk_bf16_f32 v42, v92, v93
    v_pk_add_f32 v[30:31], v[94:95], v[18:19]
    v_pk_add_f32 v[94:95], v[94:95], v[20:21]
    v_pk_fma_f32 v[24:25], v[30:31], v[30:31], v[24:25]
    v_cvt_pk_bf16_f32 v43, v94, v95
    v_pk_add_f32 v[26:27], v[96:97], v[18:19]
    v_pk_add_f32 v[96:97], v[96:97], v[20:21]
    v_pk_fma_f32 v[22:23], v[26:27], v[26:27], v[22:23]
    v_cvt_pk_bf16_f32 v44, v96, v97
    v_pk_add_f32 v[28:29], v[98:99], v[18:19]
    v_pk_add_f32 v[98:99], v[98:99], v[20:21]
    v_pk_fma_f32 v[24:25], v[28:29], v[28:29], v[24:25]
    v_cvt_pk_bf16_f32 v45, v98, v99
    v_pk_add_f32 v[30:31], v[100:101], v[18:19]
    v_pk_add_f32 v[100:101], v[100:101], v[20:21]
    v_pk_fma_f32 v[22:23], v[30:31], v[30:31], v[22:23]
    v_cvt_pk_bf16_f32 v46, v100, v101
    v_pk_add_f32 v[26:27], v[102:103], v[18:19]
    v_pk_add_f32 v[102:103], v[102:103], v[20:21]
    v_pk_fma_f32 v[24:25], v[26:27], v[26:27], v[24:25]
    v_cvt_pk_bf16_f32 v47, v102, v103
    v_pk_add_f32 v[28:29], v[104:105], v[18:19]
    v_pk_add_f32 v[104:105], v[104:105], v[20:21]
    v_pk_fma_f32 v[22:23], v[28:29], v[28:29], v[22:23]
    v_cvt_pk_bf16_f32 v48, v104, v105
    v_pk_add_f32 v[30:31], v[106:107], v[18:19]
    v_pk_add_f32 v[106:107], v[106:107], v[20:21]
    v_pk_fma_f32 v[24:25], v[30:31], v[30:31], v[24:25]
    v_cvt_pk_bf16_f32 v49, v106, v107
    v_pk_add_f32 v[26:27], v[108:109], v[18:19]
    v_pk_add_f32 v[108:109], v[108:109], v[20:21]
    v_pk_fma_f32 v[22:23], v[26:27], v[26:27], v[22:23]
    v_cvt_pk_bf16_f32 v50, v108, v109
    v_pk_add_f32 v[28:29], v[110:111], v[18:19]
    v_pk_add_f32 v[110:111], v[110:111], v[20:21]
    v_pk_fma_f32 v[24:25], v[28:29], v[28:29], v[24:25]
    v_cvt_pk_bf16_f32 v51, v110, v111
    v_pk_add_f32 v[30:31], v[112:113], v[18:19]
    v_pk_add_f32 v[112:113], v[112:113], v[20:21]
    v_pk_fma_f32 v[22:23], v[30:31], v[30:31], v[22:23]
    v_cvt_pk_bf16_f32 v52, v112, v113
    v_pk_add_f32 v[26:27], v[114:115], v[18:19]
    v_pk_add_f32 v[114:115], v[114:115], v[20:21]
    v_pk_fma_f32 v[24:25], v[26:27], v[26:27], v[24:25]
    v_cvt_pk_bf16_f32 v53, v114, v115
    v_pk_add_f32 v[28:29], v[116:117], v[18:19]
    v_pk_add_f32 v[116:117], v[116:117], v[20:21]
    v_pk_fma_f32 v[22:23], v[28:29], v[28:29], v[22:23]
    v_cvt_pk_bf16_f32 v54, v116, v117
    v_pk_add_f32 v[30:31], v[118:119], v[18:19]
    v_pk_add_f32 v[118:119], v[118:119], v[20:21]
    v_pk_fma_f32 v[24:25], v[30:31], v[30:31], v[24:25]
    v_cvt_pk_bf16_f32 v55, v118, v119
    v_pk_add_f32 v[26:27], v[120:121], v[18:19]
    v_pk_add_f32 v[120:121], v[120:121], v[20:21]
    v_pk_fma_f32 v[22:23], v[26:27], v[26:27], v[22:23]
    v_cvt_pk_bf16_f32 v56, v120, v121
    v_pk_add_f32 v[28:29], v[122:123], v[18:19]
    v_pk_add_f32 v[122:123], v[122:123], v[20:21]
    v_pk_fma_f32 v[24:25], v[28:29], v[28:29], v[24:25]
    v_cvt_pk_bf16_f32 v57, v122, v123
    v_pk_add_f32 v[30:31], v[124:125], v[18:19]
    v_pk_add_f32 v[124:125], v[124:125], v[20:21]
    v_pk_fma_f32 v[22:23], v[30:31], v[30:31], v[22:23]
    v_cvt_pk_bf16_f32 v58, v124, v125
    v_pk_add_f32 v[26:27], v[126:127], v[18:19]
    v_pk_add_f32 v[126:127], v[126:127], v[20:21]
    v_pk_fma_f32 v[24:25], v[26:27], v[26:27], v[24:25]
    v_cvt_pk_bf16_f32 v59, v126, v127
    v_pk_add_f32 v[28:29], v[128:129], v[18:19]
    v_pk_add_f32 v[128:129], v[128:129], v[20:21]
    v_pk_fma_f32 v[22:23], v[28:29], v[28:29], v[22:23]
    v_cvt_pk_bf16_f32 v60, v128, v129
    v_pk_add_f32 v[30:31], v[130:131], v[18:19]
    v_pk_add_f32 v[130:131], v[130:131], v[20:21]
    v_pk_fma_f32 v[24:25], v[30:31], v[30:31], v[24:25]
    v_cvt_pk_bf16_f32 v61, v130, v131
    v_pk_add_f32 v[26:27], v[132:133], v[18:19]
    v_pk_add_f32 v[132:133], v[132:133], v[20:21]
    v_pk_fma_f32 v[22:23], v[26:27], v[26:27], v[22:23]
    v_cvt_pk_bf16_f32 v62, v132, v133
    v_pk_add_f32 v[28:29], v[134:135], v[18:19]
    v_pk_add_f32 v[134:135], v[134:135], v[20:21]
    v_pk_fma_f32 v[24:25], v[28:29], v[28:29], v[24:25]
    v_cvt_pk_bf16_f32 v63, v134, v135
    v_pk_add_f32 v[30:31], v[136:137], v[18:19]
    v_pk_add_f32 v[136:137], v[136:137], v[20:21]
    v_pk_fma_f32 v[22:23], v[30:31], v[30:31], v[22:23]
    v_cvt_pk_bf16_f32 v64, v136, v137
    v_pk_add_f32 v[26:27], v[138:139], v[18:19]
    v_pk_add_f32 v[138:139], v[138:139], v[20:21]
    v_pk_fma_f32 v[24:25], v[26:27], v[26:27], v[24:25]
    v_cvt_pk_bf16_f32 v65, v138, v139
    v_pk_add_f32 v[28:29], v[140:141], v[18:19]
    v_pk_add_f32 v[140:141], v[140:141], v[20:21]
    v_pk_fma_f32 v[22:23], v[28:29], v[28:29], v[22:23]
    v_cvt_pk_bf16_f32 v66, v140, v141
    v_pk_add_f32 v[30:31], v[142:143], v[18:19]
    v_pk_add_f32 v[142:143], v[142:143], v[20:21]
    v_pk_fma_f32 v[24:25], v[30:31], v[30:31], v[24:25]
    v_cvt_pk_bf16_f32 v67, v142, v143
    v_add_f32 v22, v22, v23
    v_add_f32 v24, v24, v25
    v_add_f32 v22, v22, v24
    s_nop 1
    v_add_f32_dpp v22, v22, v22 quad_perm:[1,0,3,2] row_mask:0xf bank_mask:0xf
    s_nop 1
    v_add_f32_dpp v22, v22, v22 quad_perm:[2,3,0,1] row_mask:0xf bank_mask:0xf
    s_nop 1
    v_add_f32_dpp v22, v22, v22 row_half_mirror row_mask:0xf bank_mask:0xf
    v_mul_f32 v22, 0x3ae38e39, v22
    v_cvt_pk_bf16_f32 v22, v22, v22
    v_lshlrev_b32 v22, 16, v22
    v_add_f32 v22, 0x3727c5ac, v22
    v_cvt_pk_bf16_f32 v22, v22, v22
    v_lshlrev_b32 v22, 16, v22
    v_sqrt_f32 v22, v22
    s_nop 0
    v_cvt_pk_bf16_f32 v22, v22, v22
    v_lshlrev_b32 v22, 16, v22
    v_rcp_f32 v22, v22
    s_nop 0
    v_mov_b32 v23, v22
    v_lshlrev_b32 v72, 16, v32
    v_and_b32 v73, 0xffff0000, v32
    v_lshlrev_b32 v74, 16, v33
    v_and_b32 v75, 0xffff0000, v33
    v_lshlrev_b32 v76, 16, v34
    v_and_b32 v77, 0xffff0000, v34
    v_lshlrev_b32 v78, 16, v35
    v_and_b32 v79, 0xffff0000, v35
    v_pk_mul_f32 v[72:73], v[72:73], v[22:23]
    v_pk_mul_f32 v[74:75], v[74:75], v[22:23]
    v_pk_mul_f32 v[76:77], v[76:77], v[22:23]
    v_pk_mul_f32 v[78:79], v[78:79], v[22:23]
    v_cvt_pk_bf16_f32 v32, v72, v73
    v_cvt_pk_bf16_f32 v33, v74, v75
    v_cvt_pk_bf16_f32 v34, v76, v77
    v_cvt_pk_bf16_f32 v35, v78, v79
    buffer_store_dwordx4 v[32:35], v14, s[28:31], s47 offen
    s_add_u32 s47, s47, 2048
    v_lshlrev_b32 v80, 16, v36
    v_and_b32 v81, 0xffff0000, v36
    v_lshlrev_b32 v82, 16, v37
    v_and_b32 v83, 0xffff0000, v37
    v_lshlrev_b32 v84, 16, v38
    v_and_b32 v85, 0xffff0000, v38
    v_lshlrev_b32 v86, 16, v39
    v_and_b32 v87, 0xffff0000, v39
    v_pk_mul_f32 v[80:81], v[80:81], v[22:23]
    v_pk_mul_f32 v[82:83], v[82:83], v[22:23]
    v_pk_mul_f32 v[84:85], v[84:85], v[22:23]
    v_pk_mul_f32 v[86:87], v[86:87], v[22:23]
    v_cvt_pk_bf16_f32 v36, v80, v81
    v_cvt_pk_bf16_f32 v37, v82, v83
    v_cvt_pk_bf16_f32 v38, v84, v85
    v_cvt_pk_bf16_f32 v39, v86, v87
    buffer_store_dwordx4 v[36:39], v14, s[28:31], s47 offen
    s_add_u32 s47, s47, 2048
    v_lshlrev_b32 v88, 16, v40
    v_and_b32 v89, 0xffff0000, v40
    v_lshlrev_b32 v90, 16, v41
    v_and_b32 v91, 0xffff0000, v41
    v_lshlrev_b32 v92, 16, v42
    v_and_b32 v93, 0xffff0000, v42
    v_lshlrev_b32 v94, 16, v43
    v_and_b32 v95, 0xffff0000, v43
    v_pk_mul_f32 v[88:89], v[88:89], v[22:23]
    v_pk_mul_f32 v[90:91], v[90:91], v[22:23]
    v_pk_mul_f32 v[92:93], v[92:93], v[22:23]
    v_pk_mul_f32 v[94:95], v[94:95], v[22:23]
    v_cvt_pk_bf16_f32 v40, v88, v89
    v_cvt_pk_bf16_f32 v41, v90, v91
    v_cvt_pk_bf16_f32 v42, v92, v93
    v_cvt_pk_bf16_f32 v43, v94, v95
    buffer_store_dwordx4 v[40:43], v14, s[28:31], s47 offen
    s_add_u32 s47, s47, 2048
    v_lshlrev_b32 v96, 16, v44
    v_and_b32 v97, 0xffff0000, v44
    v_lshlrev_b32 v98, 16, v45
    v_and_b32 v99, 0xffff0000, v45
    v_lshlrev_b32 v100, 16, v46
    v_and_b32 v101, 0xffff0000, v46
    v_lshlrev_b32 v102, 16, v47
    v_and_b32 v103, 0xffff0000, v47
    v_pk_mul_f32 v[96:97], v[96:97], v[22:23]
    v_pk_mul_f32 v[98:99], v[98:99], v[22:23]
    v_pk_mul_f32 v[100:101], v[100:101], v[22:23]
    v_pk_mul_f32 v[102:103], v[102:103], v[22:23]
    v_cvt_pk_bf16_f32 v44, v96, v97
    v_cvt_pk_bf16_f32 v45, v98, v99
    v_cvt_pk_bf16_f32 v46, v100, v101
    v_cvt_pk_bf16_f32 v47, v102, v103
    buffer_store_dwordx4 v[44:47], v14, s[28:31], s47 offen
    s_add_u32 s47, s47, 2048
    v_lshlrev_b32 v104, 16, v48
    v_and_b32 v105, 0xffff0000, v48
    v_lshlrev_b32 v106, 16, v49
    v_and_b32 v107, 0xffff0000, v49
    v_lshlrev_b32 v108, 16, v50
    v_and_b32 v109, 0xffff0000, v50
    v_lshlrev_b32 v110, 16, v51
    v_and_b32 v111, 0xffff0000, v51
    v_pk_mul_f32 v[104:105], v[104:105], v[22:23]
    v_pk_mul_f32 v[106:107], v[106:107], v[22:23]
    v_pk_mul_f32 v[108:109], v[108:109], v[22:23]
    v_pk_mul_f32 v[110:111], v[110:111], v[22:23]
    v_cvt_pk_bf16_f32 v48, v104, v105
    v_cvt_pk_bf16_f32 v49, v106, v107
    v_cvt_pk_bf16_f32 v50, v108, v109
    v_cvt_pk_bf16_f32 v51, v110, v111
    buffer_store_dwordx4 v[48:51], v14, s[28:31], s47 offen
    s_add_u32 s47, s47, 2048
    v_lshlrev_b32 v112, 16, v52
    v_and_b32 v113, 0xffff0000, v52
    v_lshlrev_b32 v114, 16, v53
    v_and_b32 v115, 0xffff0000, v53
    v_lshlrev_b32 v116, 16, v54
    v_and_b32 v117, 0xffff0000, v54
    v_lshlrev_b32 v118, 16, v55
    v_and_b32 v119, 0xffff0000, v55
    v_pk_mul_f32 v[112:113], v[112:113], v[22:23]
    v_pk_mul_f32 v[114:115], v[114:115], v[22:23]
    v_pk_mul_f32 v[116:117], v[116:117], v[22:23]
    v_pk_mul_f32 v[118:119], v[118:119], v[22:23]
    v_cvt_pk_bf16_f32 v52, v112, v113
    v_cvt_pk_bf16_f32 v53, v114, v115
    v_cvt_pk_bf16_f32 v54, v116, v117
    v_cvt_pk_bf16_f32 v55, v118, v119
    buffer_store_dwordx4 v[52:55], v14, s[28:31], s47 offen
    s_add_u32 s47, s47, 2048
    v_lshlrev_b32 v120, 16, v56
    v_and_b32 v121, 0xffff0000, v56
    v_lshlrev_b32 v122, 16, v57
    v_and_b32 v123, 0xffff0000, v57
    v_lshlrev_b32 v124, 16, v58
    v_and_b32 v125, 0xffff0000, v58
    v_lshlrev_b32 v126, 16, v59
    v_and_b32 v127, 0xffff0000, v59
    v_pk_mul_f32 v[120:121], v[120:121], v[22:23]
    v_pk_mul_f32 v[122:123], v[122:123], v[22:23]
    v_pk_mul_f32 v[124:125], v[124:125], v[22:23]
    v_pk_mul_f32 v[126:127], v[126:127], v[22:23]
    v_cvt_pk_bf16_f32 v56, v120, v121
    v_cvt_pk_bf16_f32 v57, v122, v123
    v_cvt_pk_bf16_f32 v58, v124, v125
    v_cvt_pk_bf16_f32 v59, v126, v127
    buffer_store_dwordx4 v[56:59], v14, s[28:31], s47 offen
    s_add_u32 s47, s47, 2048
    v_lshlrev_b32 v128, 16, v60
    v_and_b32 v129, 0xffff0000, v60
    v_lshlrev_b32 v130, 16, v61
    v_and_b32 v131, 0xffff0000, v61
    v_lshlrev_b32 v132, 16, v62
    v_and_b32 v133, 0xffff0000, v62
    v_lshlrev_b32 v134, 16, v63
    v_and_b32 v135, 0xffff0000, v63
    v_pk_mul_f32 v[128:129], v[128:129], v[22:23]
    v_pk_mul_f32 v[130:131], v[130:131], v[22:23]
    v_pk_mul_f32 v[132:133], v[132:133], v[22:23]
    v_pk_mul_f32 v[134:135], v[134:135], v[22:23]
    v_cvt_pk_bf16_f32 v60, v128, v129
    v_cvt_pk_bf16_f32 v61, v130, v131
    v_cvt_pk_bf16_f32 v62, v132, v133
    v_cvt_pk_bf16_f32 v63, v134, v135
    buffer_store_dwordx4 v[60:63], v14, s[28:31], s47 offen
    s_add_u32 s47, s47, 2048
    v_lshlrev_b32 v136, 16, v64
    v_and_b32 v137, 0xffff0000, v64
    v_lshlrev_b32 v138, 16, v65
    v_and_b32 v139, 0xffff0000, v65
    v_lshlrev_b32 v140, 16, v66
    v_and_b32 v141, 0xffff0000, v66
    v_lshlrev_b32 v142, 16, v67
    v_and_b32 v143, 0xffff0000, v67
    v_pk_mul_f32 v[136:137], v[136:137], v[22:23]
    v_pk_mul_f32 v[138:139], v[138:139], v[22:23]
    v_pk_mul_f32 v[140:141], v[140:141], v[22:23]
    v_pk_mul_f32 v[142:143], v[142:143], v[22:23]
    v_cvt_pk_bf16_f32 v64, v136, v137
    v_cvt_pk_bf16_f32 v65, v138, v139
    v_cvt_pk_bf16_f32 v66, v140, v141
    v_cvt_pk_bf16_f32 v67, v142, v143
    buffer_store_dwordx4 v[64:67], v14, s[28:31], s47 offen
    s_add_u32 s47, s47, 2048
    s_endpgm
K0_WO:
    s_cmp_ge_u32 s2, 81
    s_cbranch_scc1 K0_CT
    v_and_b32 v1, 63, v0
    s_mul_i32 s40, s2, 7282
    s_lshr_b32 s40, s40, 16
    s_mul_i32 s41, s40, 9
    s_sub_u32 s41, s2, s41
    v_lshrrev_b32 v5, 3, v1
    v_mul_u32_u24 v5, 1152, v5
    v_and_b32 v6, 7, v1
    v_lshl_add_u32 v5, v6, 4, v5
    s_mul_i32 s42, s40, 73728
    s_lshl_b32 s43, s41, 7
    s_add_u32 s42, s42, s43
    s_waitcnt lgkmcnt(0)
    s_mov_b32 s24, s8
    s_mov_b32 s25, s9
    s_mov_b32 s26, 663552
    s_mov_b32 s27, 0x00020000
    s_add_u32 s28, s22, 15728640
    s_addc_u32 s29, s23, 0
    s_mov_b32 s30, 663552
    s_mov_b32 s31, 0x00020000
    s_mov_b32 m0, 0
    s_nop 0
    buffer_load_dwordx4 v5, s[24:27], s42 offen lds
    s_add_u32 s42, s42, 9216
    s_mov_b32 m0, 1024
    s_nop 0
    buffer_load_dwordx4 v5, s[24:27], s42 offen lds
    s_add_u32 s42, s42, 9216
    s_mov_b32 m0, 2048
    s_nop 0
    buffer_load_dwordx4 v5, s[24:27], s42 offen lds
    s_add_u32 s42, s42, 9216
    s_mov_b32 m0, 3072
    s_nop 0
    buffer_load_dwordx4 v5, s[24:27], s42 offen lds
    s_add_u32 s42, s42, 9216
    s_mov_b32 m0, 4096
    s_nop 0
    buffer_load_dwordx4 v5, s[24:27], s42 offen lds
    s_add_u32 s42, s42, 9216
    s_mov_b32 m0, 5120
    s_nop 0
    buffer_load_dwordx4 v5, s[24:27], s42 offen lds
    s_add_u32 s42, s42, 9216
    s_mov_b32 m0, 6144
    s_nop 0
    buffer_load_dwordx4 v5, s[24:27], s42 offen lds
    s_add_u32 s42, s42, 9216
    s_mov_b32 m0, 7168
    s_nop 0
    buffer_load_dwordx4 v5, s[24:27], s42 offen lds
    s_add_u32 s42, s42, 9216
    v_lshrrev_b32 v6, 4, v1
    v_bfe_u32 v7, v1, 2, 2
    v_lshl_add_u32 v6, v6, 3, v7
    v_lshlrev_b32 v6, 7, v6
    v_and_b32 v7, 3, v1
    v_lshl_add_u32 v6, v7, 3, v6
    v_lshlrev_b32 v8, 4, v1
    s_mul_i32 s44, s41, 73728
    s_lshl_b32 s45, s40, 11
    s_add_u32 s44, s44, s45
    s_waitcnt vmcnt(0)
    ds_read_b64_tr_b16 v[16:17], v6 offset:0
    ds_read_b64_tr_b16 v[18:19], v6 offset:512
    ds_read_b64_tr_b16 v[20:21], v6 offset:4096
    ds_read_b64_tr_b16 v[22:23], v6 offset:4608
    ds_read_b64_tr_b16 v[24:25], v6 offset:32
    ds_read_b64_tr_b16 v[26:27], v6 offset:544
    ds_read_b64_tr_b16 v[28:29], v6 offset:4128
    ds_read_b64_tr_b16 v[30:31], v6 offset:4640
    ds_read_b64_tr_b16 v[32:33], v6 offset:64
    ds_read_b64_tr_b16 v[34:35], v6 offset:576
    ds_read_b64_tr_b16 v[36:37], v6 offset:4160
    ds_read_b64_tr_b16 v[38:39], v6 offset:4672
    ds_read_b64_tr_b16 v[40:41], v6 offset:96
    ds_read_b64_tr_b16 v[42:43], v6 offset:608
    ds_read_b64_tr_b16 v[44:45], v6 offset:4192
    ds_read_b64_tr_b16 v[46:47], v6 offset:4704
    s_waitcnt lgkmcnt(0)
    buffer_store_dwordx4 v[16:19], v8, s[28:31], s44 offen offset:0
    buffer_store_dwordx4 v[20:23], v8, s[28:31], s44 offen offset:1024
    s_add_u32 s44, s44, 18432
    buffer_store_dwordx4 v[24:27], v8, s[28:31], s44 offen offset:0
    buffer_store_dwordx4 v[28:31], v8, s[28:31], s44 offen offset:1024
    s_add_u32 s44, s44, 18432
    buffer_store_dwordx4 v[32:35], v8, s[28:31], s44 offen offset:0
    buffer_store_dwordx4 v[36:39], v8, s[28:31], s44 offen offset:1024
    s_add_u32 s44, s44, 18432
    buffer_store_dwordx4 v[40:43], v8, s[28:31], s44 offen offset:0
    buffer_store_dwordx4 v[44:47], v8, s[28:31], s44 offen offset:1024
    s_add_u32 s44, s44, 18432
    s_endpgm
K0_CT:
    s_cmp_lg_u32 s2, 200
    s_cbranch_scc1 K0_CT2
    s_waitcnt lgkmcnt(0)
    s_add_u32 s24, s22, 66060288
    s_addc_u32 s25, s23, 0
    s_mov_b32 s26, 8192
    s_mov_b32 s27, 0x00020000
    v_and_b32 v1, 63, v0
    v_lshlrev_b32 v1, 4, v1
    v_mov_b32 v4, 0
    v_mov_b32 v5, 0
    v_mov_b32 v6, 0
    v_mov_b32 v7, 0
    s_movk_i32 s40, 4096
    buffer_store_dwordx4 v[4:7], v1, s[24:27], 0 offen offset:0
    buffer_store_dwordx4 v[4:7], v1, s[24:27], s40 offen offset:0
    buffer_store_dwordx4 v[4:7], v1, s[24:27], 0 offen offset:1024
    buffer_store_dwordx4 v[4:7], v1, s[24:27], s40 offen offset:1024
    buffer_store_dwordx4 v[4:7], v1, s[24:27], 0 offen offset:2048
    buffer_store_dwordx4 v[4:7], v1, s[24:27], s40 offen offset:2048
    buffer_store_dwordx4 v[4:7], v1, s[24:27], 0 offen offset:3072
    buffer_store_dwordx4 v[4:7], v1, s[24:27], s40 offen offset:3072
    s_endpgm
K0_CT2:
    s_lshr_b32 s40, s2, 6
    s_cmp_lg_u32 s40, 2
    s_cbranch_scc1 K0_END
    s_mov_b32 s54, ALL_CODE_END-K0_PC
    v_and_b32 v1, 63, v0
    v_lshlrev_b32 v1, 7, v1
    v_add_u32 v1, 2048, v1
    buffer_load_dword v2, v1, s[52:55], 0 offen
    v_add_u32 v1, 8192, v1
    buffer_load_dword v3, v1, s[52:55], 0 offen
    v_add_u32 v1, 8192, v1
    buffer_load_dword v4, v1, s[52:55], 0 offen
    v_add_u32 v1, 8192, v1
    buffer_load_dword v5, v1, s[52:55], 0 offen
    v_add_u32 v1, 8192, v1
    buffer_load_dword v6, v1, s[52:55], 0 offen
    v_add_u32 v1, 8192, v1
    buffer_load_dword v7, v1, s[52:55], 0 offen
    v_add_u32 v1, 8192, v1
    buffer_load_dword v8, v1, s[52:55], 0 offen
    v_add_u32 v1, 8192, v1
    buffer_load_dword v9, v1, s[52:55], 0 offen
K0_END:
    s_endpgm
K0_CODE_END:
.section .rodata,"a"
.p2align 6
.amdhsa_kernel k0_kernel
  .amdhsa_next_free_vgpr 144
  .amdhsa_next_free_sgpr 102
  .amdhsa_accum_offset 144
  .amdhsa_group_segment_fixed_size 0
  .amdhsa_kernarg_size 80
  .amdhsa_user_sgpr_count 2
  .amdhsa_user_sgpr_kernarg_segment_ptr 1
  .amdhsa_system_sgpr_workgroup_id_x 1
  .amdhsa_float_denorm_mode_32 3
.end_amdhsa_kernel
.text

.globl k1_kernel
.p2align 8
.type k1_kernel,@function
k1_kernel:
    s_cmp_ge_u32 s2, 256
    s_cbranch_scc1 K1_END
    s_load_dwordx16 s[4:19], s[0:1], 0
    s_load_dwordx4 s[20:23], s[0:1], 64
    v_lshrrev_b32 v2, 6, v0
    v_and_b32 v1, 63, v0
    v_readfirstlane_b32 s44, v2
    s_and_b32 s56, s2, 7
    s_lshr_b32 s57, s2, 3
    s_and_b32 s68, s57, 1
    s_lshr_b32 s67, s57, 1
    s_lshl_b32 s65, s56, 1
    s_add_u32 s65, s65, s68
    s_mov_b32 s64, s67
    s_lshl_b32 s47, s44, 11
    s_lshr_b32 s56, s65, 1
    s_and_b32 s57, s65, 1
    s_and_b32 s45, s44, 1
    s_lshr_b32 s46, s44, 1
    s_sub_u32 s51, 5, s57
    s_mul_i32 s55, s56, 9
    s_mul_i32 s58, s57, 5
    s_add_u32 s55, s55, s58
    s_lshl_b32 s54, s56, 2
    s_mul_i32 s58, s56, 3
    s_add_u32 s58, s58, 3
    s_cmp_lt_u32 s56, 3
    s_cselect_b32 s54, s54, s58
    s_cselect_b32 s50, 4, 3
    s_mul_i32 s50, s50, s57
    s_mov_b32 s52, s51
    s_mov_b32 s60, 0xbfb8aa3b
    v_lshrrev_b32 v5, 3, v1
    s_lshl_b32 s56, s44, 4
    v_add_u32 v27, s56, v5
    s_lshl_b32 s56, s46, 5
    s_lshl_b32 s58, s45, 2
    s_add_u32 s56, s56, s58
    v_and_b32 v6, 3, v5
    v_lshrrev_b32 v7, 2, v5
    v_lshl_add_u32 v6, v7, 3, v6
    v_add_u32 v26, s56, v6
    v_bfe_u32 v6, v1, 4, 2
    v_lshlrev_b32 v6, 1, v6
    v_and_b32 v7, 7, v1
    v_xor_b32 v6, v6, v7
    v_lshlrev_b32 v28, 4, v6
    v_mul_u32_u24 v10, 9216, v26
    v_add_u32 v10, v10, v28
    v_lshlrev_b32 v18, 4, v1
    s_lshl_b32 s72, s64, 2
    s_add_u32 s72, s72, s44
    s_mul_i32 s72, s72, 36864
    s_add_u32 s75, s72, 18432
    s_lshl_b32 s73, s44, 12
    s_add_u32 s73, s73, 73728
    s_lshl_b32 s48, s55, 7
    v_add_u32 v38, 146432, v10
    s_mov_b32 s49, 589824
    s_waitcnt lgkmcnt(0)
    s_mov_b32 s28, s12
    s_mov_b32 s29, s13
    s_mov_b32 s30, 5308416
    s_mov_b32 s31, 0x00020000
    s_add_u32 s24, s22, 12582912
    s_addc_u32 s25, s23, 0
    s_mov_b32 s26, 2359296
    s_mov_b32 s27, 0x00020000
    s_add_u32 m0, s47, 0
    s_nop 0
    buffer_load_dwordx4 v10, s[28:31], s48 offen lds
    buffer_load_dwordx4 v38, s[28:31], s48 offen offset:1024 lds
    s_add_u32 s48, s48, s49
    s_add_u32 m0, s73, 0
    s_nop 0
    buffer_load_dwordx4 v18, s[24:27], s72 offen lds
    buffer_load_dwordx4 v18, s[24:27], s72 offen offset:1024 lds
    s_add_u32 s72, s72, 2048
    s_add_u32 m0, s73, 2048
    s_nop 0
    buffer_load_dwordx4 v18, s[24:27], s75 offen lds
    buffer_load_dwordx4 v18, s[24:27], s75 offen offset:1024 lds
    s_add_u32 s75, s75, 2048
    s_add_u32 m0, s47, 8192
    s_nop 0
    buffer_load_dwordx4 v10, s[28:31], s48 offen lds
    buffer_load_dwordx4 v38, s[28:31], s48 offen offset:1024 lds
    s_add_u32 s48, s48, s49
    s_add_u32 m0, s73, 16384
    s_nop 0
    buffer_load_dwordx4 v18, s[24:27], s72 offen lds
    buffer_load_dwordx4 v18, s[24:27], s72 offen offset:1024 lds
    s_add_u32 s72, s72, 2048
    s_add_u32 m0, s73, 18432
    s_nop 0
    buffer_load_dwordx4 v18, s[24:27], s75 offen lds
    buffer_load_dwordx4 v18, s[24:27], s75 offen offset:1024 lds
    s_add_u32 s75, s75, 2048
    v_subrev_u32 v3, s50, v1
    v_cmp_gt_u32 vcc, 2, v1
    s_nop 1
    v_cndmask_b32 v3, v3, v1, vcc
    v_lshrrev_b32 v4, 1, v3
    v_add_u32 v4, s55, v4
    v_lshlrev_b32 v4, 7, v4
    v_and_b32 v5, 1, v3
    v_cmp_eq_u32 vcc, 1, v5
    v_mov_b32 v19, s12
    v_mov_b32 v6, s14
    v_cndmask_b32 v19, v19, v6, vcc
    v_mov_b32 v20, s13
    v_mov_b32 v6, s15
    v_cndmask_b32 v20, v20, v6, vcc
    v_mov_b32 v21, 5308416
    v_mov_b32 v22, 589824
    v_mov_b32 v23, 9216
    v_mov_b32 v24, 0
    v_mov_b32 v25, 146432
    v_subrev_u32 v5, 2, v1
    v_cmp_gt_u32 vcc, s50, v5
    v_add_u32 v5, s54, v5
    v_lshlrev_b32 v5, 7, v5
    v_cndmask_b32 v4, v4, v5, vcc
    v_mov_b32 v6, s6
    v_cndmask_b32 v19, v19, v6, vcc
    v_mov_b32 v6, s7
    v_cndmask_b32 v20, v20, v6, vcc
    v_mov_b32 v6, 1990656
    v_cndmask_b32 v21, v21, v6, vcc
    v_mov_b32 v6, 221184
    v_cndmask_b32 v22, v22, v6, vcc
    v_mov_b32 v6, 3456
    v_cndmask_b32 v23, v23, v6, vcc
    v_mov_b32 v6, 54272
    v_cndmask_b32 v25, v25, v6, vcc
    s_lshl_b32 s56, s51, 1
    s_add_u32 s56, s56, s50
    v_cmp_le_u32 vcc, s56, v1
    v_subrev_u32 v5, s56, v1
    v_lshlrev_b32 v5, 8, v5
    s_mul_i32 s57, s55, 73728
    v_add_u32 v5, s57, v5
    v_cndmask_b32 v4, v4, v5, vcc
    v_mov_b32 v6, s16
    v_cndmask_b32 v19, v19, v6, vcc
    v_mov_b32 v6, s17
    v_cndmask_b32 v20, v20, v6, vcc
    v_mov_b32 v6, 5308416
    v_cndmask_b32 v21, v21, v6, vcc
    v_mov_b32 v6, 73728
    v_cndmask_b32 v22, v22, v6, vcc
    v_mov_b32 v6, 0
    v_cndmask_b32 v23, v23, v6, vcc
    v_mov_b32 v6, 1152
    v_cndmask_b32 v24, v24, v6, vcc
    v_mov_b32 v6, 8192
    v_cndmask_b32 v25, v25, v6, vcc
    s_add_u32 s56, s56, 5
    v_cmp_le_u32 vcc, s56, v1
    v_mov_b32 v6, 0
    s_nop 0
    v_cndmask_b32 v4, v4, v6, vcc
    v_cndmask_b32 v21, v21, v6, vcc
    v_sub_u32 v21, v21, v4
    v_add_co_u32 v19, vcc, v19, v4
    s_nop 1
    v_addc_co_u32 v20, vcc, 0, v20, vcc
    s_mov_b32 s35, 0x00020000
    s_mul_i32 s56, s67, 36
    s_mul_i32 s57, s44, 9
    s_add_u32 s56, s56, s57
    v_min_u32 v29, 8, v1
    v_add_u32 v29, s56, v29
    s_mov_b32 s66, 1
    s_mov_b32 s80, 2
    s_mov_b32 s56, 73728
    s_cmp_eq_u32 s51, 4
    s_cselect_b32 s53, 0xfffca100, s56
    v_readlane_b32 s71, v23, s80
    v_readlane_b32 s32, v19, s80
    v_readlane_b32 s33, v20, s80
    v_readlane_b32 s34, v21, s80
    v_mul_u32_u24 v30, s71, v29
    s_cmp_eq_u32 s71, 0
    s_cselect_b32 s71, 1, 0
    s_add_u32 s80, s80, 1
    v_mad_u32_u24 v30, v8, s71, v30
    s_mov_b32 s36, s22
    s_mov_b32 s37, s23
    s_mov_b32 s38, 7077888
    s_mov_b32 s39, 0x00020000
    s_add_u32 s40, s22, 16777216
    s_addc_u32 s41, s23, 0
    s_mov_b32 s42, 37748736
    s_mov_b32 s43, 0x00020000
    s_mov_b32 s4, s22
    s_mov_b32 s5, s23
    s_mov_b32 s6, 7077888
    s_mov_b32 s7, 0x00020000
    s_add_u32 s8, s22, 8388608
    s_addc_u32 s9, s23, 0
    s_mov_b32 s10, 2359296
    s_mov_b32 s11, 0x00020000
    s_add_u32 s12, s22, 66060288
    s_addc_u32 s13, s23, 0
    s_mov_b32 s14, 8192
    s_mov_b32 s15, 0x00020000
    s_and_b32 s16, s2, 7
    s_lshl_b32 s16, s16, 2
    s_lshr_b32 s56, s2, 6
    s_add_u32 s16, s16, s56
    s_lshr_b32 s17, s2, 3
    s_and_b32 s17, s17, 7
    s_mov_b32 s82, 0
    s_mov_b32 s19, 0
    v_and_b32 v5, 15, v1
    v_lshrrev_b32 v6, 4, v1
    s_lshl_b32 s56, s64, 1
    s_add_u32 s56, s56, s45
    s_mul_i32 s56, s56, 221184
    s_lshl_b32 s57, s46, 11
    s_add_u32 s56, s56, s57
    v_lshlrev_b32 v7, 6, v5
    v_lshl_add_u32 v7, v6, 4, v7
    v_add_u32 v17, s56, v7
    s_lshl_b32 s63, s54, 12
    s_sub_u32 s63, s63, 4096
    s_mov_b32 s61, 0
    s_lshl_b32 s62, s64, 1
    s_add_u32 s62, s62, s45
    s_mul_i32 s62, s62, 36
    s_add_u32 s62, s62, s46
    s_lshl_b32 s62, s62, 5
    s_add_u32 s62, s62, s65
    s_lshl_b32 s76, s62, 10
    s_add_u32 s77, s76, 589824
    s_add_u32 s78, s76, 16384
    s_add_u32 s79, s77, 16384
    v_lshrrev_b32 v7, 2, v1
    v_bfe_u32 v8, v1, 3, 2
    v_lshlrev_b32 v7, 7, v7
    v_and_b32 v9, 3, v1
    v_lshl_add_u32 v7, v9, 3, v7
    s_lshl_b32 s56, s46, 1
    v_xor_b32 v8, s56, v8
    v_lshl_add_u32 v11, v8, 5, v7
    v_xor_b32 v8, 1, v8
    v_lshl_add_u32 v13, v8, 5, v7
    v_add_u32 v12, 40960, v11
    v_add_u32 v14, 40960, v13
    s_lshl_b32 s56, s45, 13
    s_add_u32 s56, s56, 73728
    v_add_u32 v32, s56, v18
    v_lshlrev_b32 v7, 3, v1
    v_add_u32 v16, s56, v7
    v_add_u32 v33, 49152, v32
    s_lshl_b32 s57, s46, 12
    v_add_u32 v15, s57, v16
    s_add_u32 m0, s47, 16384
    s_nop 0
    buffer_load_dwordx4 v10, s[28:31], s48 offen lds
    buffer_load_dwordx4 v38, s[28:31], s48 offen offset:1024 lds
    s_add_u32 s48, s48, s49
    s_add_u32 m0, s73, 32768
    s_nop 0
    buffer_load_dwordx4 v18, s[24:27], s72 offen lds
    buffer_load_dwordx4 v18, s[24:27], s72 offen offset:1024 lds
    s_add_u32 s72, s72, 2048
    s_add_u32 m0, s73, 34816
    s_nop 0
    buffer_load_dwordx4 v18, s[24:27], s75 offen lds
    buffer_load_dwordx4 v18, s[24:27], s75 offen offset:1024 lds
    s_add_u32 s75, s75, 2048
    s_lshl_b32 s56, s67, 2
    s_add_u32 s56, s56, s44
    s_lshl_b32 s57, s51, 0
    s_mul_i32 s56, s56, s57
    s_sub_u32 s57, s57, 1
    v_lshrrev_b32 v7, 1, v1
    v_min_u32 v7, s57, v7
    v_add_u32 v7, s56, v7
    v_mul_u32_u24 v7, 1152, v7
    v_and_b32 v6, 1, v1
    v_lshl_add_u32 v8, v6, 7, v7
    v_mov_b32 v9, 0
    v_mov_b32 v39, 0
    s_waitcnt vmcnt(12)
    s_barrier
    ds_read_b64_tr_b16 v[40:41], v11 offset:0
    ds_read_b64_tr_b16 v[42:43], v11 offset:2048
    ds_read_b64_tr_b16 v[44:45], v11 offset:4096
    ds_read_b64_tr_b16 v[46:47], v11 offset:6144
    ds_read_b128 a[0:3], v32 offset:0
    ds_read_b128 a[4:7], v32 offset:2048
    ds_read_b128 a[8:11], v32 offset:4096
    ds_read_b128 a[12:15], v32 offset:6144
    ds_read_b128 a[16:19], v32 offset:1024
    ds_read_b128 a[20:23], v32 offset:3072
    ds_read_b128 a[24:27], v32 offset:5120
    ds_read_b128 a[28:31], v32 offset:7168
    s_waitcnt lgkmcnt(8)
    ds_read_b64_tr_b16 v[48:49], v13 offset:0
    ds_read_b64_tr_b16 v[50:51], v13 offset:2048
    ds_read_b64_tr_b16 v[52:53], v13 offset:4096
    ds_read_b64_tr_b16 v[54:55], v13 offset:6144
    s_waitcnt vmcnt(6) lgkmcnt(4)
    s_barrier
    v_mfma_f32_16x16x32_bf16 v[64:67], v[40:43], a[0:3], 0
    ds_read_b64_tr_b16 v[56:57], v11 offset:8192
    s_add_u32 m0, s47, 24576
    v_mfma_f32_16x16x32_bf16 v[64:67], v[44:47], a[16:19], v[64:67]
    ds_read_b128 a[32:35], v32 offset:16384
    buffer_load_dwordx4 v10, s[28:31], s48 offen lds
    v_mfma_f32_16x16x32_bf16 v[68:71], v[40:43], a[4:7], 0
    ds_read_b64_tr_b16 v[58:59], v11 offset:10240
    buffer_load_dwordx4 v38, s[28:31], s48 offen offset:1024 lds
    s_add_u32 s48, s48, s49
    v_mfma_f32_16x16x32_bf16 v[68:71], v[44:47], a[20:23], v[68:71]
    ds_read_b128 a[36:39], v32 offset:18432
    s_add_u32 m0, s73, 49152
    v_mfma_f32_16x16x32_bf16 v[72:75], v[40:43], a[8:11], 0
    ds_read_b64_tr_b16 v[60:61], v11 offset:12288
    buffer_load_dwordx4 v18, s[24:27], s72 offen lds
    v_mfma_f32_16x16x32_bf16 v[72:75], v[44:47], a[24:27], v[72:75]
    ds_read_b128 a[40:43], v32 offset:20480
    buffer_load_dwordx4 v18, s[24:27], s72 offen offset:1024 lds
    s_add_u32 s72, s72, 2048
    v_mfma_f32_16x16x32_bf16 v[76:79], v[40:43], a[12:15], 0
    ds_read_b64_tr_b16 v[62:63], v11 offset:14336
    s_add_u32 m0, s73, 51200
    v_mfma_f32_16x16x32_bf16 v[76:79], v[44:47], a[28:31], v[76:79]
    ds_read_b128 a[44:47], v32 offset:22528
    buffer_load_dwordx4 v18, s[24:27], s75 offen lds
    s_waitcnt lgkmcnt(8)
    v_mfma_f32_16x16x32_bf16 v[80:83], v[48:51], a[0:3], 0
    ds_read_b64_tr_b16 v[40:41], v13 offset:8192
    buffer_load_dwordx4 v18, s[24:27], s75 offen offset:1024 lds
    s_add_u32 s75, s75, 2048
    v_mfma_f32_16x16x32_bf16 v[80:83], v[52:55], a[16:19], v[80:83]
    ds_read_b128 a[48:51], v32 offset:17408
    v_mfma_f32_16x16x32_bf16 v[84:87], v[48:51], a[4:7], 0
    ds_read_b64_tr_b16 v[42:43], v13 offset:10240
    v_mfma_f32_16x16x32_bf16 v[84:87], v[52:55], a[20:23], v[84:87]
    ds_read_b128 a[52:55], v32 offset:19456
    v_mfma_f32_16x16x32_bf16 v[88:91], v[48:51], a[8:11], 0
    ds_read_b64_tr_b16 v[44:45], v13 offset:12288
    v_mfma_f32_16x16x32_bf16 v[88:91], v[52:55], a[24:27], v[88:91]
    ds_read_b128 a[56:59], v32 offset:21504
    v_mfma_f32_16x16x32_bf16 v[92:95], v[48:51], a[12:15], 0
    ds_read_b64_tr_b16 v[46:47], v13 offset:14336
    v_mfma_f32_16x16x32_bf16 v[92:95], v[52:55], a[28:31], v[92:95]
    ds_read_b128 a[60:63], v32 offset:23552
    s_waitcnt vmcnt(6) lgkmcnt(0)
    s_barrier
    v_mfma_f32_16x16x32_bf16 v[64:67], v[56:59], a[32:35], v[64:67]
    ds_read_b64_tr_b16 v[48:49], v11 offset:16384
    s_add_u32 m0, s47, 32768
    v_mfma_f32_16x16x32_bf16 v[64:67], v[60:63], a[48:51], v[64:67]
    ds_read_b128 a[64:67], v32 offset:32768
    buffer_load_dwordx4 v10, s[28:31], s48 offen lds
    v_mfma_f32_16x16x32_bf16 v[68:71], v[56:59], a[36:39], v[68:71]
    ds_read_b64_tr_b16 v[50:51], v11 offset:18432
    buffer_load_dwordx4 v38, s[28:31], s48 offen offset:1024 lds
    s_add_u32 s48, s48, s49
    v_mfma_f32_16x16x32_bf16 v[68:71], v[60:63], a[52:55], v[68:71]
    ds_read_b128 a[68:71], v32 offset:34816
    s_add_u32 m0, s73, 65536
    v_mfma_f32_16x16x32_bf16 v[72:75], v[56:59], a[40:43], v[72:75]
    ds_read_b64_tr_b16 v[52:53], v11 offset:20480
    buffer_load_dwordx4 v18, s[24:27], s72 offen lds
    v_mfma_f32_16x16x32_bf16 v[72:75], v[60:63], a[56:59], v[72:75]
    ds_read_b128 a[72:75], v32 offset:36864
    buffer_load_dwordx4 v18, s[24:27], s72 offen offset:1024 lds
    s_add_u32 s72, s72, 2048
    v_mfma_f32_16x16x32_bf16 v[76:79], v[56:59], a[44:47], v[76:79]
    ds_read_b64_tr_b16 v[54:55], v11 offset:22528
    s_add_u32 m0, s73, 67584
    v_mfma_f32_16x16x32_bf16 v[76:79], v[60:63], a[60:63], v[76:79]
    ds_read_b128 a[76:79], v32 offset:38912
    buffer_load_dwordx4 v18, s[24:27], s75 offen lds
    v_mfma_f32_16x16x32_bf16 v[80:83], v[40:43], a[32:35], v[80:83]
    ds_read_b64_tr_b16 v[56:57], v13 offset:16384
    buffer_load_dwordx4 v18, s[24:27], s75 offen offset:1024 lds
    s_add_u32 s75, s75, 2048
    v_mfma_f32_16x16x32_bf16 v[80:83], v[44:47], a[48:51], v[80:83]
    ds_read_b128 a[80:83], v32 offset:33792
    v_mfma_f32_16x16x32_bf16 v[84:87], v[40:43], a[36:39], v[84:87]
    ds_read_b64_tr_b16 v[58:59], v13 offset:18432
    v_mfma_f32_16x16x32_bf16 v[84:87], v[44:47], a[52:55], v[84:87]
    ds_read_b128 a[84:87], v32 offset:35840
    v_mfma_f32_16x16x32_bf16 v[88:91], v[40:43], a[40:43], v[88:91]
    ds_read_b64_tr_b16 v[60:61], v13 offset:20480
    v_mfma_f32_16x16x32_bf16 v[88:91], v[44:47], a[56:59], v[88:91]
    ds_read_b128 a[88:91], v32 offset:37888
    v_mfma_f32_16x16x32_bf16 v[92:95], v[40:43], a[44:47], v[92:95]
    ds_read_b64_tr_b16 v[62:63], v13 offset:22528
    v_mfma_f32_16x16x32_bf16 v[92:95], v[44:47], a[60:63], v[92:95]
    ds_read_b128 a[92:95], v32 offset:39936
    s_waitcnt vmcnt(6) lgkmcnt(0)
    s_barrier
    v_mfma_f32_16x16x32_bf16 v[64:67], v[48:51], a[64:67], v[64:67]
    ds_read_b64_tr_b16 v[40:41], v11 offset:24576
    s_add_u32 m0, s47, 40960
    v_mfma_f32_16x16x32_bf16 v[64:67], v[52:55], a[80:83], v[64:67]
    ds_read_b128 a[96:99], v33 offset:0
    buffer_load_dwordx4 v10, s[28:31], s48 offen lds
    v_mfma_f32_16x16x32_bf16 v[68:71], v[48:51], a[68:71], v[68:71]
    ds_read_b64_tr_b16 v[42:43], v11 offset:26624
    buffer_load_dwordx4 v38, s[28:31], s48 offen offset:1024 lds
    s_add_u32 s48, s48, s49
    v_mfma_f32_16x16x32_bf16 v[68:71], v[52:55], a[84:87], v[68:71]
    ds_read_b128 a[100:103], v33 offset:2048
    s_add_u32 m0, s73, 0
    v_mfma_f32_16x16x32_bf16 v[72:75], v[48:51], a[72:75], v[72:75]
    ds_read_b64_tr_b16 v[44:45], v11 offset:28672
    buffer_load_dwordx4 v18, s[24:27], s72 offen lds
    v_mfma_f32_16x16x32_bf16 v[72:75], v[52:55], a[88:91], v[72:75]
    ds_read_b128 a[104:107], v33 offset:4096
    buffer_load_dwordx4 v18, s[24:27], s72 offen offset:1024 lds
    s_add_u32 s72, s72, 2048
    v_mfma_f32_16x16x32_bf16 v[76:79], v[48:51], a[76:79], v[76:79]
    ds_read_b64_tr_b16 v[46:47], v11 offset:30720
    s_add_u32 m0, s73, 2048
    v_mfma_f32_16x16x32_bf16 v[76:79], v[52:55], a[92:95], v[76:79]
    ds_read_b128 a[108:111], v33 offset:6144
    buffer_load_dwordx4 v18, s[24:27], s75 offen lds
    v_mfma_f32_16x16x32_bf16 v[80:83], v[56:59], a[64:67], v[80:83]
    ds_read_b64_tr_b16 v[48:49], v13 offset:24576
    buffer_load_dwordx4 v18, s[24:27], s75 offen offset:1024 lds
    s_add_u32 s75, s75, 2048
    v_mfma_f32_16x16x32_bf16 v[80:83], v[60:63], a[80:83], v[80:83]
    ds_read_b128 a[112:115], v33 offset:1024
    v_mfma_f32_16x16x32_bf16 v[84:87], v[56:59], a[68:71], v[84:87]
    ds_read_b64_tr_b16 v[50:51], v13 offset:26624
    v_mfma_f32_16x16x32_bf16 v[84:87], v[60:63], a[84:87], v[84:87]
    ds_read_b128 a[116:119], v33 offset:3072
    v_mfma_f32_16x16x32_bf16 v[88:91], v[56:59], a[72:75], v[88:91]
    ds_read_b64_tr_b16 v[52:53], v13 offset:28672
    v_mfma_f32_16x16x32_bf16 v[88:91], v[60:63], a[88:91], v[88:91]
    ds_read_b128 a[120:123], v33 offset:5120
    v_mfma_f32_16x16x32_bf16 v[92:95], v[56:59], a[76:79], v[92:95]
    ds_read_b64_tr_b16 v[54:55], v13 offset:30720
    v_mfma_f32_16x16x32_bf16 v[92:95], v[60:63], a[92:95], v[92:95]
    ds_read_b128 a[124:127], v33 offset:7168
    s_waitcnt vmcnt(6) lgkmcnt(0)
    s_barrier
    v_mfma_f32_16x16x32_bf16 v[64:67], v[40:43], a[96:99], v[64:67]
    ds_read_b64_tr_b16 v[56:57], v11 offset:32768
    s_add_u32 m0, s47, 49152
    v_mfma_f32_16x16x32_bf16 v[64:67], v[44:47], a[112:115], v[64:67]
    ds_read_b128 a[128:131], v33 offset:16384
    buffer_load_dwordx4 v10, s[28:31], s48 offen lds
    v_mfma_f32_16x16x32_bf16 v[68:71], v[40:43], a[100:103], v[68:71]
    ds_read_b64_tr_b16 v[58:59], v11 offset:34816
    buffer_load_dwordx4 v38, s[28:31], s48 offen offset:1024 lds
    s_add_u32 s48, s48, s49
    v_mfma_f32_16x16x32_bf16 v[68:71], v[44:47], a[116:119], v[68:71]
    ds_read_b128 a[132:135], v33 offset:18432
    s_add_u32 m0, s73, 16384
    v_mfma_f32_16x16x32_bf16 v[72:75], v[40:43], a[104:107], v[72:75]
    ds_read_b64_tr_b16 v[60:61], v11 offset:36864
    buffer_load_dwordx4 v18, s[24:27], s72 offen lds
    v_mfma_f32_16x16x32_bf16 v[72:75], v[44:47], a[120:123], v[72:75]
    ds_read_b128 a[136:139], v33 offset:20480
    buffer_load_dwordx4 v18, s[24:27], s72 offen offset:1024 lds
    s_add_u32 s72, s72, 2048
    v_mfma_f32_16x16x32_bf16 v[76:79], v[40:43], a[108:111], v[76:79]
    ds_read_b64_tr_b16 v[62:63], v11 offset:38912
    s_add_u32 m0, s73, 18432
    v_mfma_f32_16x16x32_bf16 v[76:79], v[44:47], a[124:127], v[76:79]
    ds_read_b128 a[140:143], v33 offset:22528
    buffer_load_dwordx4 v18, s[24:27], s75 offen lds
    v_mfma_f32_16x16x32_bf16 v[80:83], v[48:51], a[96:99], v[80:83]
    ds_read_b64_tr_b16 v[40:41], v13 offset:32768
    buffer_load_dwordx4 v18, s[24:27], s75 offen offset:1024 lds
    s_add_u32 s75, s75, 2048
    v_mfma_f32_16x16x32_bf16 v[80:83], v[52:55], a[112:115], v[80:83]
    ds_read_b128 a[144:147], v33 offset:17408
    v_mfma_f32_16x16x32_bf16 v[84:87], v[48:51], a[100:103], v[84:87]
    ds_read_b64_tr_b16 v[42:43], v13 offset:34816
    v_mfma_f32_16x16x32_bf16 v[84:87], v[52:55], a[116:119], v[84:87]
    ds_read_b128 a[148:151], v33 offset:19456
    v_mfma_f32_16x16x32_bf16 v[88:91], v[48:51], a[104:107], v[88:91]
    ds_read_b64_tr_b16 v[44:45], v13 offset:36864
    v_mfma_f32_16x16x32_bf16 v[88:91], v[52:55], a[120:123], v[88:91]
    ds_read_b128 a[152:155], v33 offset:21504
    v_mfma_f32_16x16x32_bf16 v[92:95], v[48:51], a[108:111], v[92:95]
    ds_read_b64_tr_b16 v[46:47], v13 offset:38912
    v_mfma_f32_16x16x32_bf16 v[92:95], v[52:55], a[124:127], v[92:95]
    ds_read_b128 a[156:159], v33 offset:23552
    s_waitcnt vmcnt(6) lgkmcnt(0)
    s_barrier
    v_mfma_f32_16x16x32_bf16 v[64:67], v[56:59], a[128:131], v[64:67]
    ds_read_b64_tr_b16 v[48:49], v12 offset:0
    s_add_u32 m0, s47, 57344
    v_mfma_f32_16x16x32_bf16 v[64:67], v[60:63], a[144:147], v[64:67]
    ds_read_b128 a[160:163], v32 offset:0
    buffer_load_dwordx4 v10, s[28:31], s48 offen lds
    v_mfma_f32_16x16x32_bf16 v[68:71], v[56:59], a[132:135], v[68:71]
    ds_read_b64_tr_b16 v[50:51], v12 offset:2048
    buffer_load_dwordx4 v38, s[28:31], s48 offen offset:1024 lds
    s_add_u32 s48, s48, s49
    v_mfma_f32_16x16x32_bf16 v[68:71], v[60:63], a[148:151], v[68:71]
    ds_read_b128 a[164:167], v32 offset:2048
    s_add_u32 m0, s73, 32768
    v_mfma_f32_16x16x32_bf16 v[72:75], v[56:59], a[136:139], v[72:75]
    ds_read_b64_tr_b16 v[52:53], v12 offset:4096
    buffer_load_dwordx4 v18, s[24:27], s72 offen lds
    v_mfma_f32_16x16x32_bf16 v[72:75], v[60:63], a[152:155], v[72:75]
    ds_read_b128 a[168:171], v32 offset:4096
    buffer_load_dwordx4 v18, s[24:27], s72 offen offset:1024 lds
    s_add_u32 s72, s72, 2048
    v_mfma_f32_16x16x32_bf16 v[76:79], v[56:59], a[140:143], v[76:79]
    ds_read_b64_tr_b16 v[54:55], v12 offset:6144
    s_add_u32 m0, s73, 34816
    v_mfma_f32_16x16x32_bf16 v[76:79], v[60:63], a[156:159], v[76:79]
    ds_read_b128 a[172:175], v32 offset:6144
    buffer_load_dwordx4 v18, s[24:27], s75 offen lds
    v_mfma_f32_16x16x32_bf16 v[80:83], v[40:43], a[128:131], v[80:83]
    ds_read_b64_tr_b16 v[56:57], v14 offset:0
    buffer_load_dwordx4 v18, s[24:27], s75 offen offset:1024 lds
    s_add_u32 s75, s75, 2048
    v_mfma_f32_16x16x32_bf16 v[80:83], v[44:47], a[144:147], v[80:83]
    ds_read_b128 a[176:179], v32 offset:1024
    v_mfma_f32_16x16x32_bf16 v[84:87], v[40:43], a[132:135], v[84:87]
    ds_read_b64_tr_b16 v[58:59], v14 offset:2048
    v_mfma_f32_16x16x32_bf16 v[84:87], v[44:47], a[148:151], v[84:87]
    ds_read_b128 a[180:183], v32 offset:3072
    v_mfma_f32_16x16x32_bf16 v[88:91], v[40:43], a[136:139], v[88:91]
    ds_read_b64_tr_b16 v[60:61], v14 offset:4096
    v_mfma_f32_16x16x32_bf16 v[88:91], v[44:47], a[152:155], v[88:91]
    ds_read_b128 a[184:187], v32 offset:5120
    v_mfma_f32_16x16x32_bf16 v[92:95], v[40:43], a[140:143], v[92:95]
    ds_read_b64_tr_b16 v[62:63], v14 offset:6144
    v_mfma_f32_16x16x32_bf16 v[92:95], v[44:47], a[156:159], v[92:95]
    ds_read_b128 a[188:191], v32 offset:7168
    s_waitcnt vmcnt(6) lgkmcnt(0)
    s_barrier
    v_mfma_f32_16x16x32_bf16 v[64:67], v[48:51], a[160:163], v[64:67]
    ds_read_b64_tr_b16 v[40:41], v12 offset:8192
    s_add_u32 m0, s47, 65536
    v_mfma_f32_16x16x32_bf16 v[64:67], v[52:55], a[176:179], v[64:67]
    ds_read_b128 a[192:195], v32 offset:16384
    buffer_load_dwordx4 v10, s[28:31], s48 offen lds
    v_mfma_f32_16x16x32_bf16 v[68:71], v[48:51], a[164:167], v[68:71]
    ds_read_b64_tr_b16 v[42:43], v12 offset:10240
    buffer_load_dwordx4 v38, s[28:31], s48 offen offset:1024 lds
    s_add_u32 s48, s48, s49
    s_add_u32 m0, s73, 49152
    v_mfma_f32_16x16x32_bf16 v[68:71], v[52:55], a[180:183], v[68:71]
    ds_read_b128 a[196:199], v32 offset:18432
    buffer_load_dwordx4 v18, s[24:27], s72 offen lds
    v_mfma_f32_16x16x32_bf16 v[72:75], v[48:51], a[168:171], v[72:75]
    ds_read_b64_tr_b16 v[44:45], v12 offset:12288
    buffer_load_dwordx4 v18, s[24:27], s72 offen offset:1024 lds
    s_add_u32 s72, s72, 2048
    s_add_u32 m0, s73, 51200
    v_mfma_f32_16x16x32_bf16 v[72:75], v[52:55], a[184:187], v[72:75]
    ds_read_b128 a[200:203], v32 offset:20480
    buffer_load_dwordx4 v18, s[24:27], s75 offen lds
    v_mfma_f32_16x16x32_bf16 v[76:79], v[48:51], a[172:175], v[76:79]
    ds_read_b64_tr_b16 v[46:47], v12 offset:14336
    buffer_load_dwordx4 v18, s[24:27], s75 offen offset:1024 lds
    s_add_u32 s75, s75, 2048
    v_mfma_f32_16x16x32_bf16 v[76:79], v[52:55], a[188:191], v[76:79]
    ds_read_b128 a[204:207], v32 offset:22528
    buffer_load_dword v31, v30, s[32:35], 0 offen
    v_readlane_b32 s69, v23, s66
    v_readlane_b32 s70, v24, s66
    v_mfma_f32_16x16x32_bf16 v[80:83], v[56:59], a[160:163], v[80:83]
    ds_read_b64_tr_b16 v[48:49], v14 offset:8192
    v_readlane_b32 s81, v25, s66
    v_readlane_b32 s28, v19, s66
    v_readlane_b32 s29, v20, s66
    v_mfma_f32_16x16x32_bf16 v[80:83], v[60:63], a[176:179], v[80:83]
    ds_read_b128 a[208:211], v32 offset:17408
    v_readlane_b32 s30, v21, s66
    v_readlane_b32 s49, v22, s66
    v_mfma_f32_16x16x32_bf16 v[84:87], v[56:59], a[164:167], v[84:87]
    ds_read_b64_tr_b16 v[50:51], v14 offset:10240
    v_mad_u32_u24 v10, v26, s69, v28
    v_mad_u32_u24 v10, v27, s70, v10
    v_mfma_f32_16x16x32_bf16 v[84:87], v[60:63], a[180:183], v[84:87]
    ds_read_b128 a[212:215], v32 offset:19456
    s_mov_b32 s48, 0
    v_add_u32 v38, s81, v10
    v_mfma_f32_16x16x32_bf16 v[88:91], v[56:59], a[168:171], v[88:91]
    ds_read_b64_tr_b16 v[52:53], v14 offset:12288
    s_add_u32 s66, s66, 1
    v_mfma_f32_16x16x32_bf16 v[88:91], v[60:63], a[184:187], v[88:91]
    ds_read_b128 a[216:219], v32 offset:21504
    v_mfma_f32_16x16x32_bf16 v[92:95], v[56:59], a[172:175], v[92:95]
    ds_read_b64_tr_b16 v[54:55], v14 offset:14336
    v_mfma_f32_16x16x32_bf16 v[92:95], v[60:63], a[188:191], v[92:95]
    ds_read_b128 a[220:223], v32 offset:23552
    s_waitcnt vmcnt(7) lgkmcnt(0)
    s_barrier
    v_mfma_f32_16x16x32_bf16 v[64:67], v[40:43], a[192:195], v[64:67]
    ds_read_b64_tr_b16 v[56:57], v12 offset:16384
    s_add_u32 m0, s47, 0
    v_mfma_f32_16x16x32_bf16 v[64:67], v[44:47], a[208:211], v[64:67]
    ds_read_b128 a[224:227], v32 offset:32768
    buffer_load_dwordx4 v10, s[28:31], s48 offen lds
    v_mfma_f32_16x16x32_bf16 v[68:71], v[40:43], a[196:199], v[68:71]
    ds_read_b64_tr_b16 v[58:59], v12 offset:18432
    buffer_load_dwordx4 v38, s[28:31], s48 offen offset:1024 lds
    s_add_u32 s48, s48, s49
    v_mfma_f32_16x16x32_bf16 v[68:71], v[44:47], a[212:215], v[68:71]
    ds_read_b128 a[228:231], v32 offset:34816
    s_add_u32 m0, s47, 8192
    v_mfma_f32_16x16x32_bf16 v[72:75], v[40:43], a[200:203], v[72:75]
    ds_read_b64_tr_b16 v[60:61], v12 offset:20480
    buffer_load_dwordx4 v10, s[28:31], s48 offen lds
    v_mfma_f32_16x16x32_bf16 v[72:75], v[44:47], a[216:219], v[72:75]
    ds_read_b128 a[232:235], v32 offset:36864
    buffer_load_dwordx4 v38, s[28:31], s48 offen offset:1024 lds
    s_add_u32 s48, s48, s49
    v_mfma_f32_16x16x32_bf16 v[76:79], v[40:43], a[204:207], v[76:79]
    ds_read_b64_tr_b16 v[62:63], v12 offset:22528
    s_add_u32 m0, s47, 16384
    v_mfma_f32_16x16x32_bf16 v[76:79], v[44:47], a[220:223], v[76:79]
    ds_read_b128 a[236:239], v32 offset:38912
    buffer_load_dwordx4 v10, s[28:31], s48 offen lds
    v_mfma_f32_16x16x32_bf16 v[80:83], v[48:51], a[192:195], v[80:83]
    ds_read_b64_tr_b16 v[40:41], v14 offset:16384
    buffer_load_dwordx4 v38, s[28:31], s48 offen offset:1024 lds
    s_add_u32 s48, s48, s49
    v_mfma_f32_16x16x32_bf16 v[80:83], v[52:55], a[208:211], v[80:83]
    ds_read_b128 a[240:243], v32 offset:33792
    v_mfma_f32_16x16x32_bf16 v[84:87], v[48:51], a[196:199], v[84:87]
    ds_read_b64_tr_b16 v[42:43], v14 offset:18432
    v_mfma_f32_16x16x32_bf16 v[84:87], v[52:55], a[212:215], v[84:87]
    ds_read_b128 a[244:247], v32 offset:35840
    v_mfma_f32_16x16x32_bf16 v[88:91], v[48:51], a[200:203], v[88:91]
    ds_read_b64_tr_b16 v[44:45], v14 offset:20480
    v_mfma_f32_16x16x32_bf16 v[88:91], v[52:55], a[216:219], v[88:91]
    ds_read_b128 a[248:251], v32 offset:37888
    v_mfma_f32_16x16x32_bf16 v[92:95], v[48:51], a[204:207], v[92:95]
    ds_read_b64_tr_b16 v[46:47], v14 offset:22528
    v_mfma_f32_16x16x32_bf16 v[92:95], v[52:55], a[220:223], v[92:95]
    ds_read_b128 a[252:255], v32 offset:39936
    s_waitcnt vmcnt(7) lgkmcnt(0)
    s_barrier
    v_mfma_f32_16x16x32_bf16 v[64:67], v[56:59], a[224:227], v[64:67]
    ds_read_b64_tr_b16 v[48:49], v12 offset:24576
    s_add_u32 m0, s47, 24576
    v_mfma_f32_16x16x32_bf16 v[64:67], v[60:63], a[240:243], v[64:67]
    ds_read_b128 v[160:163], v33 offset:0
    buffer_load_dwordx4 v10, s[28:31], s48 offen lds
    v_mfma_f32_16x16x32_bf16 v[68:71], v[56:59], a[228:231], v[68:71]
    ds_read_b64_tr_b16 v[50:51], v12 offset:26624
    buffer_load_dwordx4 v38, s[28:31], s48 offen offset:1024 lds
    s_add_u32 s48, s48, s49
    v_mfma_f32_16x16x32_bf16 v[68:71], v[60:63], a[244:247], v[68:71]
    ds_read_b128 v[164:167], v33 offset:2048
    s_add_u32 m0, s47, 32768
    v_mfma_f32_16x16x32_bf16 v[72:75], v[56:59], a[232:235], v[72:75]
    ds_read_b64_tr_b16 v[52:53], v12 offset:28672
    buffer_load_dwordx4 v10, s[28:31], s48 offen lds
    v_mfma_f32_16x16x32_bf16 v[72:75], v[60:63], a[248:251], v[72:75]
    ds_read_b128 v[168:171], v33 offset:4096
    buffer_load_dwordx4 v38, s[28:31], s48 offen offset:1024 lds
    s_add_u32 s48, s48, s49
    v_mfma_f32_16x16x32_bf16 v[76:79], v[56:59], a[236:239], v[76:79]
    ds_read_b64_tr_b16 v[54:55], v12 offset:30720
    v_mfma_f32_16x16x32_bf16 v[76:79], v[60:63], a[252:255], v[76:79]
    ds_read_b128 v[172:175], v33 offset:6144
    v_mfma_f32_16x16x32_bf16 v[80:83], v[40:43], a[224:227], v[80:83]
    ds_read_b64_tr_b16 v[56:57], v14 offset:24576
    v_mfma_f32_16x16x32_bf16 v[80:83], v[44:47], a[240:243], v[80:83]
    ds_read_b128 v[176:179], v33 offset:1024
    v_mfma_f32_16x16x32_bf16 v[84:87], v[40:43], a[228:231], v[84:87]
    ds_read_b64_tr_b16 v[58:59], v14 offset:26624
    v_mfma_f32_16x16x32_bf16 v[84:87], v[44:47], a[244:247], v[84:87]
    ds_read_b128 v[180:183], v33 offset:3072
    v_mfma_f32_16x16x32_bf16 v[88:91], v[40:43], a[232:235], v[88:91]
    ds_read_b64_tr_b16 v[60:61], v14 offset:28672
    v_mfma_f32_16x16x32_bf16 v[88:91], v[44:47], a[248:251], v[88:91]
    ds_read_b128 v[184:187], v33 offset:5120
    v_mfma_f32_16x16x32_bf16 v[92:95], v[40:43], a[236:239], v[92:95]
    ds_read_b64_tr_b16 v[62:63], v14 offset:30720
    v_mfma_f32_16x16x32_bf16 v[92:95], v[44:47], a[252:255], v[92:95]
    ds_read_b128 v[188:191], v33 offset:7168
    s_waitcnt vmcnt(6) lgkmcnt(0)
    s_barrier
    v_mfma_f32_16x16x32_bf16 v[64:67], v[48:51], v[160:163], v[64:67]
    ds_read_b64_tr_b16 v[40:41], v11 offset:0
    s_add_u32 m0, s47, 40960
    v_mfma_f32_16x16x32_bf16 v[64:67], v[52:55], v[176:179], v[64:67]
    buffer_load_dwordx4 v10, s[28:31], s48 offen lds
    v_mfma_f32_16x16x32_bf16 v[68:71], v[48:51], v[164:167], v[68:71]
    ds_read_b64_tr_b16 v[42:43], v11 offset:2048
    buffer_load_dwordx4 v38, s[28:31], s48 offen offset:1024 lds
    s_add_u32 s48, s48, s49
    v_mfma_f32_16x16x32_bf16 v[68:71], v[52:55], v[180:183], v[68:71]
    s_add_u32 m0, s47, 49152
    v_mfma_f32_16x16x32_bf16 v[72:75], v[48:51], v[168:171], v[72:75]
    ds_read_b64_tr_b16 v[44:45], v11 offset:4096
    buffer_load_dwordx4 v10, s[28:31], s48 offen lds
    v_mfma_f32_16x16x32_bf16 v[72:75], v[52:55], v[184:187], v[72:75]
    buffer_load_dwordx4 v38, s[28:31], s48 offen offset:1024 lds
    s_add_u32 s48, s48, s49
    v_mfma_f32_16x16x32_bf16 v[76:79], v[48:51], v[172:175], v[76:79]
    ds_read_b64_tr_b16 v[46:47], v11 offset:6144
    v_mfma_f32_16x16x32_bf16 v[76:79], v[52:55], v[188:191], v[76:79]
    v_mfma_f32_16x16x32_bf16 v[80:83], v[56:59], v[160:163], v[80:83]
    ds_read_b64_tr_b16 v[48:49], v13 offset:0
    v_mfma_f32_16x16x32_bf16 v[80:83], v[60:63], v[176:179], v[80:83]
    v_mfma_f32_16x16x32_bf16 v[84:87], v[56:59], v[164:167], v[84:87]
    ds_read_b64_tr_b16 v[50:51], v13 offset:2048
    v_mfma_f32_16x16x32_bf16 v[84:87], v[60:63], v[180:183], v[84:87]
    v_mfma_f32_16x16x32_bf16 v[88:91], v[56:59], v[168:171], v[88:91]
    ds_read_b64_tr_b16 v[52:53], v13 offset:4096
    v_mfma_f32_16x16x32_bf16 v[88:91], v[60:63], v[184:187], v[88:91]
    v_mfma_f32_16x16x32_bf16 v[92:95], v[56:59], v[172:175], v[92:95]
    ds_read_b64_tr_b16 v[54:55], v13 offset:6144
    v_mfma_f32_16x16x32_bf16 v[92:95], v[60:63], v[188:191], v[92:95]
    s_mov_b32 s56, 73728
    s_cmp_eq_u32 s51, 5
    s_cselect_b32 s75, 0xfffb8100, s56
K1_ULOOP:
    s_waitcnt lgkmcnt(4)
    v_mfma_f32_16x16x32_bf16 v[96:99], v[40:43], a[0:3], 0
    ds_read_b64_tr_b16 v[56:57], v11 offset:8192
    s_add_u32 m0, s47, 57344
    v_mfma_f32_16x16x32_bf16 v[96:99], v[44:47], a[16:19], v[96:99]
    buffer_load_dwordx4 v10, s[28:31], s48 offen lds
    v_mfma_f32_16x16x32_bf16 v[100:103], v[40:43], a[4:7], 0
    ds_read_b64_tr_b16 v[58:59], v11 offset:10240
    v_mfma_f32_16x16x32_bf16 v[100:103], v[44:47], a[20:23], v[100:103]
    v_mfma_f32_16x16x32_bf16 v[104:107], v[40:43], a[8:11], 0
    ds_read_b64_tr_b16 v[60:61], v11 offset:12288
    v_mfma_f32_16x16x32_bf16 v[104:107], v[44:47], a[24:27], v[104:107]
    buffer_load_dwordx4 v38, s[28:31], s48 offen offset:1024 lds
    s_add_u32 s48, s48, s49
    v_mfma_f32_16x16x32_bf16 v[108:111], v[40:43], a[12:15], 0
    ds_read_b64_tr_b16 v[62:63], v11 offset:14336
    v_readlane_b32 s69, v23, s66
    v_mfma_f32_16x16x32_bf16 v[108:111], v[44:47], a[28:31], v[108:111]
    v_readlane_b32 s70, v24, s66
    s_waitcnt lgkmcnt(4)
    v_mfma_f32_16x16x32_bf16 v[112:115], v[48:51], a[0:3], 0
    ds_read_b64_tr_b16 v[40:41], v13 offset:8192
    v_readlane_b32 s81, v25, s66
    v_mfma_f32_16x16x32_bf16 v[112:115], v[52:55], a[16:19], v[112:115]
    v_mul_f32 v128, s60, v64
    v_mul_f32 v129, s60, v65
    v_mfma_f32_16x16x32_bf16 v[116:119], v[48:51], a[4:7], 0
    ds_read_b64_tr_b16 v[42:43], v13 offset:10240
    v_mul_f32 v130, s60, v66
    v_mfma_f32_16x16x32_bf16 v[116:119], v[52:55], a[20:23], v[116:119]
    v_exp_f32 v128, v128
    v_mfma_f32_16x16x32_bf16 v[120:123], v[48:51], a[8:11], 0
    ds_read_b64_tr_b16 v[44:45], v13 offset:12288
    v_mul_f32 v131, s60, v67
    v_mfma_f32_16x16x32_bf16 v[120:123], v[52:55], a[24:27], v[120:123]
    v_exp_f32 v129, v129
    v_mfma_f32_16x16x32_bf16 v[124:127], v[48:51], a[12:15], 0
    ds_read_b64_tr_b16 v[46:47], v13 offset:14336
    v_add_f32 v128, 1.0, v128
    v_mfma_f32_16x16x32_bf16 v[124:127], v[52:55], a[28:31], v[124:127]
    s_waitcnt vmcnt(8) lgkmcnt(4)
    s_barrier
    v_mfma_f32_16x16x32_bf16 v[96:99], v[56:59], a[32:35], v[96:99]
    ds_read_b64_tr_b16 v[48:49], v11 offset:16384
    s_add_u32 m0, s47, 65536
    v_mfma_f32_16x16x32_bf16 v[96:99], v[60:63], a[48:51], v[96:99]
    buffer_load_dwordx4 v10, s[28:31], s48 offen lds
    v_add_f32 v129, 1.0, v129
    v_mfma_f32_16x16x32_bf16 v[100:103], v[56:59], a[36:39], v[100:103]
    ds_read_b64_tr_b16 v[50:51], v11 offset:18432
    v_mul_f32 v132, s60, v68
    v_mfma_f32_16x16x32_bf16 v[100:103], v[60:63], a[52:55], v[100:103]
    v_exp_f32 v130, v130
    v_mfma_f32_16x16x32_bf16 v[104:107], v[56:59], a[40:43], v[104:107]
    ds_read_b64_tr_b16 v[52:53], v11 offset:20480
    v_add_f32 v130, 1.0, v130
    v_mfma_f32_16x16x32_bf16 v[104:107], v[60:63], a[56:59], v[104:107]
    buffer_load_dwordx4 v38, s[28:31], s48 offen offset:1024 lds
    s_add_u32 s48, s48, s49
    v_readlane_b32 s28, v19, s66
    v_mfma_f32_16x16x32_bf16 v[108:111], v[56:59], a[44:47], v[108:111]
    ds_read_b64_tr_b16 v[54:55], v11 offset:22528
    v_readlane_b32 s29, v20, s66
    v_mfma_f32_16x16x32_bf16 v[108:111], v[60:63], a[60:63], v[108:111]
    v_readlane_b32 s30, v21, s66
    s_waitcnt lgkmcnt(4)
    v_mfma_f32_16x16x32_bf16 v[112:115], v[40:43], a[32:35], v[112:115]
    ds_read_b64_tr_b16 v[56:57], v13 offset:16384
    v_readlane_b32 s49, v22, s66
    v_mfma_f32_16x16x32_bf16 v[112:115], v[44:47], a[48:51], v[112:115]
    v_mad_u32_u24 v10, v26, s69, v28
    v_mad_u32_u24 v10, v27, s70, v10
    v_mfma_f32_16x16x32_bf16 v[116:119], v[40:43], a[36:39], v[116:119]
    ds_read_b64_tr_b16 v[58:59], v13 offset:18432
    s_mov_b32 s48, 0
    v_mfma_f32_16x16x32_bf16 v[116:119], v[44:47], a[52:55], v[116:119]
    v_add_u32 v38, s81, v10
    s_add_u32 s66, s66, 1
    v_mfma_f32_16x16x32_bf16 v[120:123], v[40:43], a[40:43], v[120:123]
    ds_read_b64_tr_b16 v[60:61], v13 offset:20480
    s_cmp_eq_u32 s70, 0
    s_cselect_b32 s84, s49, s53
    s_cselect_b32 s85, s49, s75
    v_mfma_f32_16x16x32_bf16 v[120:123], v[44:47], a[56:59], v[120:123]
    v_exp_f32 v131, v131
    v_mfma_f32_16x16x32_bf16 v[124:127], v[40:43], a[44:47], v[124:127]
    ds_read_b64_tr_b16 v[62:63], v13 offset:22528
    v_add_f32 v131, 1.0, v131
    v_mfma_f32_16x16x32_bf16 v[124:127], v[44:47], a[60:63], v[124:127]
    v_mul_f32 v133, s60, v69
    s_waitcnt lgkmcnt(4)
    v_mfma_f32_16x16x32_bf16 v[96:99], v[48:51], a[64:67], v[96:99]
    ds_read_b64_tr_b16 v[40:41], v11 offset:24576
    s_add_u32 m0, s47, 0
    v_mfma_f32_16x16x32_bf16 v[96:99], v[52:55], a[80:83], v[96:99]
    buffer_load_dwordx4 v10, s[28:31], s48 offen lds
    v_mul_f32 v134, s60, v70
    v_mfma_f32_16x16x32_bf16 v[100:103], v[48:51], a[68:71], v[100:103]
    ds_read_b64_tr_b16 v[42:43], v11 offset:26624
    v_mul_f32 v135, s60, v71
    v_mfma_f32_16x16x32_bf16 v[100:103], v[52:55], a[84:87], v[100:103]
    v_exp_f32 v132, v132
    v_mfma_f32_16x16x32_bf16 v[104:107], v[48:51], a[72:75], v[104:107]
    ds_read_b64_tr_b16 v[44:45], v11 offset:28672
    v_add_f32 v132, 1.0, v132
    v_mfma_f32_16x16x32_bf16 v[104:107], v[52:55], a[88:91], v[104:107]
    buffer_load_dwordx4 v38, s[28:31], s48 offen offset:1024 lds
    s_add_u32 s48, s48, s49
    v_mfma_f32_16x16x32_bf16 v[108:111], v[48:51], a[76:79], v[108:111]
    ds_read_b64_tr_b16 v[46:47], v11 offset:30720
    v_mul_f32 v136, s60, v72
    v_mfma_f32_16x16x32_bf16 v[108:111], v[52:55], a[92:95], v[108:111]
    v_mul_f32 v137, s60, v73
    s_waitcnt lgkmcnt(4)
    v_mfma_f32_16x16x32_bf16 v[112:115], v[56:59], a[64:67], v[112:115]
    ds_read_b64_tr_b16 v[48:49], v13 offset:24576
    v_mul_f32 v138, s60, v74
    v_mfma_f32_16x16x32_bf16 v[112:115], v[60:63], a[80:83], v[112:115]
    v_exp_f32 v133, v133
    v_mfma_f32_16x16x32_bf16 v[116:119], v[56:59], a[68:71], v[116:119]
    ds_read_b64_tr_b16 v[50:51], v13 offset:26624
    v_add_f32 v133, 1.0, v133
    v_mfma_f32_16x16x32_bf16 v[116:119], v[60:63], a[84:87], v[116:119]
    v_exp_f32 v134, v134
    v_mfma_f32_16x16x32_bf16 v[120:123], v[56:59], a[72:75], v[120:123]
    ds_read_b64_tr_b16 v[52:53], v13 offset:28672
    v_add_f32 v134, 1.0, v134
    v_mfma_f32_16x16x32_bf16 v[120:123], v[60:63], a[88:91], v[120:123]
    v_exp_f32 v135, v135
    v_mfma_f32_16x16x32_bf16 v[124:127], v[56:59], a[76:79], v[124:127]
    ds_read_b64_tr_b16 v[54:55], v13 offset:30720
    v_add_f32 v135, 1.0, v135
    v_mfma_f32_16x16x32_bf16 v[124:127], v[60:63], a[92:95], v[124:127]
    s_waitcnt vmcnt(8) lgkmcnt(4)
    s_barrier
    v_mfma_f32_16x16x32_bf16 v[96:99], v[40:43], a[96:99], v[96:99]
    ds_read_b64_tr_b16 v[56:57], v11 offset:32768
    s_add_u32 m0, s47, 8192
    v_mfma_f32_16x16x32_bf16 v[96:99], v[44:47], a[112:115], v[96:99]
    buffer_load_dwordx4 v10, s[28:31], s48 offen lds
    v_mul_f32 v139, s60, v75
    v_mfma_f32_16x16x32_bf16 v[100:103], v[40:43], a[100:103], v[100:103]
    ds_read_b64_tr_b16 v[58:59], v11 offset:34816
    v_mul_f32 v140, s60, v76
    v_mfma_f32_16x16x32_bf16 v[100:103], v[44:47], a[116:119], v[100:103]
    v_exp_f32 v136, v136
    v_mfma_f32_16x16x32_bf16 v[104:107], v[40:43], a[104:107], v[104:107]
    ds_read_b64_tr_b16 v[60:61], v11 offset:36864
    v_add_f32 v136, 1.0, v136
    v_mfma_f32_16x16x32_bf16 v[104:107], v[44:47], a[120:123], v[104:107]
    buffer_load_dwordx4 v38, s[28:31], s48 offen offset:1024 lds
    s_add_u32 s48, s48, s49
    v_mfma_f32_16x16x32_bf16 v[108:111], v[40:43], a[108:111], v[108:111]
    ds_read_b64_tr_b16 v[62:63], v11 offset:38912
    v_mul_f32 v141, s60, v77
    v_mfma_f32_16x16x32_bf16 v[108:111], v[44:47], a[124:127], v[108:111]
    v_mul_f32 v142, s60, v78
    s_waitcnt lgkmcnt(4)
    v_mfma_f32_16x16x32_bf16 v[112:115], v[48:51], a[96:99], v[112:115]
    ds_read_b64_tr_b16 v[40:41], v13 offset:32768
    v_mul_f32 v143, s60, v79
    v_mfma_f32_16x16x32_bf16 v[112:115], v[52:55], a[112:115], v[112:115]
    v_exp_f32 v137, v137
    v_mfma_f32_16x16x32_bf16 v[116:119], v[48:51], a[100:103], v[116:119]
    ds_read_b64_tr_b16 v[42:43], v13 offset:34816
    v_add_f32 v137, 1.0, v137
    v_mfma_f32_16x16x32_bf16 v[116:119], v[52:55], a[116:119], v[116:119]
    v_exp_f32 v138, v138
    v_mfma_f32_16x16x32_bf16 v[120:123], v[48:51], a[104:107], v[120:123]
    ds_read_b64_tr_b16 v[44:45], v13 offset:36864
    v_add_f32 v138, 1.0, v138
    v_mfma_f32_16x16x32_bf16 v[120:123], v[52:55], a[120:123], v[120:123]
    v_exp_f32 v139, v139
    v_mfma_f32_16x16x32_bf16 v[124:127], v[48:51], a[108:111], v[124:127]
    ds_read_b64_tr_b16 v[46:47], v13 offset:38912
    v_add_f32 v139, 1.0, v139
    v_mfma_f32_16x16x32_bf16 v[124:127], v[52:55], a[124:127], v[124:127]
    v_mul_f32 v144, s60, v80
    s_waitcnt lgkmcnt(4)
    v_mfma_f32_16x16x32_bf16 v[96:99], v[56:59], a[128:131], v[96:99]
    ds_read_b64_tr_b16 v[48:49], v12 offset:0
    s_add_u32 m0, s47, 16384
    v_mfma_f32_16x16x32_bf16 v[96:99], v[60:63], a[144:147], v[96:99]
    buffer_load_dwordx4 v10, s[28:31], s48 offen lds
    v_mul_f32 v145, s60, v81
    v_mfma_f32_16x16x32_bf16 v[100:103], v[56:59], a[132:135], v[100:103]
    ds_read_b64_tr_b16 v[50:51], v12 offset:2048
    v_mul_f32 v146, s60, v82
    v_mfma_f32_16x16x32_bf16 v[100:103], v[60:63], a[148:151], v[100:103]
    v_exp_f32 v140, v140
    v_mfma_f32_16x16x32_bf16 v[104:107], v[56:59], a[136:139], v[104:107]
    ds_read_b64_tr_b16 v[52:53], v12 offset:4096
    v_add_f32 v140, 1.0, v140
    v_mfma_f32_16x16x32_bf16 v[104:107], v[60:63], a[152:155], v[104:107]
    buffer_load_dwordx4 v38, s[28:31], s48 offen offset:1024 lds
    s_add_u32 s48, s48, s49
    v_mfma_f32_16x16x32_bf16 v[108:111], v[56:59], a[140:143], v[108:111]
    ds_read_b64_tr_b16 v[54:55], v12 offset:6144
    v_mul_f32 v147, s60, v83
    v_mfma_f32_16x16x32_bf16 v[108:111], v[60:63], a[156:159], v[108:111]
    v_mul_f32 v148, s60, v84
    s_waitcnt lgkmcnt(4)
    v_mfma_f32_16x16x32_bf16 v[112:115], v[40:43], a[128:131], v[112:115]
    ds_read_b64_tr_b16 v[56:57], v14 offset:0
    v_mul_f32 v149, s60, v85
    v_mfma_f32_16x16x32_bf16 v[112:115], v[44:47], a[144:147], v[112:115]
    v_exp_f32 v141, v141
    v_mfma_f32_16x16x32_bf16 v[116:119], v[40:43], a[132:135], v[116:119]
    ds_read_b64_tr_b16 v[58:59], v14 offset:2048
    v_add_f32 v141, 1.0, v141
    v_mfma_f32_16x16x32_bf16 v[116:119], v[44:47], a[148:151], v[116:119]
    v_exp_f32 v142, v142
    v_mfma_f32_16x16x32_bf16 v[120:123], v[40:43], a[136:139], v[120:123]
    ds_read_b64_tr_b16 v[60:61], v14 offset:4096
    v_add_f32 v142, 1.0, v142
    v_mfma_f32_16x16x32_bf16 v[120:123], v[44:47], a[152:155], v[120:123]
    v_exp_f32 v143, v143
    v_mfma_f32_16x16x32_bf16 v[124:127], v[40:43], a[140:143], v[124:127]
    ds_read_b64_tr_b16 v[62:63], v14 offset:6144
    v_add_f32 v143, 1.0, v143
    v_mfma_f32_16x16x32_bf16 v[124:127], v[44:47], a[156:159], v[124:127]
    s_waitcnt vmcnt(8) lgkmcnt(4)
    s_barrier
    v_mfma_f32_16x16x32_bf16 v[96:99], v[48:51], a[160:163], v[96:99]
    ds_read_b64_tr_b16 v[40:41], v12 offset:8192
    s_add_u32 m0, s47, 24576
    v_mfma_f32_16x16x32_bf16 v[96:99], v[52:55], a[176:179], v[96:99]
    buffer_load_dwordx4 v10, s[28:31], s48 offen lds
    v_mul_f32 v150, s60, v86
    v_mfma_f32_16x16x32_bf16 v[100:103], v[48:51], a[164:167], v[100:103]
    ds_read_b64_tr_b16 v[42:43], v12 offset:10240
    v_mul_f32 v151, s60, v87
    v_mfma_f32_16x16x32_bf16 v[100:103], v[52:55], a[180:183], v[100:103]
    v_exp_f32 v144, v144
    v_mfma_f32_16x16x32_bf16 v[104:107], v[48:51], a[168:171], v[104:107]
    ds_read_b64_tr_b16 v[44:45], v12 offset:12288
    v_add_f32 v144, 1.0, v144
    v_mfma_f32_16x16x32_bf16 v[104:107], v[52:55], a[184:187], v[104:107]
    buffer_load_dwordx4 v38, s[28:31], s48 offen offset:1024 lds
    s_add_u32 s48, s48, s84
    v_mfma_f32_16x16x32_bf16 v[108:111], v[48:51], a[172:175], v[108:111]
    ds_read_b64_tr_b16 v[46:47], v12 offset:14336
    v_readlane_b32 s71, v23, s80
    v_mfma_f32_16x16x32_bf16 v[108:111], v[52:55], a[188:191], v[108:111]
    v_readlane_b32 s32, v19, s80
    s_waitcnt lgkmcnt(4)
    v_mfma_f32_16x16x32_bf16 v[112:115], v[56:59], a[160:163], v[112:115]
    ds_read_b64_tr_b16 v[48:49], v14 offset:8192
    v_readlane_b32 s33, v20, s80
    v_mfma_f32_16x16x32_bf16 v[112:115], v[60:63], a[176:179], v[112:115]
    v_readlane_b32 s34, v21, s80
    v_mul_u32_u24 v30, s71, v29
    v_mfma_f32_16x16x32_bf16 v[116:119], v[56:59], a[164:167], v[116:119]
    ds_read_b64_tr_b16 v[50:51], v14 offset:10240
    s_cmp_eq_u32 s71, 0
    s_cselect_b32 s71, 1, 0
    v_mfma_f32_16x16x32_bf16 v[116:119], v[60:63], a[180:183], v[116:119]
    s_add_u32 s80, s80, 1
    v_mad_u32_u24 v30, v8, s71, v30
    v_mfma_f32_16x16x32_bf16 v[120:123], v[56:59], a[168:171], v[120:123]
    ds_read_b64_tr_b16 v[52:53], v14 offset:12288
    v_exp_f32 v145, v145
    v_mfma_f32_16x16x32_bf16 v[120:123], v[60:63], a[184:187], v[120:123]
    v_exp_f32 v146, v146
    v_mfma_f32_16x16x32_bf16 v[124:127], v[56:59], a[172:175], v[124:127]
    ds_read_b64_tr_b16 v[54:55], v14 offset:14336
    v_add_f32 v145, 1.0, v145
    v_mfma_f32_16x16x32_bf16 v[124:127], v[60:63], a[188:191], v[124:127]
    v_add_f32 v146, 1.0, v146
    s_waitcnt lgkmcnt(4)
    v_mfma_f32_16x16x32_bf16 v[96:99], v[40:43], a[192:195], v[96:99]
    ds_read_b64_tr_b16 v[56:57], v12 offset:16384
    buffer_load_dword v31, v30, s[32:35], 0 offen
    v_mfma_f32_16x16x32_bf16 v[96:99], v[44:47], a[208:211], v[96:99]
    v_readlane_b32 s71, v23, s80
    v_readlane_b32 s32, v19, s80
    v_mfma_f32_16x16x32_bf16 v[100:103], v[40:43], a[196:199], v[100:103]
    ds_read_b64_tr_b16 v[58:59], v12 offset:18432
    v_readlane_b32 s33, v20, s80
    v_readlane_b32 s34, v21, s80
    v_mfma_f32_16x16x32_bf16 v[100:103], v[44:47], a[212:215], v[100:103]
    v_mul_u32_u24 v30, s71, v29
    s_cmp_eq_u32 s71, 0
    s_cselect_b32 s71, 1, 0
    v_mfma_f32_16x16x32_bf16 v[104:107], v[40:43], a[200:203], v[104:107]
    ds_read_b64_tr_b16 v[60:61], v12 offset:20480
    s_add_u32 s80, s80, 1
    v_mad_u32_u24 v30, v8, s71, v30
    v_mfma_f32_16x16x32_bf16 v[104:107], v[44:47], a[216:219], v[104:107]
    s_nop 1
    buffer_load_dword v31, v30, s[32:35], 0 offen
    s_add_u32 m0, s47, 32768
    v_mfma_f32_16x16x32_bf16 v[108:111], v[40:43], a[204:207], v[108:111]
    ds_read_b64_tr_b16 v[62:63], v12 offset:22528
    v_exp_f32 v147, v147
    v_mfma_f32_16x16x32_bf16 v[108:111], v[44:47], a[220:223], v[108:111]
    v_exp_f32 v148, v148
    s_waitcnt lgkmcnt(4)
    v_mfma_f32_16x16x32_bf16 v[112:115], v[48:51], a[192:195], v[112:115]
    ds_read_b64_tr_b16 v[40:41], v14 offset:16384
    v_exp_f32 v149, v149
    v_mfma_f32_16x16x32_bf16 v[112:115], v[52:55], a[208:211], v[112:115]
    buffer_load_dwordx4 v10, s[28:31], s48 offen lds
    v_exp_f32 v150, v150
    v_mfma_f32_16x16x32_bf16 v[116:119], v[48:51], a[196:199], v[116:119]
    ds_read_b64_tr_b16 v[42:43], v14 offset:18432
    v_exp_f32 v151, v151
    v_mfma_f32_16x16x32_bf16 v[116:119], v[52:55], a[212:215], v[116:119]
    v_add_f32 v147, 1.0, v147
    v_add_f32 v148, 1.0, v148
    v_mfma_f32_16x16x32_bf16 v[120:123], v[48:51], a[200:203], v[120:123]
    ds_read_b64_tr_b16 v[44:45], v14 offset:20480
    v_add_f32 v149, 1.0, v149
    v_mfma_f32_16x16x32_bf16 v[120:123], v[52:55], a[216:219], v[120:123]
    buffer_load_dwordx4 v38, s[28:31], s48 offen offset:1024 lds
    s_add_u32 s48, s48, s85
    v_mfma_f32_16x16x32_bf16 v[124:127], v[48:51], a[204:207], v[124:127]
    ds_read_b64_tr_b16 v[46:47], v14 offset:22528
    v_add_f32 v150, 1.0, v150
    v_mfma_f32_16x16x32_bf16 v[124:127], v[52:55], a[220:223], v[124:127]
    s_waitcnt vmcnt(12) lgkmcnt(4)
    s_barrier
    v_mfma_f32_16x16x32_bf16 v[96:99], v[56:59], a[224:227], v[96:99]
    ds_read_b64_tr_b16 v[48:49], v12 offset:24576
    s_add_u32 m0, s47, 40960
    v_add_f32 v151, 1.0, v151
    v_mfma_f32_16x16x32_bf16 v[96:99], v[60:63], a[240:243], v[96:99]
    buffer_load_dwordx4 v10, s[28:31], s48 offen lds
    v_mul_f32 v152, s60, v88
    v_mul_f32 v153, s60, v89
    v_mfma_f32_16x16x32_bf16 v[100:103], v[56:59], a[228:231], v[100:103]
    ds_read_b64_tr_b16 v[50:51], v12 offset:26624
    v_mul_f32 v154, s60, v90
    v_mfma_f32_16x16x32_bf16 v[100:103], v[60:63], a[244:247], v[100:103]
    v_exp_f32 v152, v152
    v_mfma_f32_16x16x32_bf16 v[104:107], v[56:59], a[232:235], v[104:107]
    ds_read_b64_tr_b16 v[52:53], v12 offset:28672
    v_mul_f32 v155, s60, v91
    v_mfma_f32_16x16x32_bf16 v[104:107], v[60:63], a[248:251], v[104:107]
    buffer_load_dwordx4 v38, s[28:31], s48 offen offset:1024 lds
    s_add_u32 s48, s48, s49
    v_mfma_f32_16x16x32_bf16 v[108:111], v[56:59], a[236:239], v[108:111]
    ds_read_b64_tr_b16 v[54:55], v12 offset:30720
    v_add_f32 v152, 1.0, v152
    v_mfma_f32_16x16x32_bf16 v[108:111], v[60:63], a[252:255], v[108:111]
    v_mul_f32 v156, s60, v92
    s_waitcnt lgkmcnt(4)
    v_mfma_f32_16x16x32_bf16 v[112:115], v[40:43], a[224:227], v[112:115]
    ds_read_b64_tr_b16 v[56:57], v14 offset:24576
    v_mul_f32 v157, s60, v93
    v_mfma_f32_16x16x32_bf16 v[112:115], v[44:47], a[240:243], v[112:115]
    v_exp_f32 v153, v153
    v_mfma_f32_16x16x32_bf16 v[116:119], v[40:43], a[228:231], v[116:119]
    ds_read_b64_tr_b16 v[58:59], v14 offset:26624
    v_add_f32 v153, 1.0, v153
    v_mfma_f32_16x16x32_bf16 v[116:119], v[44:47], a[244:247], v[116:119]
    v_exp_f32 v154, v154
    v_mfma_f32_16x16x32_bf16 v[120:123], v[40:43], a[232:235], v[120:123]
    ds_read_b64_tr_b16 v[60:61], v14 offset:28672
    v_add_f32 v154, 1.0, v154
    v_mfma_f32_16x16x32_bf16 v[120:123], v[44:47], a[248:251], v[120:123]
    v_exp_f32 v155, v155
    v_mfma_f32_16x16x32_bf16 v[124:127], v[40:43], a[236:239], v[124:127]
    ds_read_b64_tr_b16 v[62:63], v14 offset:30720
    v_add_f32 v155, 1.0, v155
    v_mfma_f32_16x16x32_bf16 v[124:127], v[44:47], a[252:255], v[124:127]
    s_waitcnt vmcnt(10) lgkmcnt(4)
    s_barrier
    v_mfma_f32_16x16x32_bf16 v[96:99], v[48:51], v[160:163], v[96:99]
    ds_read_b64_tr_b16 v[40:41], v11 offset:0
    s_add_u32 m0, s47, 49152
    v_mfma_f32_16x16x32_bf16 v[96:99], v[52:55], v[176:179], v[96:99]
    buffer_load_dwordx4 v10, s[28:31], s48 offen lds
    v_mul_f32 v158, s60, v94
    v_mfma_f32_16x16x32_bf16 v[100:103], v[48:51], v[164:167], v[100:103]
    ds_read_b64_tr_b16 v[42:43], v11 offset:2048
    v_mul_f32 v159, s60, v95
    v_mfma_f32_16x16x32_bf16 v[100:103], v[52:55], v[180:183], v[100:103]
    v_exp_f32 v156, v156
    v_mfma_f32_16x16x32_bf16 v[104:107], v[48:51], v[168:171], v[104:107]
    ds_read_b64_tr_b16 v[44:45], v11 offset:4096
    v_add_f32 v156, 1.0, v156
    v_mfma_f32_16x16x32_bf16 v[104:107], v[52:55], v[184:187], v[104:107]
    buffer_load_dwordx4 v38, s[28:31], s48 offen offset:1024 lds
    s_add_u32 s48, s48, s49
    v_mfma_f32_16x16x32_bf16 v[108:111], v[48:51], v[172:175], v[108:111]
    ds_read_b64_tr_b16 v[46:47], v11 offset:6144
    v_mfma_f32_16x16x32_bf16 v[108:111], v[52:55], v[188:191], v[108:111]
    s_waitcnt lgkmcnt(4)
    v_mfma_f32_16x16x32_bf16 v[112:115], v[56:59], v[160:163], v[112:115]
    ds_read_b64_tr_b16 v[48:49], v13 offset:0
    v_exp_f32 v157, v157
    v_mfma_f32_16x16x32_bf16 v[112:115], v[60:63], v[176:179], v[112:115]
    v_exp_f32 v158, v158
    v_mfma_f32_16x16x32_bf16 v[116:119], v[56:59], v[164:167], v[116:119]
    ds_read_b64_tr_b16 v[50:51], v13 offset:2048
    v_add_f32 v157, 1.0, v157
    v_mfma_f32_16x16x32_bf16 v[116:119], v[60:63], v[180:183], v[116:119]
    v_exp_f32 v159, v159
    v_mfma_f32_16x16x32_bf16 v[120:123], v[56:59], v[168:171], v[120:123]
    ds_read_b64_tr_b16 v[52:53], v13 offset:4096
    v_add_f32 v158, 1.0, v158
    v_mfma_f32_16x16x32_bf16 v[120:123], v[60:63], v[184:187], v[120:123]
    v_add_f32 v159, 1.0, v159
    v_mfma_f32_16x16x32_bf16 v[124:127], v[56:59], v[172:175], v[124:127]
    ds_read_b64_tr_b16 v[54:55], v13 offset:6144
    v_mfma_f32_16x16x32_bf16 v[124:127], v[60:63], v[188:191], v[124:127]
    s_sub_u32 s52, s52, 1
    s_cmp_eq_u32 s52, 0
    s_cbranch_scc1 K1_DSTART
    s_cmp_eq_u32 s50, 0
    s_cbranch_scc1 K1_G
    s_mov_b32 s38, 0
K1_QLOOP:
    s_waitcnt lgkmcnt(4)
    v_mfma_f32_16x16x32_bf16 v[64:67], a[0:3], v[40:43], 0
    ds_read_b64_tr_b16 v[56:57], v11 offset:8192
    s_add_u32 m0, s47, 57344
    v_mfma_f32_16x16x32_bf16 v[64:67], a[16:19], v[44:47], v[64:67]
    buffer_load_dwordx4 v10, s[28:31], s48 offen lds
    v_mfma_f32_16x16x32_bf16 v[68:71], a[4:7], v[40:43], 0
    ds_read_b64_tr_b16 v[58:59], v11 offset:10240
    v_mfma_f32_16x16x32_bf16 v[68:71], a[20:23], v[44:47], v[68:71]
    v_mfma_f32_16x16x32_bf16 v[72:75], a[8:11], v[40:43], 0
    ds_read_b64_tr_b16 v[60:61], v11 offset:12288
    v_mfma_f32_16x16x32_bf16 v[72:75], a[24:27], v[44:47], v[72:75]
    buffer_load_dwordx4 v38, s[28:31], s48 offen offset:1024 lds
    s_add_u32 s48, s48, s49
    v_mfma_f32_16x16x32_bf16 v[76:79], a[12:15], v[40:43], 0
    ds_read_b64_tr_b16 v[62:63], v11 offset:14336
    v_readlane_b32 s69, v23, s66
    v_mfma_f32_16x16x32_bf16 v[76:79], a[28:31], v[44:47], v[76:79]
    v_readlane_b32 s70, v24, s66
    s_waitcnt lgkmcnt(4)
    v_mfma_f32_16x16x32_bf16 v[80:83], a[0:3], v[48:51], 0
    ds_read_b64_tr_b16 v[40:41], v13 offset:8192
    v_readlane_b32 s81, v25, s66
    v_mfma_f32_16x16x32_bf16 v[80:83], a[16:19], v[52:55], v[80:83]
    v_mfma_f32_16x16x32_bf16 v[84:87], a[4:7], v[48:51], 0
    ds_read_b64_tr_b16 v[42:43], v13 offset:10240
    v_mfma_f32_16x16x32_bf16 v[84:87], a[20:23], v[52:55], v[84:87]
    v_mfma_f32_16x16x32_bf16 v[88:91], a[8:11], v[48:51], 0
    ds_read_b64_tr_b16 v[44:45], v13 offset:12288
    v_mfma_f32_16x16x32_bf16 v[88:91], a[24:27], v[52:55], v[88:91]
    buffer_store_dwordx4 v[192:195], v17, s[36:39], s63 offen offset:0 sc1
    v_mfma_f32_16x16x32_bf16 v[92:95], a[12:15], v[48:51], 0
    ds_read_b64_tr_b16 v[46:47], v13 offset:14336
    v_mfma_f32_16x16x32_bf16 v[92:95], a[28:31], v[52:55], v[92:95]
    s_waitcnt vmcnt(9) lgkmcnt(4)
    s_barrier
    v_mfma_f32_16x16x32_bf16 v[64:67], a[32:35], v[56:59], v[64:67]
    ds_read_b64_tr_b16 v[48:49], v11 offset:16384
    s_add_u32 m0, s47, 65536
    v_mfma_f32_16x16x32_bf16 v[64:67], a[48:51], v[60:63], v[64:67]
    buffer_load_dwordx4 v10, s[28:31], s48 offen lds
    v_mfma_f32_16x16x32_bf16 v[68:71], a[36:39], v[56:59], v[68:71]
    ds_read_b64_tr_b16 v[50:51], v11 offset:18432
    v_mfma_f32_16x16x32_bf16 v[68:71], a[52:55], v[60:63], v[68:71]
    v_mfma_f32_16x16x32_bf16 v[72:75], a[40:43], v[56:59], v[72:75]
    ds_read_b64_tr_b16 v[52:53], v11 offset:20480
    v_mfma_f32_16x16x32_bf16 v[72:75], a[56:59], v[60:63], v[72:75]
    buffer_load_dwordx4 v38, s[28:31], s48 offen offset:1024 lds
    s_add_u32 s48, s48, s49
    v_mfma_f32_16x16x32_bf16 v[76:79], a[44:47], v[56:59], v[76:79]
    ds_read_b64_tr_b16 v[54:55], v11 offset:22528
    v_readlane_b32 s28, v19, s66
    v_mfma_f32_16x16x32_bf16 v[76:79], a[60:63], v[60:63], v[76:79]
    v_readlane_b32 s29, v20, s66
    s_waitcnt lgkmcnt(4)
    v_mfma_f32_16x16x32_bf16 v[80:83], a[32:35], v[40:43], v[80:83]
    ds_read_b64_tr_b16 v[56:57], v13 offset:16384
    v_readlane_b32 s30, v21, s66
    v_mfma_f32_16x16x32_bf16 v[80:83], a[48:51], v[44:47], v[80:83]
    v_readlane_b32 s49, v22, s66
    v_mad_u32_u24 v10, v26, s69, v28
    v_mfma_f32_16x16x32_bf16 v[84:87], a[36:39], v[40:43], v[84:87]
    ds_read_b64_tr_b16 v[58:59], v13 offset:18432
    v_mad_u32_u24 v10, v27, s70, v10
    v_mfma_f32_16x16x32_bf16 v[84:87], a[52:55], v[44:47], v[84:87]
    s_mov_b32 s48, 0
    v_add_u32 v38, s81, v10
    v_mfma_f32_16x16x32_bf16 v[88:91], a[40:43], v[40:43], v[88:91]
    ds_read_b64_tr_b16 v[60:61], v13 offset:20480
    s_add_u32 s66, s66, 1
    v_mfma_f32_16x16x32_bf16 v[88:91], a[56:59], v[44:47], v[88:91]
    v_mfma_f32_16x16x32_bf16 v[92:95], a[44:47], v[40:43], v[92:95]
    ds_read_b64_tr_b16 v[62:63], v13 offset:22528
    v_mfma_f32_16x16x32_bf16 v[92:95], a[60:63], v[44:47], v[92:95]
    s_waitcnt lgkmcnt(4)
    v_mfma_f32_16x16x32_bf16 v[64:67], a[64:67], v[48:51], v[64:67]
    ds_read_b64_tr_b16 v[40:41], v11 offset:24576
    s_add_u32 m0, s47, 0
    v_mfma_f32_16x16x32_bf16 v[64:67], a[80:83], v[52:55], v[64:67]
    buffer_load_dwordx4 v10, s[28:31], s48 offen lds
    v_mfma_f32_16x16x32_bf16 v[68:71], a[68:71], v[48:51], v[68:71]
    ds_read_b64_tr_b16 v[42:43], v11 offset:26624
    v_mfma_f32_16x16x32_bf16 v[68:71], a[84:87], v[52:55], v[68:71]
    v_mfma_f32_16x16x32_bf16 v[72:75], a[72:75], v[48:51], v[72:75]
    ds_read_b64_tr_b16 v[44:45], v11 offset:28672
    v_mfma_f32_16x16x32_bf16 v[72:75], a[88:91], v[52:55], v[72:75]
    buffer_load_dwordx4 v38, s[28:31], s48 offen offset:1024 lds
    s_add_u32 s48, s48, s49
    v_mfma_f32_16x16x32_bf16 v[76:79], a[76:79], v[48:51], v[76:79]
    ds_read_b64_tr_b16 v[46:47], v11 offset:30720
    v_mfma_f32_16x16x32_bf16 v[76:79], a[92:95], v[52:55], v[76:79]
    s_waitcnt lgkmcnt(4)
    v_mfma_f32_16x16x32_bf16 v[80:83], a[64:67], v[56:59], v[80:83]
    ds_read_b64_tr_b16 v[48:49], v13 offset:24576
    v_mfma_f32_16x16x32_bf16 v[80:83], a[80:83], v[60:63], v[80:83]
    v_mfma_f32_16x16x32_bf16 v[84:87], a[68:71], v[56:59], v[84:87]
    ds_read_b64_tr_b16 v[50:51], v13 offset:26624
    v_mfma_f32_16x16x32_bf16 v[84:87], a[84:87], v[60:63], v[84:87]
    v_mfma_f32_16x16x32_bf16 v[88:91], a[72:75], v[56:59], v[88:91]
    ds_read_b64_tr_b16 v[52:53], v13 offset:28672
    v_mfma_f32_16x16x32_bf16 v[88:91], a[88:91], v[60:63], v[88:91]
    buffer_store_dwordx4 v[196:199], v17, s[36:39], s61 offen offset:0 sc1
    v_mfma_f32_16x16x32_bf16 v[92:95], a[76:79], v[56:59], v[92:95]
    ds_read_b64_tr_b16 v[54:55], v13 offset:30720
    v_mfma_f32_16x16x32_bf16 v[92:95], a[92:95], v[60:63], v[92:95]
    s_waitcnt vmcnt(10) lgkmcnt(4)
    s_barrier
    v_mfma_f32_16x16x32_bf16 v[64:67], a[96:99], v[40:43], v[64:67]
    ds_read_b64_tr_b16 v[56:57], v11 offset:32768
    s_add_u32 m0, s47, 8192
    v_mfma_f32_16x16x32_bf16 v[64:67], a[112:115], v[44:47], v[64:67]
    buffer_load_dwordx4 v10, s[28:31], s48 offen lds
    v_mfma_f32_16x16x32_bf16 v[68:71], a[100:103], v[40:43], v[68:71]
    ds_read_b64_tr_b16 v[58:59], v11 offset:34816
    v_mfma_f32_16x16x32_bf16 v[68:71], a[116:119], v[44:47], v[68:71]
    v_mfma_f32_16x16x32_bf16 v[72:75], a[104:107], v[40:43], v[72:75]
    ds_read_b64_tr_b16 v[60:61], v11 offset:36864
    v_mfma_f32_16x16x32_bf16 v[72:75], a[120:123], v[44:47], v[72:75]
    buffer_load_dwordx4 v38, s[28:31], s48 offen offset:1024 lds
    s_add_u32 s48, s48, s49
    v_mfma_f32_16x16x32_bf16 v[76:79], a[108:111], v[40:43], v[76:79]
    ds_read_b64_tr_b16 v[62:63], v11 offset:38912
    v_mfma_f32_16x16x32_bf16 v[76:79], a[124:127], v[44:47], v[76:79]
    s_waitcnt lgkmcnt(4)
    v_mfma_f32_16x16x32_bf16 v[80:83], a[96:99], v[48:51], v[80:83]
    ds_read_b64_tr_b16 v[40:41], v13 offset:32768
    v_mfma_f32_16x16x32_bf16 v[80:83], a[112:115], v[52:55], v[80:83]
    v_mfma_f32_16x16x32_bf16 v[84:87], a[100:103], v[48:51], v[84:87]
    ds_read_b64_tr_b16 v[42:43], v13 offset:34816
    v_mfma_f32_16x16x32_bf16 v[84:87], a[116:119], v[52:55], v[84:87]
    v_mfma_f32_16x16x32_bf16 v[88:91], a[104:107], v[48:51], v[88:91]
    ds_read_b64_tr_b16 v[44:45], v13 offset:36864
    v_mfma_f32_16x16x32_bf16 v[88:91], a[120:123], v[52:55], v[88:91]
    v_mfma_f32_16x16x32_bf16 v[92:95], a[108:111], v[48:51], v[92:95]
    ds_read_b64_tr_b16 v[46:47], v13 offset:38912
    v_mfma_f32_16x16x32_bf16 v[92:95], a[124:127], v[52:55], v[92:95]
    s_waitcnt lgkmcnt(4)
    v_mfma_f32_16x16x32_bf16 v[64:67], a[128:131], v[56:59], v[64:67]
    ds_read_b64_tr_b16 v[48:49], v12 offset:0
    s_add_u32 m0, s47, 16384
    v_mfma_f32_16x16x32_bf16 v[64:67], a[144:147], v[60:63], v[64:67]
    buffer_load_dwordx4 v10, s[28:31], s48 offen lds
    v_mfma_f32_16x16x32_bf16 v[68:71], a[132:135], v[56:59], v[68:71]
    ds_read_b64_tr_b16 v[50:51], v12 offset:2048
    v_mfma_f32_16x16x32_bf16 v[68:71], a[148:151], v[60:63], v[68:71]
    v_mfma_f32_16x16x32_bf16 v[72:75], a[136:139], v[56:59], v[72:75]
    ds_read_b64_tr_b16 v[52:53], v12 offset:4096
    v_mfma_f32_16x16x32_bf16 v[72:75], a[152:155], v[60:63], v[72:75]
    buffer_load_dwordx4 v38, s[28:31], s48 offen offset:1024 lds
    s_add_u32 s48, s48, s49
    v_mfma_f32_16x16x32_bf16 v[76:79], a[140:143], v[56:59], v[76:79]
    ds_read_b64_tr_b16 v[54:55], v12 offset:6144
    v_mfma_f32_16x16x32_bf16 v[76:79], a[156:159], v[60:63], v[76:79]
    s_waitcnt lgkmcnt(4)
    v_mfma_f32_16x16x32_bf16 v[80:83], a[128:131], v[40:43], v[80:83]
    ds_read_b64_tr_b16 v[56:57], v14 offset:0
    v_mfma_f32_16x16x32_bf16 v[80:83], a[144:147], v[44:47], v[80:83]
    v_mfma_f32_16x16x32_bf16 v[84:87], a[132:135], v[40:43], v[84:87]
    ds_read_b64_tr_b16 v[58:59], v14 offset:2048
    v_mfma_f32_16x16x32_bf16 v[84:87], a[148:151], v[44:47], v[84:87]
    v_mfma_f32_16x16x32_bf16 v[88:91], a[136:139], v[40:43], v[88:91]
    ds_read_b64_tr_b16 v[60:61], v14 offset:4096
    v_mfma_f32_16x16x32_bf16 v[88:91], a[152:155], v[44:47], v[88:91]
    buffer_store_dwordx4 v[200:203], v17, s[36:39], s63 offen offset:1024 sc1
    v_mfma_f32_16x16x32_bf16 v[92:95], a[140:143], v[40:43], v[92:95]
    ds_read_b64_tr_b16 v[62:63], v14 offset:6144
    v_mfma_f32_16x16x32_bf16 v[92:95], a[156:159], v[44:47], v[92:95]
    s_waitcnt vmcnt(11) lgkmcnt(4)
    s_barrier
    v_mfma_f32_16x16x32_bf16 v[64:67], a[160:163], v[48:51], v[64:67]
    ds_read_b64_tr_b16 v[40:41], v12 offset:8192
    s_add_u32 m0, s47, 24576
    v_mfma_f32_16x16x32_bf16 v[64:67], a[176:179], v[52:55], v[64:67]
    buffer_load_dwordx4 v10, s[28:31], s48 offen lds
    v_mfma_f32_16x16x32_bf16 v[68:71], a[164:167], v[48:51], v[68:71]
    ds_read_b64_tr_b16 v[42:43], v12 offset:10240
    v_mfma_f32_16x16x32_bf16 v[68:71], a[180:183], v[52:55], v[68:71]
    v_mfma_f32_16x16x32_bf16 v[72:75], a[168:171], v[48:51], v[72:75]
    ds_read_b64_tr_b16 v[44:45], v12 offset:12288
    v_mfma_f32_16x16x32_bf16 v[72:75], a[184:187], v[52:55], v[72:75]
    buffer_load_dwordx4 v38, s[28:31], s48 offen offset:1024 lds
    s_add_u32 s48, s48, s49
    v_mfma_f32_16x16x32_bf16 v[76:79], a[172:175], v[48:51], v[76:79]
    ds_read_b64_tr_b16 v[46:47], v12 offset:14336
    v_readlane_b32 s71, v23, s80
    v_mfma_f32_16x16x32_bf16 v[76:79], a[188:191], v[52:55], v[76:79]
    v_readlane_b32 s32, v19, s80
    s_waitcnt lgkmcnt(4)
    v_mfma_f32_16x16x32_bf16 v[80:83], a[160:163], v[56:59], v[80:83]
    ds_read_b64_tr_b16 v[48:49], v14 offset:8192
    v_readlane_b32 s33, v20, s80
    v_mfma_f32_16x16x32_bf16 v[80:83], a[176:179], v[60:63], v[80:83]
    v_readlane_b32 s34, v21, s80
    v_mul_u32_u24 v30, s71, v29
    v_mfma_f32_16x16x32_bf16 v[84:87], a[164:167], v[56:59], v[84:87]
    ds_read_b64_tr_b16 v[50:51], v14 offset:10240
    s_cmp_eq_u32 s71, 0
    s_cselect_b32 s71, 1, 0
    v_mfma_f32_16x16x32_bf16 v[84:87], a[180:183], v[60:63], v[84:87]
    s_add_u32 s80, s80, 1
    v_mad_u32_u24 v30, v8, s71, v30
    v_mfma_f32_16x16x32_bf16 v[88:91], a[168:171], v[56:59], v[88:91]
    ds_read_b64_tr_b16 v[52:53], v14 offset:12288
    v_mfma_f32_16x16x32_bf16 v[88:91], a[184:187], v[60:63], v[88:91]
    v_mfma_f32_16x16x32_bf16 v[92:95], a[172:175], v[56:59], v[92:95]
    ds_read_b64_tr_b16 v[54:55], v14 offset:14336
    v_mfma_f32_16x16x32_bf16 v[92:95], a[188:191], v[60:63], v[92:95]
    s_waitcnt lgkmcnt(4)
    v_mfma_f32_16x16x32_bf16 v[64:67], a[192:195], v[40:43], v[64:67]
    ds_read_b64_tr_b16 v[56:57], v12 offset:16384
    buffer_load_dword v31, v30, s[32:35], 0 offen
    v_mfma_f32_16x16x32_bf16 v[64:67], a[208:211], v[44:47], v[64:67]
    s_add_u32 m0, s47, 32768
    v_mfma_f32_16x16x32_bf16 v[68:71], a[196:199], v[40:43], v[68:71]
    ds_read_b64_tr_b16 v[58:59], v12 offset:18432
    v_mfma_f32_16x16x32_bf16 v[68:71], a[212:215], v[44:47], v[68:71]
    v_mfma_f32_16x16x32_bf16 v[72:75], a[200:203], v[40:43], v[72:75]
    ds_read_b64_tr_b16 v[60:61], v12 offset:20480
    buffer_load_dwordx4 v10, s[28:31], s48 offen lds
    v_mfma_f32_16x16x32_bf16 v[72:75], a[216:219], v[44:47], v[72:75]
    v_mfma_f32_16x16x32_bf16 v[76:79], a[204:207], v[40:43], v[76:79]
    ds_read_b64_tr_b16 v[62:63], v12 offset:22528
    v_mfma_f32_16x16x32_bf16 v[76:79], a[220:223], v[44:47], v[76:79]
    s_waitcnt lgkmcnt(4)
    v_mfma_f32_16x16x32_bf16 v[80:83], a[192:195], v[48:51], v[80:83]
    ds_read_b64_tr_b16 v[40:41], v14 offset:16384
    buffer_load_dwordx4 v38, s[28:31], s48 offen offset:1024 lds
    v_mfma_f32_16x16x32_bf16 v[80:83], a[208:211], v[52:55], v[80:83]
    s_add_u32 s48, s48, s49
    v_mfma_f32_16x16x32_bf16 v[84:87], a[196:199], v[48:51], v[84:87]
    ds_read_b64_tr_b16 v[42:43], v14 offset:18432
    v_mfma_f32_16x16x32_bf16 v[84:87], a[212:215], v[52:55], v[84:87]
    v_mfma_f32_16x16x32_bf16 v[88:91], a[200:203], v[48:51], v[88:91]
    ds_read_b64_tr_b16 v[44:45], v14 offset:20480
    v_mfma_f32_16x16x32_bf16 v[88:91], a[216:219], v[52:55], v[88:91]
    buffer_store_dwordx4 v[204:207], v17, s[36:39], s61 offen offset:1024 sc1
    v_mfma_f32_16x16x32_bf16 v[92:95], a[204:207], v[48:51], v[92:95]
    ds_read_b64_tr_b16 v[46:47], v14 offset:22528
    v_mfma_f32_16x16x32_bf16 v[92:95], a[220:223], v[52:55], v[92:95]
    s_waitcnt vmcnt(14) lgkmcnt(4)
    s_barrier
    v_mfma_f32_16x16x32_bf16 v[64:67], a[224:227], v[56:59], v[64:67]
    ds_read_b64_tr_b16 v[48:49], v12 offset:24576
    s_add_u32 m0, s47, 40960
    v_mfma_f32_16x16x32_bf16 v[64:67], a[240:243], v[60:63], v[64:67]
    buffer_load_dwordx4 v10, s[28:31], s48 offen lds
    v_mfma_f32_16x16x32_bf16 v[68:71], a[228:231], v[56:59], v[68:71]
    ds_read_b64_tr_b16 v[50:51], v12 offset:26624
    v_mfma_f32_16x16x32_bf16 v[68:71], a[244:247], v[60:63], v[68:71]
    v_mfma_f32_16x16x32_bf16 v[72:75], a[232:235], v[56:59], v[72:75]
    ds_read_b64_tr_b16 v[52:53], v12 offset:28672
    v_mfma_f32_16x16x32_bf16 v[72:75], a[248:251], v[60:63], v[72:75]
    buffer_load_dwordx4 v38, s[28:31], s48 offen offset:1024 lds
    s_add_u32 s48, s48, s49
    v_mfma_f32_16x16x32_bf16 v[76:79], a[236:239], v[56:59], v[76:79]
    ds_read_b64_tr_b16 v[54:55], v12 offset:30720
    v_mfma_f32_16x16x32_bf16 v[76:79], a[252:255], v[60:63], v[76:79]
    s_waitcnt lgkmcnt(4)
    v_mfma_f32_16x16x32_bf16 v[80:83], a[224:227], v[40:43], v[80:83]
    ds_read_b64_tr_b16 v[56:57], v14 offset:24576
    v_mfma_f32_16x16x32_bf16 v[80:83], a[240:243], v[44:47], v[80:83]
    v_mfma_f32_16x16x32_bf16 v[84:87], a[228:231], v[40:43], v[84:87]
    ds_read_b64_tr_b16 v[58:59], v14 offset:26624
    v_mfma_f32_16x16x32_bf16 v[84:87], a[244:247], v[44:47], v[84:87]
    v_mfma_f32_16x16x32_bf16 v[88:91], a[232:235], v[40:43], v[88:91]
    ds_read_b64_tr_b16 v[60:61], v14 offset:28672
    v_mfma_f32_16x16x32_bf16 v[88:91], a[248:251], v[44:47], v[88:91]
    v_mfma_f32_16x16x32_bf16 v[92:95], a[236:239], v[40:43], v[92:95]
    ds_read_b64_tr_b16 v[62:63], v14 offset:30720
    v_mfma_f32_16x16x32_bf16 v[92:95], a[252:255], v[44:47], v[92:95]
    s_waitcnt vmcnt(11) lgkmcnt(4)
    s_barrier
    v_mfma_f32_16x16x32_bf16 v[64:67], v[160:163], v[48:51], v[64:67]
    ds_read_b64_tr_b16 v[40:41], v11 offset:0
    s_add_u32 m0, s47, 49152
    v_mfma_f32_16x16x32_bf16 v[64:67], v[176:179], v[52:55], v[64:67]
    buffer_load_dwordx4 v10, s[28:31], s48 offen lds
    v_mfma_f32_16x16x32_bf16 v[68:71], v[164:167], v[48:51], v[68:71]
    ds_read_b64_tr_b16 v[42:43], v11 offset:2048
    v_mfma_f32_16x16x32_bf16 v[68:71], v[180:183], v[52:55], v[68:71]
    v_mfma_f32_16x16x32_bf16 v[72:75], v[168:171], v[48:51], v[72:75]
    ds_read_b64_tr_b16 v[44:45], v11 offset:4096
    v_mfma_f32_16x16x32_bf16 v[72:75], v[184:187], v[52:55], v[72:75]
    buffer_load_dwordx4 v38, s[28:31], s48 offen offset:1024 lds
    s_add_u32 s48, s48, s49
    v_mfma_f32_16x16x32_bf16 v[76:79], v[172:175], v[48:51], v[76:79]
    ds_read_b64_tr_b16 v[46:47], v11 offset:6144
    v_mfma_f32_16x16x32_bf16 v[76:79], v[188:191], v[52:55], v[76:79]
    s_waitcnt lgkmcnt(4)
    v_mfma_f32_16x16x32_bf16 v[80:83], v[160:163], v[56:59], v[80:83]
    ds_read_b64_tr_b16 v[48:49], v13 offset:0
    v_mfma_f32_16x16x32_bf16 v[80:83], v[176:179], v[60:63], v[80:83]
    v_mfma_f32_16x16x32_bf16 v[84:87], v[164:167], v[56:59], v[84:87]
    ds_read_b64_tr_b16 v[50:51], v13 offset:2048
    v_mfma_f32_16x16x32_bf16 v[84:87], v[180:183], v[60:63], v[84:87]
    v_mfma_f32_16x16x32_bf16 v[88:91], v[168:171], v[56:59], v[88:91]
    ds_read_b64_tr_b16 v[52:53], v13 offset:4096
    v_mfma_f32_16x16x32_bf16 v[88:91], v[184:187], v[60:63], v[88:91]
    v_mfma_f32_16x16x32_bf16 v[92:95], v[172:175], v[56:59], v[92:95]
    ds_read_b64_tr_b16 v[54:55], v13 offset:6144
    v_mfma_f32_16x16x32_bf16 v[92:95], v[188:191], v[60:63], v[92:95]
    s_mov_b32 s38, 7077888
    s_add_u32 s63, s63, 4096
    s_add_u32 s61, s63, 110592
    s_cmp_lt_u32 s54, 9
    s_cselect_b32 s18, 0x3eae1a93, 1.0
    s_add_u32 s54, s54, 1
    v_mul_f32 v64, s18, v64
    v_mul_f32 v65, s18, v65
    v_mul_f32 v66, s18, v66
    v_mul_f32 v67, s18, v67
    v_cvt_pk_bf16_f32 v192, v64, v65
    v_cvt_pk_bf16_f32 v193, v66, v67
    v_mul_f32 v68, s18, v68
    v_mul_f32 v69, s18, v69
    v_mul_f32 v70, s18, v70
    v_mul_f32 v71, s18, v71
    v_cvt_pk_bf16_f32 v194, v68, v69
    v_cvt_pk_bf16_f32 v195, v70, v71
    v_mul_f32 v72, s18, v72
    v_mul_f32 v73, s18, v73
    v_mul_f32 v74, s18, v74
    v_mul_f32 v75, s18, v75
    v_cvt_pk_bf16_f32 v196, v72, v73
    v_cvt_pk_bf16_f32 v197, v74, v75
    v_mul_f32 v76, s18, v76
    v_mul_f32 v77, s18, v77
    v_mul_f32 v78, s18, v78
    v_mul_f32 v79, s18, v79
    v_cvt_pk_bf16_f32 v198, v76, v77
    v_cvt_pk_bf16_f32 v199, v78, v79
    v_mul_f32 v80, s18, v80
    v_mul_f32 v81, s18, v81
    v_mul_f32 v82, s18, v82
    v_mul_f32 v83, s18, v83
    v_cvt_pk_bf16_f32 v200, v80, v81
    v_cvt_pk_bf16_f32 v201, v82, v83
    v_mul_f32 v84, s18, v84
    v_mul_f32 v85, s18, v85
    v_mul_f32 v86, s18, v86
    v_mul_f32 v87, s18, v87
    v_cvt_pk_bf16_f32 v202, v84, v85
    v_cvt_pk_bf16_f32 v203, v86, v87
    v_mul_f32 v88, s18, v88
    v_mul_f32 v89, s18, v89
    v_mul_f32 v90, s18, v90
    v_mul_f32 v91, s18, v91
    v_cvt_pk_bf16_f32 v204, v88, v89
    v_cvt_pk_bf16_f32 v205, v90, v91
    v_mul_f32 v92, s18, v92
    v_mul_f32 v93, s18, v93
    v_mul_f32 v94, s18, v94
    v_mul_f32 v95, s18, v95
    v_cvt_pk_bf16_f32 v206, v92, v93
    v_cvt_pk_bf16_f32 v207, v94, v95
    s_sub_u32 s50, s50, 1
    s_cmp_lg_u32 s50, 0
    s_cbranch_scc1 K1_QLOOP
    buffer_store_dwordx4 v[192:195], v17, s[36:39], s63 offen offset:0 sc1
    buffer_store_dwordx4 v[196:199], v17, s[36:39], s61 offen offset:0 sc1
    buffer_store_dwordx4 v[200:203], v17, s[36:39], s63 offen offset:1024 sc1
    buffer_store_dwordx4 v[204:207], v17, s[36:39], s61 offen offset:1024 sc1
    s_cmp_eq_u32 s44, 0
    s_cselect_b32 s82, 1, 0
K1_G:
    s_waitcnt lgkmcnt(4)
    v_mfma_f32_16x16x32_bf16 v[64:67], v[40:43], a[0:3], 0
    ds_read_b64_tr_b16 v[56:57], v11 offset:8192
    s_add_u32 m0, s47, 57344
    v_mfma_f32_16x16x32_bf16 v[64:67], v[44:47], a[16:19], v[64:67]
    buffer_load_dwordx4 v10, s[28:31], s48 offen lds
    v_mfma_f32_16x16x32_bf16 v[68:71], v[40:43], a[4:7], 0
    ds_read_b64_tr_b16 v[58:59], v11 offset:10240
    v_mfma_f32_16x16x32_bf16 v[68:71], v[44:47], a[20:23], v[68:71]
    v_mfma_f32_16x16x32_bf16 v[72:75], v[40:43], a[8:11], 0
    ds_read_b64_tr_b16 v[60:61], v11 offset:12288
    v_mfma_f32_16x16x32_bf16 v[72:75], v[44:47], a[24:27], v[72:75]
    buffer_load_dwordx4 v38, s[28:31], s48 offen offset:1024 lds
    s_add_u32 s48, s48, s49
    v_mfma_f32_16x16x32_bf16 v[76:79], v[40:43], a[12:15], 0
    ds_read_b64_tr_b16 v[62:63], v11 offset:14336
    v_readlane_b32 s69, v23, s66
    v_mfma_f32_16x16x32_bf16 v[76:79], v[44:47], a[28:31], v[76:79]
    v_readlane_b32 s70, v24, s66
    s_waitcnt lgkmcnt(4)
    v_mfma_f32_16x16x32_bf16 v[80:83], v[48:51], a[0:3], 0
    ds_read_b64_tr_b16 v[40:41], v13 offset:8192
    v_readlane_b32 s81, v25, s66
    v_mfma_f32_16x16x32_bf16 v[80:83], v[52:55], a[16:19], v[80:83]
    v_rcp_f32 v128, v128
    v_mfma_f32_16x16x32_bf16 v[84:87], v[48:51], a[4:7], 0
    ds_read_b64_tr_b16 v[42:43], v13 offset:10240
    v_mul_f32 v128, v128, v96
    v_mfma_f32_16x16x32_bf16 v[84:87], v[52:55], a[20:23], v[84:87]
    v_rcp_f32 v129, v129
    v_mfma_f32_16x16x32_bf16 v[88:91], v[48:51], a[8:11], 0
    ds_read_b64_tr_b16 v[44:45], v13 offset:12288
    v_mul_f32 v129, v129, v97
    v_mfma_f32_16x16x32_bf16 v[88:91], v[52:55], a[24:27], v[88:91]
    v_rcp_f32 v130, v130
    v_mfma_f32_16x16x32_bf16 v[92:95], v[48:51], a[12:15], 0
    ds_read_b64_tr_b16 v[46:47], v13 offset:14336
    v_mul_f32 v130, v130, v98
    v_mfma_f32_16x16x32_bf16 v[92:95], v[52:55], a[28:31], v[92:95]
    s_waitcnt vmcnt(8) lgkmcnt(4)
    s_barrier
    v_mfma_f32_16x16x32_bf16 v[64:67], v[56:59], a[32:35], v[64:67]
    ds_read_b64_tr_b16 v[48:49], v11 offset:16384
    s_add_u32 m0, s47, 65536
    v_mfma_f32_16x16x32_bf16 v[64:67], v[60:63], a[48:51], v[64:67]
    buffer_load_dwordx4 v10, s[28:31], s48 offen lds
    v_cvt_pk_bf16_f32 v240, v128, v129
    v_mfma_f32_16x16x32_bf16 v[68:71], v[56:59], a[36:39], v[68:71]
    ds_read_b64_tr_b16 v[50:51], v11 offset:18432
    v_mfma_f32_16x16x32_bf16 v[68:71], v[60:63], a[52:55], v[68:71]
    v_rcp_f32 v131, v131
    v_mfma_f32_16x16x32_bf16 v[72:75], v[56:59], a[40:43], v[72:75]
    ds_read_b64_tr_b16 v[52:53], v11 offset:20480
    v_mul_f32 v131, v131, v99
    v_mfma_f32_16x16x32_bf16 v[72:75], v[60:63], a[56:59], v[72:75]
    buffer_load_dwordx4 v38, s[28:31], s48 offen offset:1024 lds
    s_add_u32 s48, s48, s49
    v_mfma_f32_16x16x32_bf16 v[76:79], v[56:59], a[44:47], v[76:79]
    ds_read_b64_tr_b16 v[54:55], v11 offset:22528
    v_readlane_b32 s28, v19, s66
    v_mfma_f32_16x16x32_bf16 v[76:79], v[60:63], a[60:63], v[76:79]
    v_readlane_b32 s29, v20, s66
    s_waitcnt lgkmcnt(4)
    v_mfma_f32_16x16x32_bf16 v[80:83], v[40:43], a[32:35], v[80:83]
    ds_read_b64_tr_b16 v[56:57], v13 offset:16384
    v_readlane_b32 s30, v21, s66
    v_mfma_f32_16x16x32_bf16 v[80:83], v[44:47], a[48:51], v[80:83]
    v_readlane_b32 s49, v22, s66
    v_mad_u32_u24 v10, v26, s69, v28
    v_mfma_f32_16x16x32_bf16 v[84:87], v[40:43], a[36:39], v[84:87]
    ds_read_b64_tr_b16 v[58:59], v13 offset:18432
    v_mad_u32_u24 v10, v27, s70, v10
    v_mfma_f32_16x16x32_bf16 v[84:87], v[44:47], a[52:55], v[84:87]
    s_mov_b32 s48, 0
    v_add_u32 v38, s81, v10
    v_mfma_f32_16x16x32_bf16 v[88:91], v[40:43], a[40:43], v[88:91]
    ds_read_b64_tr_b16 v[60:61], v13 offset:20480
    s_add_u32 s66, s66, 1
    v_mfma_f32_16x16x32_bf16 v[88:91], v[44:47], a[56:59], v[88:91]
    v_rcp_f32 v144, v144
    v_cvt_pk_bf16_f32 v241, v130, v131
    v_mfma_f32_16x16x32_bf16 v[92:95], v[40:43], a[44:47], v[92:95]
    ds_read_b64_tr_b16 v[62:63], v13 offset:22528
    v_mul_f32 v144, v144, v112
    v_mfma_f32_16x16x32_bf16 v[92:95], v[44:47], a[60:63], v[92:95]
    s_waitcnt lgkmcnt(4)
    v_mfma_f32_16x16x32_bf16 v[64:67], v[48:51], a[64:67], v[64:67]
    ds_read_b64_tr_b16 v[40:41], v11 offset:24576
    s_add_u32 m0, s47, 0
    v_mfma_f32_16x16x32_bf16 v[64:67], v[52:55], a[80:83], v[64:67]
    buffer_load_dwordx4 v10, s[28:31], s48 offen lds
    v_rcp_f32 v145, v145
    v_mfma_f32_16x16x32_bf16 v[68:71], v[48:51], a[68:71], v[68:71]
    ds_read_b64_tr_b16 v[42:43], v11 offset:26624
    v_mul_f32 v145, v145, v113
    v_mfma_f32_16x16x32_bf16 v[68:71], v[52:55], a[84:87], v[68:71]
    v_rcp_f32 v146, v146
    v_mfma_f32_16x16x32_bf16 v[72:75], v[48:51], a[72:75], v[72:75]
    ds_read_b64_tr_b16 v[44:45], v11 offset:28672
    v_mul_f32 v146, v146, v114
    v_mfma_f32_16x16x32_bf16 v[72:75], v[52:55], a[88:91], v[72:75]
    buffer_load_dwordx4 v38, s[28:31], s48 offen offset:1024 lds
    s_add_u32 s48, s48, s49
    v_mfma_f32_16x16x32_bf16 v[76:79], v[48:51], a[76:79], v[76:79]
    ds_read_b64_tr_b16 v[46:47], v11 offset:30720
    v_cvt_pk_bf16_f32 v242, v144, v145
    v_mfma_f32_16x16x32_bf16 v[76:79], v[52:55], a[92:95], v[76:79]
    s_waitcnt lgkmcnt(4)
    v_mfma_f32_16x16x32_bf16 v[80:83], v[56:59], a[64:67], v[80:83]
    ds_read_b64_tr_b16 v[48:49], v13 offset:24576
    v_rcp_f32 v147, v147
    v_mfma_f32_16x16x32_bf16 v[80:83], v[60:63], a[80:83], v[80:83]
    v_rcp_f32 v132, v132
    v_mfma_f32_16x16x32_bf16 v[84:87], v[56:59], a[68:71], v[84:87]
    ds_read_b64_tr_b16 v[50:51], v13 offset:26624
    v_mul_f32 v147, v147, v115
    v_mfma_f32_16x16x32_bf16 v[84:87], v[60:63], a[84:87], v[84:87]
    v_rcp_f32 v133, v133
    v_mfma_f32_16x16x32_bf16 v[88:91], v[56:59], a[72:75], v[88:91]
    ds_read_b64_tr_b16 v[52:53], v13 offset:28672
    v_cvt_pk_bf16_f32 v243, v146, v147
    v_mfma_f32_16x16x32_bf16 v[88:91], v[60:63], a[88:91], v[88:91]
    v_rcp_f32 v134, v134
    v_mfma_f32_16x16x32_bf16 v[92:95], v[56:59], a[76:79], v[92:95]
    ds_read_b64_tr_b16 v[54:55], v13 offset:30720
    v_mul_f32 v132, v132, v100
    v_mfma_f32_16x16x32_bf16 v[92:95], v[60:63], a[92:95], v[92:95]
    s_waitcnt vmcnt(8) lgkmcnt(4)
    s_barrier
    v_mfma_f32_16x16x32_bf16 v[64:67], v[40:43], a[96:99], v[64:67]
    ds_read_b64_tr_b16 v[56:57], v11 offset:32768
    s_add_u32 m0, s47, 8192
    v_mfma_f32_16x16x32_bf16 v[64:67], v[44:47], a[112:115], v[64:67]
    buffer_load_dwordx4 v10, s[28:31], s48 offen lds
    v_mul_f32 v133, v133, v101
    v_mfma_f32_16x16x32_bf16 v[68:71], v[40:43], a[100:103], v[68:71]
    ds_read_b64_tr_b16 v[58:59], v11 offset:34816
    v_mul_f32 v134, v134, v102
    v_mfma_f32_16x16x32_bf16 v[68:71], v[44:47], a[116:119], v[68:71]
    v_rcp_f32 v135, v135
    v_mfma_f32_16x16x32_bf16 v[72:75], v[40:43], a[104:107], v[72:75]
    ds_read_b64_tr_b16 v[60:61], v11 offset:36864
    v_mul_f32 v135, v135, v103
    v_mfma_f32_16x16x32_bf16 v[72:75], v[44:47], a[120:123], v[72:75]
    buffer_load_dwordx4 v38, s[28:31], s48 offen offset:1024 lds
    s_add_u32 s48, s48, s49
    v_mfma_f32_16x16x32_bf16 v[76:79], v[40:43], a[108:111], v[76:79]
    ds_read_b64_tr_b16 v[62:63], v11 offset:38912
    v_cvt_pk_bf16_f32 v244, v132, v133
    v_mfma_f32_16x16x32_bf16 v[76:79], v[44:47], a[124:127], v[76:79]
    v_cvt_pk_bf16_f32 v245, v134, v135
    s_waitcnt lgkmcnt(4)
    v_mfma_f32_16x16x32_bf16 v[80:83], v[48:51], a[96:99], v[80:83]
    ds_read_b64_tr_b16 v[40:41], v13 offset:32768
    v_mfma_f32_16x16x32_bf16 v[80:83], v[52:55], a[112:115], v[80:83]
    v_rcp_f32 v148, v148
    v_mfma_f32_16x16x32_bf16 v[84:87], v[48:51], a[100:103], v[84:87]
    ds_read_b64_tr_b16 v[42:43], v13 offset:34816
    v_mul_f32 v148, v148, v116
    v_mfma_f32_16x16x32_bf16 v[84:87], v[52:55], a[116:119], v[84:87]
    v_rcp_f32 v149, v149
    v_mfma_f32_16x16x32_bf16 v[88:91], v[48:51], a[104:107], v[88:91]
    ds_read_b64_tr_b16 v[44:45], v13 offset:36864
    v_mul_f32 v149, v149, v117
    v_mfma_f32_16x16x32_bf16 v[88:91], v[52:55], a[120:123], v[88:91]
    v_rcp_f32 v150, v150
    v_mfma_f32_16x16x32_bf16 v[92:95], v[48:51], a[108:111], v[92:95]
    ds_read_b64_tr_b16 v[46:47], v13 offset:38912
    v_mul_f32 v150, v150, v118
    v_mfma_f32_16x16x32_bf16 v[92:95], v[52:55], a[124:127], v[92:95]
    v_cvt_pk_bf16_f32 v246, v148, v149
    s_waitcnt lgkmcnt(4)
    v_mfma_f32_16x16x32_bf16 v[64:67], v[56:59], a[128:131], v[64:67]
    ds_read_b64_tr_b16 v[48:49], v12 offset:0
    s_add_u32 m0, s47, 16384
    v_mfma_f32_16x16x32_bf16 v[64:67], v[60:63], a[144:147], v[64:67]
    buffer_load_dwordx4 v10, s[28:31], s48 offen lds
    v_mfma_f32_16x16x32_bf16 v[68:71], v[56:59], a[132:135], v[68:71]
    ds_read_b64_tr_b16 v[50:51], v12 offset:2048
    v_mfma_f32_16x16x32_bf16 v[68:71], v[60:63], a[148:151], v[68:71]
    v_rcp_f32 v151, v151
    v_mfma_f32_16x16x32_bf16 v[72:75], v[56:59], a[136:139], v[72:75]
    ds_read_b64_tr_b16 v[52:53], v12 offset:4096
    v_mul_f32 v151, v151, v119
    v_mfma_f32_16x16x32_bf16 v[72:75], v[60:63], a[152:155], v[72:75]
    buffer_load_dwordx4 v38, s[28:31], s48 offen offset:1024 lds
    s_add_u32 s48, s48, s49
    v_mfma_f32_16x16x32_bf16 v[76:79], v[56:59], a[140:143], v[76:79]
    ds_read_b64_tr_b16 v[54:55], v12 offset:6144
    v_cvt_pk_bf16_f32 v247, v150, v151
    v_mfma_f32_16x16x32_bf16 v[76:79], v[60:63], a[156:159], v[76:79]
    s_waitcnt lgkmcnt(4)
    v_mfma_f32_16x16x32_bf16 v[80:83], v[40:43], a[128:131], v[80:83]
    ds_read_b64_tr_b16 v[56:57], v14 offset:0
    v_rcp_f32 v136, v136
    v_mfma_f32_16x16x32_bf16 v[80:83], v[44:47], a[144:147], v[80:83]
    v_rcp_f32 v137, v137
    v_mfma_f32_16x16x32_bf16 v[84:87], v[40:43], a[132:135], v[84:87]
    ds_read_b64_tr_b16 v[58:59], v14 offset:2048
    v_mul_f32 v136, v136, v104
    v_mfma_f32_16x16x32_bf16 v[84:87], v[44:47], a[148:151], v[84:87]
    v_rcp_f32 v138, v138
    v_mfma_f32_16x16x32_bf16 v[88:91], v[40:43], a[136:139], v[88:91]
    ds_read_b64_tr_b16 v[60:61], v14 offset:4096
    v_mul_f32 v137, v137, v105
    v_mfma_f32_16x16x32_bf16 v[88:91], v[44:47], a[152:155], v[88:91]
    v_rcp_f32 v139, v139
    v_mfma_f32_16x16x32_bf16 v[92:95], v[40:43], a[140:143], v[92:95]
    ds_read_b64_tr_b16 v[62:63], v14 offset:6144
    v_mul_f32 v138, v138, v106
    v_mfma_f32_16x16x32_bf16 v[92:95], v[44:47], a[156:159], v[92:95]
    s_waitcnt vmcnt(8) lgkmcnt(4)
    s_barrier
    v_mfma_f32_16x16x32_bf16 v[64:67], v[48:51], a[160:163], v[64:67]
    ds_read_b64_tr_b16 v[40:41], v12 offset:8192
    s_add_u32 m0, s47, 24576
    v_mfma_f32_16x16x32_bf16 v[64:67], v[52:55], a[176:179], v[64:67]
    buffer_load_dwordx4 v10, s[28:31], s48 offen lds
    v_mul_f32 v139, v139, v107
    v_mfma_f32_16x16x32_bf16 v[68:71], v[48:51], a[164:167], v[68:71]
    ds_read_b64_tr_b16 v[42:43], v12 offset:10240
    v_cvt_pk_bf16_f32 v248, v136, v137
    v_mfma_f32_16x16x32_bf16 v[68:71], v[52:55], a[180:183], v[68:71]
    v_rcp_f32 v152, v152
    v_mfma_f32_16x16x32_bf16 v[72:75], v[48:51], a[168:171], v[72:75]
    ds_read_b64_tr_b16 v[44:45], v12 offset:12288
    v_cvt_pk_bf16_f32 v249, v138, v139
    v_mfma_f32_16x16x32_bf16 v[72:75], v[52:55], a[184:187], v[72:75]
    buffer_load_dwordx4 v38, s[28:31], s48 offen offset:1024 lds
    s_add_u32 s48, s48, s49
    v_mfma_f32_16x16x32_bf16 v[76:79], v[48:51], a[172:175], v[76:79]
    ds_read_b64_tr_b16 v[46:47], v12 offset:14336
    v_readlane_b32 s71, v23, s80
    v_mfma_f32_16x16x32_bf16 v[76:79], v[52:55], a[188:191], v[76:79]
    v_readlane_b32 s32, v19, s80
    s_waitcnt lgkmcnt(4)
    v_mfma_f32_16x16x32_bf16 v[80:83], v[56:59], a[160:163], v[80:83]
    ds_read_b64_tr_b16 v[48:49], v14 offset:8192
    v_readlane_b32 s33, v20, s80
    v_readlane_b32 s34, v21, s80
    v_mfma_f32_16x16x32_bf16 v[80:83], v[60:63], a[176:179], v[80:83]
    v_mul_u32_u24 v30, s71, v29
    s_cmp_eq_u32 s71, 0
    s_cselect_b32 s71, 1, 0
    v_mfma_f32_16x16x32_bf16 v[84:87], v[56:59], a[164:167], v[84:87]
    ds_read_b64_tr_b16 v[50:51], v14 offset:10240
    s_add_u32 s80, s80, 1
    v_mad_u32_u24 v30, v8, s71, v30
    v_mfma_f32_16x16x32_bf16 v[84:87], v[60:63], a[180:183], v[84:87]
    v_rcp_f32 v153, v153
    v_mul_f32 v152, v152, v120
    v_mfma_f32_16x16x32_bf16 v[88:91], v[56:59], a[168:171], v[88:91]
    ds_read_b64_tr_b16 v[52:53], v14 offset:12288
    v_rcp_f32 v154, v154
    v_mfma_f32_16x16x32_bf16 v[88:91], v[60:63], a[184:187], v[88:91]
    v_rcp_f32 v155, v155
    v_mul_f32 v153, v153, v121
    v_mfma_f32_16x16x32_bf16 v[92:95], v[56:59], a[172:175], v[92:95]
    ds_read_b64_tr_b16 v[54:55], v14 offset:14336
    v_mul_f32 v154, v154, v122
    v_mfma_f32_16x16x32_bf16 v[92:95], v[60:63], a[188:191], v[92:95]
    v_mul_f32 v155, v155, v123
    s_waitcnt lgkmcnt(4)
    v_mfma_f32_16x16x32_bf16 v[64:67], v[40:43], a[192:195], v[64:67]
    ds_read_b64_tr_b16 v[56:57], v12 offset:16384
    buffer_load_dword v31, v30, s[32:35], 0 offen
    v_mfma_f32_16x16x32_bf16 v[64:67], v[44:47], a[208:211], v[64:67]
    v_readlane_b32 s71, v23, s80
    v_readlane_b32 s32, v19, s80
    v_mfma_f32_16x16x32_bf16 v[68:71], v[40:43], a[196:199], v[68:71]
    ds_read_b64_tr_b16 v[58:59], v12 offset:18432
    v_readlane_b32 s33, v20, s80
    v_readlane_b32 s34, v21, s80
    v_mfma_f32_16x16x32_bf16 v[68:71], v[44:47], a[212:215], v[68:71]
    v_mul_u32_u24 v30, s71, v29
    s_cmp_eq_u32 s71, 0
    s_cselect_b32 s71, 1, 0
    v_mfma_f32_16x16x32_bf16 v[72:75], v[40:43], a[200:203], v[72:75]
    ds_read_b64_tr_b16 v[60:61], v12 offset:20480
    s_add_u32 s80, s80, 1
    v_mad_u32_u24 v30, v8, s71, v30
    v_mfma_f32_16x16x32_bf16 v[72:75], v[44:47], a[216:219], v[72:75]
    s_nop 1
    buffer_load_dword v31, v30, s[32:35], 0 offen
    s_add_u32 m0, s47, 32768
    v_mfma_f32_16x16x32_bf16 v[76:79], v[40:43], a[204:207], v[76:79]
    ds_read_b64_tr_b16 v[62:63], v12 offset:22528
    v_rcp_f32 v140, v140
    v_mfma_f32_16x16x32_bf16 v[76:79], v[44:47], a[220:223], v[76:79]
    v_rcp_f32 v141, v141
    s_waitcnt lgkmcnt(4)
    v_mfma_f32_16x16x32_bf16 v[80:83], v[48:51], a[192:195], v[80:83]
    ds_read_b64_tr_b16 v[40:41], v14 offset:16384
    v_rcp_f32 v142, v142
    v_mfma_f32_16x16x32_bf16 v[80:83], v[52:55], a[208:211], v[80:83]
    buffer_load_dwordx4 v10, s[28:31], s48 offen lds
    v_rcp_f32 v143, v143
    v_mfma_f32_16x16x32_bf16 v[84:87], v[48:51], a[196:199], v[84:87]
    ds_read_b64_tr_b16 v[42:43], v14 offset:18432
    v_rcp_f32 v156, v156
    v_mfma_f32_16x16x32_bf16 v[84:87], v[52:55], a[212:215], v[84:87]
    v_rcp_f32 v157, v157
    v_mfma_f32_16x16x32_bf16 v[88:91], v[48:51], a[200:203], v[88:91]
    ds_read_b64_tr_b16 v[44:45], v14 offset:20480
    v_cvt_pk_bf16_f32 v250, v152, v153
    v_mfma_f32_16x16x32_bf16 v[88:91], v[52:55], a[216:219], v[88:91]
    buffer_load_dwordx4 v38, s[28:31], s48 offen offset:1024 lds
    s_add_u32 s48, s48, s49
    v_mfma_f32_16x16x32_bf16 v[92:95], v[48:51], a[204:207], v[92:95]
    ds_read_b64_tr_b16 v[46:47], v14 offset:22528
    v_cvt_pk_bf16_f32 v251, v154, v155
    v_mfma_f32_16x16x32_bf16 v[92:95], v[52:55], a[220:223], v[92:95]
    s_waitcnt vmcnt(12) lgkmcnt(4)
    s_barrier
    v_mfma_f32_16x16x32_bf16 v[64:67], v[56:59], a[224:227], v[64:67]
    ds_read_b64_tr_b16 v[48:49], v12 offset:24576
    s_add_u32 m0, s47, 40960
    v_mul_f32 v140, v140, v108
    v_mfma_f32_16x16x32_bf16 v[64:67], v[60:63], a[240:243], v[64:67]
    buffer_load_dwordx4 v10, s[28:31], s48 offen lds
    v_rcp_f32 v158, v158
    v_mfma_f32_16x16x32_bf16 v[68:71], v[56:59], a[228:231], v[68:71]
    ds_read_b64_tr_b16 v[50:51], v12 offset:26624
    v_mul_f32 v141, v141, v109
    v_mfma_f32_16x16x32_bf16 v[68:71], v[60:63], a[244:247], v[68:71]
    v_rcp_f32 v159, v159
    v_mfma_f32_16x16x32_bf16 v[72:75], v[56:59], a[232:235], v[72:75]
    ds_read_b64_tr_b16 v[52:53], v12 offset:28672
    v_mul_f32 v142, v142, v110
    v_mfma_f32_16x16x32_bf16 v[72:75], v[60:63], a[248:251], v[72:75]
    buffer_load_dwordx4 v38, s[28:31], s48 offen offset:1024 lds
    s_add_u32 s48, s48, s49
    v_mfma_f32_16x16x32_bf16 v[76:79], v[56:59], a[236:239], v[76:79]
    ds_read_b64_tr_b16 v[54:55], v12 offset:30720
    v_mul_f32 v143, v143, v111
    v_mfma_f32_16x16x32_bf16 v[76:79], v[60:63], a[252:255], v[76:79]
    v_cvt_pk_bf16_f32 v252, v140, v141
    s_waitcnt lgkmcnt(4)
    v_mfma_f32_16x16x32_bf16 v[80:83], v[40:43], a[224:227], v[80:83]
    ds_read_b64_tr_b16 v[56:57], v14 offset:24576
    v_cvt_pk_bf16_f32 v253, v142, v143
    v_mfma_f32_16x16x32_bf16 v[80:83], v[44:47], a[240:243], v[80:83]
    ds_write_b64 v15, v[240:241] offset:0
    v_mfma_f32_16x16x32_bf16 v[84:87], v[40:43], a[228:231], v[84:87]
    ds_read_b64_tr_b16 v[58:59], v14 offset:26624
    v_mul_f32 v156, v156, v124
    v_mfma_f32_16x16x32_bf16 v[84:87], v[44:47], a[244:247], v[84:87]
    ds_write_b64 v15, v[242:243] offset:512
    v_mfma_f32_16x16x32_bf16 v[88:91], v[40:43], a[232:235], v[88:91]
    ds_read_b64_tr_b16 v[60:61], v14 offset:28672
    v_mul_f32 v157, v157, v125
    v_mfma_f32_16x16x32_bf16 v[88:91], v[44:47], a[248:251], v[88:91]
    ds_write_b64 v15, v[244:245] offset:1024
    v_mfma_f32_16x16x32_bf16 v[92:95], v[40:43], a[236:239], v[92:95]
    ds_read_b64_tr_b16 v[62:63], v14 offset:30720
    v_mul_f32 v158, v158, v126
    v_mfma_f32_16x16x32_bf16 v[92:95], v[44:47], a[252:255], v[92:95]
    s_waitcnt vmcnt(10) lgkmcnt(7)
    s_barrier
    v_mfma_f32_16x16x32_bf16 v[64:67], v[48:51], v[160:163], v[64:67]
    ds_read_b64_tr_b16 v[40:41], v11 offset:0
    s_add_u32 m0, s47, 49152
    v_mfma_f32_16x16x32_bf16 v[64:67], v[52:55], v[176:179], v[64:67]
    buffer_load_dwordx4 v10, s[28:31], s48 offen lds
    v_mul_f32 v159, v159, v127
    v_mfma_f32_16x16x32_bf16 v[68:71], v[48:51], v[164:167], v[68:71]
    ds_read_b64_tr_b16 v[42:43], v11 offset:2048
    v_cvt_pk_bf16_f32 v254, v156, v157
    v_mfma_f32_16x16x32_bf16 v[68:71], v[52:55], v[180:183], v[68:71]
    ds_write_b64 v15, v[246:247] offset:1536
    v_mfma_f32_16x16x32_bf16 v[72:75], v[48:51], v[168:171], v[72:75]
    ds_read_b64_tr_b16 v[44:45], v11 offset:4096
    v_cvt_pk_bf16_f32 v255, v158, v159
    v_mfma_f32_16x16x32_bf16 v[72:75], v[52:55], v[184:187], v[72:75]
    buffer_load_dwordx4 v38, s[28:31], s48 offen offset:1024 lds
    s_add_u32 s48, s48, s49
    v_mfma_f32_16x16x32_bf16 v[76:79], v[48:51], v[172:175], v[76:79]
    ds_read_b64_tr_b16 v[46:47], v11 offset:6144
    v_mfma_f32_16x16x32_bf16 v[76:79], v[52:55], v[188:191], v[76:79]
    s_waitcnt lgkmcnt(5)
    v_mfma_f32_16x16x32_bf16 v[80:83], v[56:59], v[160:163], v[80:83]
    ds_read_b64_tr_b16 v[48:49], v13 offset:0
    ds_write_b64 v15, v[248:249] offset:2048
    v_mfma_f32_16x16x32_bf16 v[80:83], v[60:63], v[176:179], v[80:83]
    ds_write_b64 v15, v[250:251] offset:2560
    v_mfma_f32_16x16x32_bf16 v[84:87], v[56:59], v[164:167], v[84:87]
    ds_read_b64_tr_b16 v[50:51], v13 offset:2048
    v_mfma_f32_16x16x32_bf16 v[84:87], v[60:63], v[180:183], v[84:87]
    ds_write_b64 v15, v[252:253] offset:3072
    v_mfma_f32_16x16x32_bf16 v[88:91], v[56:59], v[168:171], v[88:91]
    ds_read_b64_tr_b16 v[52:53], v13 offset:4096
    v_mfma_f32_16x16x32_bf16 v[88:91], v[60:63], v[184:187], v[88:91]
    ds_write_b64 v15, v[254:255] offset:3584
    v_mfma_f32_16x16x32_bf16 v[92:95], v[56:59], v[172:175], v[92:95]
    ds_read_b64_tr_b16 v[54:55], v13 offset:6144
    v_add_u32 v15, 16384, v15
    v_mfma_f32_16x16x32_bf16 v[92:95], v[60:63], v[188:191], v[92:95]
    s_cmp_eq_u32 s82, 0
    s_cbranch_scc1 K1_ULOOP
    s_mov_b32 s82, 0
    s_mov_b64 exec, 1
    s_or_b32 s19, s19, 2
    v_mov_b32 v2, s19
    s_lshl_b32 s57, s64, 7
    s_add_u32 s57, s57, s65
    buffer_store_byte v2, v9, s[12:15], s57 offen sc0 sc1
    s_mov_b64 exec, -1
    s_branch K1_ULOOP
K1_DSTART:
    s_mov_b32 s86, 8192
    s_mov_b32 s87, 57344
    s_mov_b32 s52, 7
    ds_read2st64_b64 a[0:3], v16 offset0:0 offset1:1
    ds_read2st64_b64 a[16:19], v16 offset0:8 offset1:9
    ds_read2st64_b64 a[4:7], v16 offset0:2 offset1:3
    ds_read2st64_b64 a[20:23], v16 offset0:10 offset1:11
    ds_read2st64_b64 a[8:11], v16 offset0:4 offset1:5
    ds_read2st64_b64 a[24:27], v16 offset0:12 offset1:13
    ds_read2st64_b64 a[12:15], v16 offset0:6 offset1:7
    ds_read2st64_b64 a[28:31], v16 offset0:14 offset1:15
    s_waitcnt lgkmcnt(0)
    s_cmp_eq_u32 s51, 4
    s_cbranch_scc1 K1_D4
K1_D5:
    s_mov_b32 s54, 0xfffb8100
    s_mov_b32 s55, 131072
    s_mov_b32 s50, 131072
    s_waitcnt lgkmcnt(4)
    v_add_u32 v6, s86, v11
    v_mfma_f32_16x16x32_bf16 v[64:67], v[40:43], a[0:3], 0
    ds_read_b64_tr_b16 v[56:57], v6 offset:0
    v_add_u32 v7, s86, v13
    s_add_u32 m0, s47, s87
    v_mfma_f32_16x16x32_bf16 v[64:67], v[44:47], a[16:19], v[64:67]
    ds_read2st64_b64 a[32:35], v16 offset0:32 offset1:33
    buffer_load_dwordx4 v10, s[28:31], s48 offen lds
    v_mfma_f32_16x16x32_bf16 v[68:71], v[40:43], a[4:7], 0
    ds_read_b64_tr_b16 v[58:59], v6 offset:2048
    v_mfma_f32_16x16x32_bf16 v[68:71], v[44:47], a[20:23], v[68:71]
    ds_read2st64_b64 a[48:51], v16 offset0:40 offset1:41
    v_mfma_f32_16x16x32_bf16 v[72:75], v[40:43], a[8:11], 0
    ds_read_b64_tr_b16 v[60:61], v6 offset:4096
    v_rcp_f32 v128, v128
    v_rcp_f32 v129, v129
    v_mfma_f32_16x16x32_bf16 v[72:75], v[44:47], a[24:27], v[72:75]
    ds_read2st64_b64 a[36:39], v16 offset0:34 offset1:35
    buffer_load_dwordx4 v38, s[28:31], s48 offen offset:1024 lds
    s_add_u32 s48, s48, 0x12000
    s_add_u32 s86, s86, 8192
    s_cmp_ge_u32 s86, 73728
    s_cselect_b32 s86, 0, s86
    v_mfma_f32_16x16x32_bf16 v[76:79], v[40:43], a[12:15], 0
    ds_read_b64_tr_b16 v[62:63], v6 offset:6144
    s_add_u32 s87, s87, 8192
    s_cmp_ge_u32 s87, 73728
    s_cselect_b32 s87, 0, s87
    v_bfe_u32 v5, v1, 2, 2
    s_lshl_b32 s58, s17, 1
    v_mfma_f32_16x16x32_bf16 v[76:79], v[44:47], a[28:31], v[76:79]
    ds_read2st64_b64 a[52:55], v16 offset0:42 offset1:43
    s_sub_u32 s58, s58, 2
    v_add_u32 v5, s58, v5
    v_max_i32 v5, 0, v5
    v_lshlrev_b32 v5, 7, v5
    s_waitcnt lgkmcnt(8)
    v_mfma_f32_16x16x32_bf16 v[80:83], v[48:51], a[0:3], 0
    ds_read_b64_tr_b16 v[160:161], v7 offset:0
    v_and_b32 v4, 3, v1
    v_lshl_add_u32 v5, v4, 2, v5
    v_rcp_f32 v130, v130
    v_mfma_f32_16x16x32_bf16 v[80:83], v[52:55], a[16:19], v[80:83]
    ds_read2st64_b64 a[40:43], v16 offset0:36 offset1:37
    buffer_load_dword v39, v5, s[12:15], 0 offen sc1
    v_rcp_f32 v131, v131
    v_mul_f32 v128, v128, v96
    v_mfma_f32_16x16x32_bf16 v[84:87], v[48:51], a[4:7], 0
    ds_read_b64_tr_b16 v[162:163], v7 offset:2048
    v_rcp_f32 v144, v144
    v_rcp_f32 v145, v145
    v_mfma_f32_16x16x32_bf16 v[84:87], v[52:55], a[20:23], v[84:87]
    ds_read2st64_b64 a[56:59], v16 offset0:44 offset1:45
    v_rcp_f32 v146, v146
    v_rcp_f32 v147, v147
    v_mfma_f32_16x16x32_bf16 v[88:91], v[48:51], a[8:11], 0
    ds_read_b64_tr_b16 v[164:165], v7 offset:4096
    v_rcp_f32 v132, v132
    v_rcp_f32 v133, v133
    v_mfma_f32_16x16x32_bf16 v[88:91], v[52:55], a[24:27], v[88:91]
    ds_read2st64_b64 a[44:47], v16 offset0:38 offset1:39
    v_rcp_f32 v134, v134
    v_rcp_f32 v135, v135
    v_mfma_f32_16x16x32_bf16 v[92:95], v[48:51], a[12:15], 0
    ds_read_b64_tr_b16 v[166:167], v7 offset:6144
    v_rcp_f32 v148, v148
    v_rcp_f32 v149, v149
    v_mfma_f32_16x16x32_bf16 v[92:95], v[52:55], a[28:31], v[92:95]
    ds_read2st64_b64 a[60:63], v16 offset0:46 offset1:47
    v_rcp_f32 v150, v150
    v_mul_f32 v129, v129, v97
    s_waitcnt vmcnt(9) lgkmcnt(9)
    s_barrier
    v_add_u32 v6, s86, v11
    s_waitcnt lgkmcnt(0)
    v_mfma_f32_16x16x32_bf16 v[64:67], v[56:59], a[32:35], v[64:67]
    ds_read_b64_tr_b16 v[168:169], v6 offset:0
    v_add_u32 v7, s86, v13
    s_add_u32 m0, s47, s87
    v_mfma_f32_16x16x32_bf16 v[64:67], v[60:63], a[48:51], v[64:67]
    ds_read2st64_b64 a[64:67], v16 offset0:64 offset1:65
    buffer_load_dwordx4 v10, s[28:31], s48 offen lds
    v_rcp_f32 v151, v151
    v_mul_f32 v130, v130, v98
    v_mfma_f32_16x16x32_bf16 v[68:71], v[56:59], a[36:39], v[68:71]
    ds_read_b64_tr_b16 v[170:171], v6 offset:2048
    v_rcp_f32 v136, v136
    v_rcp_f32 v137, v137
    v_mfma_f32_16x16x32_bf16 v[68:71], v[60:63], a[52:55], v[68:71]
    ds_read2st64_b64 a[80:83], v16 offset0:72 offset1:73
    v_rcp_f32 v138, v138
    v_mfma_f32_16x16x32_bf16 v[72:75], v[56:59], a[40:43], v[72:75]
    ds_read_b64_tr_b16 v[172:173], v6 offset:4096
    v_rcp_f32 v139, v139
    v_mfma_f32_16x16x32_bf16 v[72:75], v[60:63], a[56:59], v[72:75]
    ds_read2st64_b64 a[68:71], v16 offset0:66 offset1:67
    buffer_load_dwordx4 v38, s[28:31], s48 offen offset:1024 lds
    s_add_u32 s48, s48, 0x12000
    v_mfma_f32_16x16x32_bf16 v[76:79], v[56:59], a[44:47], v[76:79]
    ds_read_b64_tr_b16 v[174:175], v6 offset:6144
    s_add_u32 s86, s86, 8192
    s_cmp_ge_u32 s86, 73728
    s_cselect_b32 s86, 0, s86
    s_add_u32 s87, s87, 8192
    v_mfma_f32_16x16x32_bf16 v[76:79], v[60:63], a[60:63], v[76:79]
    ds_read2st64_b64 a[84:87], v16 offset0:74 offset1:75
    s_cmp_ge_u32 s87, 73728
    s_cselect_b32 s87, 0, s87
    v_rcp_f32 v152, v152
    v_mfma_f32_16x16x32_bf16 v[80:83], v[160:163], a[32:35], v[80:83]
    ds_read_b64_tr_b16 v[40:41], v7 offset:0
    v_rcp_f32 v153, v153
    v_rcp_f32 v154, v154
    v_mfma_f32_16x16x32_bf16 v[80:83], v[164:167], a[48:51], v[80:83]
    ds_read2st64_b64 a[72:75], v16 offset0:68 offset1:69
    v_rcp_f32 v155, v155
    v_rcp_f32 v140, v140
    v_mfma_f32_16x16x32_bf16 v[84:87], v[160:163], a[36:39], v[84:87]
    ds_read_b64_tr_b16 v[42:43], v7 offset:2048
    v_rcp_f32 v141, v141
    v_mfma_f32_16x16x32_bf16 v[84:87], v[164:167], a[52:55], v[84:87]
    ds_read2st64_b64 a[88:91], v16 offset0:76 offset1:77
    v_rcp_f32 v142, v142
    v_mfma_f32_16x16x32_bf16 v[88:91], v[160:163], a[40:43], v[88:91]
    ds_read_b64_tr_b16 v[44:45], v7 offset:4096
    v_rcp_f32 v143, v143
    v_mfma_f32_16x16x32_bf16 v[88:91], v[164:167], a[56:59], v[88:91]
    ds_read2st64_b64 a[76:79], v16 offset0:70 offset1:71
    v_rcp_f32 v156, v156
    v_mfma_f32_16x16x32_bf16 v[92:95], v[160:163], a[44:47], v[92:95]
    ds_read_b64_tr_b16 v[46:47], v7 offset:6144
    v_rcp_f32 v157, v157
    v_mfma_f32_16x16x32_bf16 v[92:95], v[164:167], a[60:63], v[92:95]
    ds_read2st64_b64 a[92:95], v16 offset0:78 offset1:79
    v_mul_f32 v131, v131, v99
    s_waitcnt lgkmcnt(9)
    v_add_u32 v6, s86, v11
    s_waitcnt lgkmcnt(0)
    v_mfma_f32_16x16x32_bf16 v[64:67], v[168:171], a[64:67], v[64:67]
    ds_read_b64_tr_b16 v[48:49], v6 offset:0
    v_add_u32 v7, s86, v13
    s_add_u32 m0, s47, s87
    v_mfma_f32_16x16x32_bf16 v[64:67], v[172:175], a[80:83], v[64:67]
    ds_read2st64_b64 a[96:99], v16 offset0:96 offset1:97
    buffer_load_dwordx4 v10, s[28:31], s48 offen lds
    v_rcp_f32 v158, v158
    v_cvt_pk_bf16_f32 v240, v128, v129
    v_mfma_f32_16x16x32_bf16 v[68:71], v[168:171], a[68:71], v[68:71]
    ds_read_b64_tr_b16 v[50:51], v6 offset:2048
    v_rcp_f32 v159, v159
    v_cvt_pk_bf16_f32 v241, v130, v131
    v_mul_f32 v144, v144, v112
    v_mfma_f32_16x16x32_bf16 v[68:71], v[172:175], a[84:87], v[68:71]
    ds_read2st64_b64 a[112:115], v16 offset0:104 offset1:105
    v_mul_f32 v145, v145, v113
    v_mul_f32 v146, v146, v114
    v_mfma_f32_16x16x32_bf16 v[72:75], v[168:171], a[72:75], v[72:75]
    ds_read_b64_tr_b16 v[52:53], v6 offset:4096
    ds_write_b64 v15, v[240:241] offset:0
    v_mfma_f32_16x16x32_bf16 v[72:75], v[172:175], a[88:91], v[72:75]
    ds_read2st64_b64 a[100:103], v16 offset0:98 offset1:99
    buffer_load_dwordx4 v38, s[28:31], s48 offen offset:1024 lds
    s_add_u32 s48, s48, s54
    v_mfma_f32_16x16x32_bf16 v[76:79], v[168:171], a[76:79], v[76:79]
    ds_read_b64_tr_b16 v[54:55], v6 offset:6144
    s_add_u32 s86, s86, 8192
    s_cmp_ge_u32 s86, 73728
    s_cselect_b32 s86, 0, s86
    s_add_u32 s87, s87, 8192
    v_mfma_f32_16x16x32_bf16 v[76:79], v[172:175], a[92:95], v[76:79]
    ds_read2st64_b64 a[116:119], v16 offset0:106 offset1:107
    s_cmp_ge_u32 s87, 73728
    s_cselect_b32 s87, 0, s87
    v_mul_f32 v147, v147, v115
    v_cvt_pk_bf16_f32 v242, v144, v145
    v_mfma_f32_16x16x32_bf16 v[80:83], v[40:43], a[64:67], v[80:83]
    ds_read_b64_tr_b16 v[56:57], v7 offset:0
    v_cvt_pk_bf16_f32 v243, v146, v147
    v_mul_f32 v132, v132, v100
    v_mul_f32 v133, v133, v101
    v_mul_f32 v134, v134, v102
    v_mfma_f32_16x16x32_bf16 v[80:83], v[44:47], a[80:83], v[80:83]
    ds_read2st64_b64 a[104:107], v16 offset0:100 offset1:101
    ds_write_b64 v15, v[242:243] offset:512
    v_mul_f32 v135, v135, v103
    v_cvt_pk_bf16_f32 v244, v132, v133
    v_mfma_f32_16x16x32_bf16 v[84:87], v[40:43], a[68:71], v[84:87]
    ds_read_b64_tr_b16 v[58:59], v7 offset:2048
    v_cvt_pk_bf16_f32 v245, v134, v135
    v_mul_f32 v148, v148, v116
    v_mfma_f32_16x16x32_bf16 v[84:87], v[44:47], a[84:87], v[84:87]
    ds_read2st64_b64 a[120:123], v16 offset0:108 offset1:109
    ds_write_b64 v15, v[244:245] offset:1024
    v_mfma_f32_16x16x32_bf16 v[88:91], v[40:43], a[72:75], v[88:91]
    ds_read_b64_tr_b16 v[60:61], v7 offset:4096
    v_mul_f32 v149, v149, v117
    v_mul_f32 v150, v150, v118
    v_mfma_f32_16x16x32_bf16 v[88:91], v[44:47], a[88:91], v[88:91]
    ds_read2st64_b64 a[108:111], v16 offset0:102 offset1:103
    v_mul_f32 v151, v151, v119
    v_cvt_pk_bf16_f32 v246, v148, v149
    v_mfma_f32_16x16x32_bf16 v[92:95], v[40:43], a[76:79], v[92:95]
    ds_read_b64_tr_b16 v[62:63], v7 offset:6144
    v_cvt_pk_bf16_f32 v247, v150, v151
    v_mul_f32 v136, v136, v104
    v_mfma_f32_16x16x32_bf16 v[92:95], v[44:47], a[92:95], v[92:95]
    ds_read2st64_b64 a[124:127], v16 offset0:110 offset1:111
    v_mul_f32 v137, v137, v105
    s_waitcnt vmcnt(11) lgkmcnt(11)
    s_barrier
    v_add_u32 v6, s86, v11
    s_waitcnt lgkmcnt(0)
    v_mfma_f32_16x16x32_bf16 v[64:67], v[48:51], a[96:99], v[64:67]
    ds_read_b64_tr_b16 v[160:161], v6 offset:0
    v_add_u32 v7, s86, v13
    s_add_u32 m0, s47, s87
    v_mfma_f32_16x16x32_bf16 v[64:67], v[52:55], a[112:115], v[64:67]
    buffer_load_dwordx4 v10, s[28:31], s48 offen lds
    ds_write_b64 v15, v[246:247] offset:1536
    v_mul_f32 v138, v138, v106
    v_mul_f32 v139, v139, v107
    v_mfma_f32_16x16x32_bf16 v[68:71], v[48:51], a[100:103], v[68:71]
    ds_read_b64_tr_b16 v[162:163], v6 offset:2048
    v_cvt_pk_bf16_f32 v248, v136, v137
    v_cvt_pk_bf16_f32 v249, v138, v139
    v_mfma_f32_16x16x32_bf16 v[68:71], v[52:55], a[116:119], v[68:71]
    ds_write_b64 v15, v[248:249] offset:2048
    v_mul_f32 v152, v152, v120
    v_mfma_f32_16x16x32_bf16 v[72:75], v[48:51], a[104:107], v[72:75]
    ds_read_b64_tr_b16 v[164:165], v6 offset:4096
    v_mul_f32 v153, v153, v121
    v_mul_f32 v154, v154, v122
    v_mfma_f32_16x16x32_bf16 v[72:75], v[52:55], a[120:123], v[72:75]
    buffer_load_dwordx4 v38, s[28:31], s48 offen offset:1024 lds
    s_add_u32 s48, s48, 0x12000
    s_add_u32 s86, s86, 8192
    v_mfma_f32_16x16x32_bf16 v[76:79], v[48:51], a[108:111], v[76:79]
    ds_read_b64_tr_b16 v[166:167], v6 offset:6144
    s_cmp_ge_u32 s86, 73728
    s_cselect_b32 s86, 0, s86
    s_add_u32 s87, s87, 8192
    s_cmp_ge_u32 s87, 73728
    s_cselect_b32 s87, 0, s87
    v_mfma_f32_16x16x32_bf16 v[76:79], v[52:55], a[124:127], v[76:79]
    v_mul_f32 v155, v155, v123
    v_cvt_pk_bf16_f32 v250, v152, v153
    v_mul_f32 v140, v140, v108
    v_mul_f32 v141, v141, v109
    v_mfma_f32_16x16x32_bf16 v[80:83], v[56:59], a[96:99], v[80:83]
    ds_read_b64_tr_b16 v[168:169], v7 offset:0
    v_cvt_pk_bf16_f32 v251, v154, v155
    v_mul_f32 v142, v142, v110
    v_mul_f32 v143, v143, v111
    v_cvt_pk_bf16_f32 v252, v140, v141
    v_mfma_f32_16x16x32_bf16 v[80:83], v[60:63], a[112:115], v[80:83]
    ds_write_b64 v15, v[250:251] offset:2560
    v_cvt_pk_bf16_f32 v253, v142, v143
    v_mfma_f32_16x16x32_bf16 v[84:87], v[56:59], a[100:103], v[84:87]
    ds_read_b64_tr_b16 v[170:171], v7 offset:2048
    ds_write_b64 v15, v[252:253] offset:3072
    v_mfma_f32_16x16x32_bf16 v[84:87], v[60:63], a[116:119], v[84:87]
    v_mul_f32 v156, v156, v124
    v_mul_f32 v157, v157, v125
    v_mul_f32 v158, v158, v126
    v_mfma_f32_16x16x32_bf16 v[88:91], v[56:59], a[104:107], v[88:91]
    ds_read_b64_tr_b16 v[172:173], v7 offset:4096
    v_mul_f32 v159, v159, v127
    v_cvt_pk_bf16_f32 v254, v156, v157
    v_mfma_f32_16x16x32_bf16 v[88:91], v[60:63], a[120:123], v[88:91]
    v_cvt_pk_bf16_f32 v255, v158, v159
    v_mfma_f32_16x16x32_bf16 v[92:95], v[56:59], a[108:111], v[92:95]
    ds_read_b64_tr_b16 v[174:175], v7 offset:6144
    v_mfma_f32_16x16x32_bf16 v[92:95], v[60:63], a[124:127], v[92:95]
    ds_write_b64 v15, v[254:255] offset:3584
    s_waitcnt lgkmcnt(7)
    s_waitcnt vmcnt(9) lgkmcnt(0)
    s_barrier
    ds_read2st64_b64 a[128:131], v16 offset0:128 offset1:129
    ds_read2st64_b64 a[144:147], v16 offset0:136 offset1:137
    ds_read2st64_b64 a[132:135], v16 offset0:130 offset1:131
    ds_read2st64_b64 a[148:151], v16 offset0:138 offset1:139
    ds_read2st64_b64 a[136:139], v16 offset0:132 offset1:133
    ds_read2st64_b64 a[152:155], v16 offset0:140 offset1:141
    ds_read2st64_b64 a[140:143], v16 offset0:134 offset1:135
    ds_read2st64_b64 a[156:159], v16 offset0:142 offset1:143
    v_add_u32 v6, s86, v11
    s_waitcnt lgkmcnt(0)
    v_mfma_f32_16x16x32_bf16 v[64:67], v[160:163], a[128:131], v[64:67]
    ds_read_b64_tr_b16 v[40:41], v6 offset:0
    v_add_u32 v7, s86, v13
    v_mfma_f32_16x16x32_bf16 v[64:67], v[164:167], a[144:147], v[64:67]
    s_add_u32 m0, s47, s87
    v_mfma_f32_16x16x32_bf16 v[68:71], v[160:163], a[132:135], v[68:71]
    ds_read_b64_tr_b16 v[42:43], v6 offset:2048
    buffer_load_dwordx4 v10, s[28:31], s48 offen lds
    v_mfma_f32_16x16x32_bf16 v[68:71], v[164:167], a[148:151], v[68:71]
    v_mfma_f32_16x16x32_bf16 v[72:75], v[160:163], a[136:139], v[72:75]
    ds_read_b64_tr_b16 v[44:45], v6 offset:4096
    v_mfma_f32_16x16x32_bf16 v[72:75], v[164:167], a[152:155], v[72:75]
    v_mfma_f32_16x16x32_bf16 v[76:79], v[160:163], a[140:143], v[76:79]
    ds_read_b64_tr_b16 v[46:47], v6 offset:6144
    buffer_load_dwordx4 v38, s[28:31], s48 offen offset:1024 lds
    s_add_u32 s48, s48, 0x12000
    s_add_u32 s86, s86, 8192
    s_cmp_ge_u32 s86, 73728
    s_cselect_b32 s86, 0, s86
    v_mfma_f32_16x16x32_bf16 v[76:79], v[164:167], a[156:159], v[76:79]
    s_add_u32 s87, s87, 8192
    s_cmp_ge_u32 s87, 73728
    s_cselect_b32 s87, 0, s87
    v_mfma_f32_16x16x32_bf16 v[80:83], v[168:171], a[128:131], v[80:83]
    ds_read_b64_tr_b16 v[48:49], v7 offset:0
    v_cvt_pk_bf16_f32 v192, v64, v65
    v_cvt_pk_bf16_f32 v193, v66, v67
    v_mfma_f32_16x16x32_bf16 v[80:83], v[172:175], a[144:147], v[80:83]
    v_mfma_f32_16x16x32_bf16 v[84:87], v[168:171], a[132:135], v[84:87]
    ds_read_b64_tr_b16 v[50:51], v7 offset:2048
    v_cvt_pk_bf16_f32 v194, v68, v69
    v_cvt_pk_bf16_f32 v195, v70, v71
    v_mfma_f32_16x16x32_bf16 v[84:87], v[172:175], a[148:151], v[84:87]
    v_mfma_f32_16x16x32_bf16 v[88:91], v[168:171], a[136:139], v[88:91]
    ds_read_b64_tr_b16 v[52:53], v7 offset:4096
    v_cvt_pk_bf16_f32 v196, v72, v73
    v_cvt_pk_bf16_f32 v197, v74, v75
    v_mfma_f32_16x16x32_bf16 v[88:91], v[172:175], a[152:155], v[88:91]
    buffer_store_dwordx4 v[192:195], v18, s[40:43], s76 offen sc0 sc1
    s_add_u32 s76, s76, s55
    v_mfma_f32_16x16x32_bf16 v[92:95], v[168:171], a[140:143], v[92:95]
    ds_read_b64_tr_b16 v[54:55], v7 offset:6144
    v_mfma_f32_16x16x32_bf16 v[92:95], v[172:175], a[156:159], v[92:95]
    v_cvt_pk_bf16_f32 v198, v76, v77
    v_cvt_pk_bf16_f32 v199, v78, v79
    buffer_store_dwordx4 v[196:199], v18, s[40:43], s77 offen sc0 sc1
    s_add_u32 s77, s77, s55
    v_and_b32 v39, 0x02000200, v39
    v_cmp_ne_u32 vcc, 0x02000200, v39
    s_nop 4
    s_cmp_eq_u64 vcc, 0
    s_cselect_b32 s56, 128, 0
    s_mov_b32 s57, 0
K1_POLL5:
    s_cmp_ge_u32 s56, 128
    s_cbranch_scc1 K1_READY5
    s_add_u32 s57, s57, 1
    s_cmp_ge_u32 s57, 0x200000
    s_cbranch_scc1 K1_READY5
    s_sleep 8
    buffer_load_dword v39, v5, s[12:15], 0 offen sc1
    s_waitcnt vmcnt(0)
    v_and_b32 v39, 0x02000200, v39
    v_cmp_ne_u32 vcc, 0x02000200, v39
    s_nop 4
    s_cmp_eq_u64 vcc, 0
    s_cselect_b32 s56, 128, 0
    s_branch K1_POLL5
K1_READY5:
    s_lshl_b32 s56, s44, 6
    s_lshl_b32 s57, s17, 3
    s_sub_u32 s57, s57, 8
    s_mul_i32 s57, s57, 110592
    s_mov_b32 s58, 14564
    s_mov_b32 s59, 109440
    v_add_u32 v2, s56, v1
    v_mul_u32_u24 v3, s58, v2
    v_lshrrev_b32 v3, 20, v3
    v_lshlrev_b32 v4, 4, v2
    v_mad_u32_u24 v4, v3, s59, v4
    v_add_u32 v176, s57, v4
    v_mul_u32_u24 v3, 72, v3
    v_sub_u32 v3, v2, v3
    v_bfe_u32 v3, v3, 4, 2
    v_lshlrev_b32 v3, 4, v3
    v_xor_b32 v181, v176, v3
    v_add_u32 v186, 884736, v176
    v_add_u32 v2, s56, v1
    v_add_u32 v2, 256, v2
    v_mul_u32_u24 v3, s58, v2
    v_lshrrev_b32 v3, 20, v3
    v_lshlrev_b32 v4, 4, v2
    v_mad_u32_u24 v4, v3, s59, v4
    v_add_u32 v177, s57, v4
    v_mul_u32_u24 v3, 72, v3
    v_sub_u32 v3, v2, v3
    v_bfe_u32 v3, v3, 4, 2
    v_lshlrev_b32 v3, 4, v3
    v_xor_b32 v182, v177, v3
    v_add_u32 v187, 884736, v177
    v_add_u32 v2, s56, v1
    v_add_u32 v2, 512, v2
    v_mul_u32_u24 v3, s58, v2
    v_lshrrev_b32 v3, 20, v3
    v_lshlrev_b32 v4, 4, v2
    v_mad_u32_u24 v4, v3, s59, v4
    v_add_u32 v178, s57, v4
    v_mul_u32_u24 v3, 72, v3
    v_sub_u32 v3, v2, v3
    v_bfe_u32 v3, v3, 4, 2
    v_lshlrev_b32 v3, 4, v3
    v_xor_b32 v183, v178, v3
    v_add_u32 v188, 884736, v178
    v_add_u32 v2, s56, v1
    v_add_u32 v2, 768, v2
    v_mul_u32_u24 v3, s58, v2
    v_lshrrev_b32 v3, 20, v3
    v_lshlrev_b32 v4, 4, v2
    v_mad_u32_u24 v4, v3, s59, v4
    v_add_u32 v179, s57, v4
    v_mul_u32_u24 v3, 72, v3
    v_sub_u32 v3, v2, v3
    v_bfe_u32 v3, v3, 4, 2
    v_lshlrev_b32 v3, 4, v3
    v_xor_b32 v184, v179, v3
    v_add_u32 v2, s56, v1
    v_add_u32 v2, 1024, v2
    v_mul_u32_u24 v3, s58, v2
    v_lshrrev_b32 v3, 20, v3
    v_lshlrev_b32 v4, 4, v2
    v_mad_u32_u24 v4, v3, s59, v4
    v_add_u32 v180, s57, v4
    v_mul_u32_u24 v3, 72, v3
    v_sub_u32 v3, v2, v3
    v_bfe_u32 v3, v3, 4, 2
    v_lshlrev_b32 v3, 4, v3
    v_xor_b32 v185, v180, v3
    s_mul_i32 s72, s16, 1152
    s_add_u32 s73, s72, 36864
    s_add_u32 s74, s72, 73728
    s_lshl_b32 s3, s44, 10
    s_waitcnt lgkmcnt(4)
    v_add_u32 v6, s86, v11
    v_mfma_f32_16x16x32_bf16 v[64:67], v[40:43], a[0:3], 0
    ds_read_b64_tr_b16 v[56:57], v6 offset:0
    v_add_u32 v7, s86, v13
    v_mfma_f32_16x16x32_bf16 v[64:67], v[44:47], a[16:19], v[64:67]
    v_cvt_pk_bf16_f32 v200, v80, v81
    v_cvt_pk_bf16_f32 v201, v82, v83
    s_add_u32 m0, s47, s87
    v_mfma_f32_16x16x32_bf16 v[68:71], v[40:43], a[4:7], 0
    ds_read_b64_tr_b16 v[58:59], v6 offset:2048
    buffer_load_dwordx4 v10, s[28:31], s48 offen lds
    v_mfma_f32_16x16x32_bf16 v[68:71], v[44:47], a[20:23], v[68:71]
    v_cvt_pk_bf16_f32 v202, v84, v85
    v_cvt_pk_bf16_f32 v203, v86, v87
    v_mfma_f32_16x16x32_bf16 v[72:75], v[40:43], a[8:11], 0
    ds_read_b64_tr_b16 v[60:61], v6 offset:4096
    v_mfma_f32_16x16x32_bf16 v[72:75], v[44:47], a[24:27], v[72:75]
    v_cvt_pk_bf16_f32 v204, v88, v89
    v_cvt_pk_bf16_f32 v205, v90, v91
    v_mfma_f32_16x16x32_bf16 v[76:79], v[40:43], a[12:15], 0
    ds_read_b64_tr_b16 v[62:63], v6 offset:6144
    buffer_load_dwordx4 v38, s[28:31], s48 offen offset:1024 lds
    v_mfma_f32_16x16x32_bf16 v[76:79], v[44:47], a[28:31], v[76:79]
    s_add_u32 s48, s48, 0x12000
    s_waitcnt lgkmcnt(4)
    v_mfma_f32_16x16x32_bf16 v[80:83], v[48:51], a[0:3], 0
    ds_read_b64_tr_b16 v[160:161], v7 offset:0
    s_add_u32 s86, s86, 8192
    v_mfma_f32_16x16x32_bf16 v[80:83], v[52:55], a[16:19], v[80:83]
    v_cvt_pk_bf16_f32 v206, v92, v93
    v_cvt_pk_bf16_f32 v207, v94, v95
    s_cmp_ge_u32 s86, 73728
    s_cselect_b32 s86, 0, s86
    v_mfma_f32_16x16x32_bf16 v[84:87], v[48:51], a[4:7], 0
    ds_read_b64_tr_b16 v[162:163], v7 offset:2048
    s_add_u32 s87, s87, 8192
    v_mfma_f32_16x16x32_bf16 v[84:87], v[52:55], a[20:23], v[84:87]
    s_cmp_ge_u32 s87, 73728
    s_cselect_b32 s87, 0, s87
    v_mfma_f32_16x16x32_bf16 v[88:91], v[48:51], a[8:11], 0
    ds_read_b64_tr_b16 v[164:165], v7 offset:4096
    v_mfma_f32_16x16x32_bf16 v[88:91], v[52:55], a[24:27], v[88:91]
    buffer_store_dwordx4 v[200:203], v18, s[40:43], s78 offen sc0 sc1
    s_add_u32 s78, s78, s50
    v_mfma_f32_16x16x32_bf16 v[92:95], v[48:51], a[12:15], 0
    ds_read_b64_tr_b16 v[166:167], v7 offset:6144
    v_mfma_f32_16x16x32_bf16 v[92:95], v[52:55], a[28:31], v[92:95]
    s_waitcnt vmcnt(9) lgkmcnt(4)
    s_barrier
    v_add_u32 v6, s86, v11
    v_mfma_f32_16x16x32_bf16 v[64:67], v[56:59], a[32:35], v[64:67]
    ds_read_b64_tr_b16 v[168:169], v6 offset:0
    v_add_u32 v7, s86, v13
    v_mfma_f32_16x16x32_bf16 v[64:67], v[60:63], a[48:51], v[64:67]
    s_add_u32 m0, s47, s87
    v_mfma_f32_16x16x32_bf16 v[68:71], v[56:59], a[36:39], v[68:71]
    ds_read_b64_tr_b16 v[170:171], v6 offset:2048
    buffer_load_dwordx4 v10, s[28:31], s48 offen lds
    v_mfma_f32_16x16x32_bf16 v[68:71], v[60:63], a[52:55], v[68:71]
    v_mfma_f32_16x16x32_bf16 v[72:75], v[56:59], a[40:43], v[72:75]
    ds_read_b64_tr_b16 v[172:173], v6 offset:4096
    buffer_load_dwordx4 v38, s[28:31], s48 offen offset:1024 lds
    v_mfma_f32_16x16x32_bf16 v[72:75], v[60:63], a[56:59], v[72:75]
    buffer_store_dwordx4 v[204:207], v18, s[40:43], s79 offen sc0 sc1
    s_add_u32 s79, s79, s50
    s_add_u32 s48, s48, 0x12000
    v_mfma_f32_16x16x32_bf16 v[76:79], v[56:59], a[44:47], v[76:79]
    ds_read_b64_tr_b16 v[174:175], v6 offset:6144
    s_add_u32 s86, s86, 8192
    v_mfma_f32_16x16x32_bf16 v[76:79], v[60:63], a[60:63], v[76:79]
    s_cmp_ge_u32 s86, 73728
    s_cselect_b32 s86, 0, s86
    s_waitcnt lgkmcnt(4)
    v_mfma_f32_16x16x32_bf16 v[80:83], v[160:163], a[32:35], v[80:83]
    ds_read_b64_tr_b16 v[40:41], v7 offset:0
    s_add_u32 s87, s87, 8192
    v_mfma_f32_16x16x32_bf16 v[80:83], v[164:167], a[48:51], v[80:83]
    s_cmp_ge_u32 s87, 73728
    s_cselect_b32 s87, 0, s87
    v_mfma_f32_16x16x32_bf16 v[84:87], v[160:163], a[36:39], v[84:87]
    ds_read_b64_tr_b16 v[42:43], v7 offset:2048
    s_add_u32 m0, s3, 86016
    v_mfma_f32_16x16x32_bf16 v[84:87], v[164:167], a[52:55], v[84:87]
    buffer_load_dwordx4 v176, s[4:7], s73 offen sc1 lds
    s_add_u32 m0, s3, 90112
    v_mfma_f32_16x16x32_bf16 v[88:91], v[160:163], a[40:43], v[88:91]
    ds_read_b64_tr_b16 v[44:45], v7 offset:4096
    v_mfma_f32_16x16x32_bf16 v[88:91], v[164:167], a[56:59], v[88:91]
    buffer_load_dwordx4 v177, s[4:7], s73 offen sc1 lds
    s_add_u32 m0, s3, 94208
    v_mfma_f32_16x16x32_bf16 v[92:95], v[160:163], a[44:47], v[92:95]
    ds_read_b64_tr_b16 v[46:47], v7 offset:6144
    v_mfma_f32_16x16x32_bf16 v[92:95], v[164:167], a[60:63], v[92:95]
    buffer_load_dwordx4 v178, s[4:7], s73 offen sc1 lds
    s_waitcnt lgkmcnt(4)
    v_add_u32 v6, s86, v11
    v_mfma_f32_16x16x32_bf16 v[64:67], v[168:171], a[64:67], v[64:67]
    ds_read_b64_tr_b16 v[48:49], v6 offset:0
    v_add_u32 v7, s86, v13
    s_add_u32 m0, s47, s87
    v_mfma_f32_16x16x32_bf16 v[64:67], v[172:175], a[80:83], v[64:67]
    buffer_load_dwordx4 v10, s[28:31], s48 offen lds
    v_mfma_f32_16x16x32_bf16 v[68:71], v[168:171], a[68:71], v[68:71]
    ds_read_b64_tr_b16 v[50:51], v6 offset:2048
    v_mfma_f32_16x16x32_bf16 v[68:71], v[172:175], a[84:87], v[68:71]
    buffer_load_dwordx4 v38, s[28:31], s48 offen offset:1024 lds
    s_add_u32 s48, s48, s54
    s_add_u32 s86, s86, 8192
    v_mfma_f32_16x16x32_bf16 v[72:75], v[168:171], a[72:75], v[72:75]
    ds_read_b64_tr_b16 v[52:53], v6 offset:4096
    s_cmp_ge_u32 s86, 73728
    s_cselect_b32 s86, 0, s86
    v_mfma_f32_16x16x32_bf16 v[72:75], v[172:175], a[88:91], v[72:75]
    s_add_u32 s87, s87, 8192
    s_cmp_ge_u32 s87, 73728
    s_cselect_b32 s87, 0, s87
    v_mfma_f32_16x16x32_bf16 v[76:79], v[168:171], a[76:79], v[76:79]
    ds_read_b64_tr_b16 v[54:55], v6 offset:6144
    s_add_u32 m0, s3, 98304
    v_mfma_f32_16x16x32_bf16 v[76:79], v[172:175], a[92:95], v[76:79]
    buffer_load_dwordx4 v179, s[4:7], s73 offen sc1 lds
    s_waitcnt lgkmcnt(4)
    v_mfma_f32_16x16x32_bf16 v[80:83], v[40:43], a[64:67], v[80:83]
    ds_read_b64_tr_b16 v[56:57], v7 offset:0
    s_add_u32 m0, s3, 102400
    v_mfma_f32_16x16x32_bf16 v[80:83], v[44:47], a[80:83], v[80:83]
    buffer_load_dwordx4 v180, s[4:7], s73 offen sc1 lds
    s_add_u32 m0, s3, 73728
    v_mfma_f32_16x16x32_bf16 v[84:87], v[40:43], a[68:71], v[84:87]
    ds_read_b64_tr_b16 v[58:59], v7 offset:2048
    v_mfma_f32_16x16x32_bf16 v[84:87], v[44:47], a[84:87], v[84:87]
    buffer_load_dwordx4 v186, s[4:7], s72 offen sc1 lds
    s_add_u32 m0, s3, 77824
    v_mfma_f32_16x16x32_bf16 v[88:91], v[40:43], a[72:75], v[88:91]
    ds_read_b64_tr_b16 v[60:61], v7 offset:4096
    v_mfma_f32_16x16x32_bf16 v[88:91], v[44:47], a[88:91], v[88:91]
    buffer_load_dwordx4 v187, s[4:7], s72 offen sc1 lds
    v_mfma_f32_16x16x32_bf16 v[92:95], v[40:43], a[76:79], v[92:95]
    ds_read_b64_tr_b16 v[62:63], v7 offset:6144
    v_mfma_f32_16x16x32_bf16 v[92:95], v[44:47], a[92:95], v[92:95]
    s_waitcnt vmcnt(19) lgkmcnt(4)
    s_barrier
    v_add_u32 v6, s86, v11
    v_mfma_f32_16x16x32_bf16 v[64:67], v[48:51], a[96:99], v[64:67]
    ds_read_b64_tr_b16 v[160:161], v6 offset:0
    v_add_u32 v7, s86, v13
    v_mfma_f32_16x16x32_bf16 v[64:67], v[52:55], a[112:115], v[64:67]
    s_add_u32 m0, s47, s87
    v_mfma_f32_16x16x32_bf16 v[68:71], v[48:51], a[100:103], v[68:71]
    ds_read_b64_tr_b16 v[162:163], v6 offset:2048
    buffer_load_dwordx4 v10, s[28:31], s48 offen lds
    v_mfma_f32_16x16x32_bf16 v[68:71], v[52:55], a[116:119], v[68:71]
    v_mfma_f32_16x16x32_bf16 v[72:75], v[48:51], a[104:107], v[72:75]
    ds_read_b64_tr_b16 v[164:165], v6 offset:4096
    buffer_load_dwordx4 v38, s[28:31], s48 offen offset:1024 lds
    v_mfma_f32_16x16x32_bf16 v[72:75], v[52:55], a[120:123], v[72:75]
    s_add_u32 s48, s48, 0x12000
    s_add_u32 s86, s86, 8192
    v_mfma_f32_16x16x32_bf16 v[76:79], v[48:51], a[108:111], v[76:79]
    ds_read_b64_tr_b16 v[166:167], v6 offset:6144
    s_cmp_ge_u32 s86, 73728
    s_cselect_b32 s86, 0, s86
    v_mfma_f32_16x16x32_bf16 v[76:79], v[52:55], a[124:127], v[76:79]
    s_add_u32 s87, s87, 8192
    s_waitcnt lgkmcnt(4)
    v_mfma_f32_16x16x32_bf16 v[80:83], v[56:59], a[96:99], v[80:83]
    ds_read_b64_tr_b16 v[168:169], v7 offset:0
    s_cmp_ge_u32 s87, 73728
    s_cselect_b32 s87, 0, s87
    v_mfma_f32_16x16x32_bf16 v[80:83], v[60:63], a[112:115], v[80:83]
    s_add_u32 m0, s3, 81920
    v_mfma_f32_16x16x32_bf16 v[84:87], v[56:59], a[100:103], v[84:87]
    ds_read_b64_tr_b16 v[170:171], v7 offset:2048
    buffer_load_dwordx4 v188, s[4:7], s72 offen sc1 lds
    v_mfma_f32_16x16x32_bf16 v[84:87], v[60:63], a[116:119], v[84:87]
    s_add_u32 m0, s3, 106496
    v_mfma_f32_16x16x32_bf16 v[88:91], v[56:59], a[104:107], v[88:91]
    ds_read_b64_tr_b16 v[172:173], v7 offset:4096
    buffer_load_dwordx4 v181, s[4:7], s74 offen sc1 lds
    v_mfma_f32_16x16x32_bf16 v[88:91], v[60:63], a[120:123], v[88:91]
    s_add_u32 m0, s3, 110592
    v_mfma_f32_16x16x32_bf16 v[92:95], v[56:59], a[108:111], v[92:95]
    ds_read_b64_tr_b16 v[174:175], v7 offset:6144
    buffer_load_dwordx4 v182, s[4:7], s74 offen sc1 lds
    v_mfma_f32_16x16x32_bf16 v[92:95], v[60:63], a[124:127], v[92:95]
    s_waitcnt vmcnt(20) lgkmcnt(4)
    s_barrier
    v_add_u32 v6, s86, v11
    v_mfma_f32_16x16x32_bf16 v[64:67], v[160:163], a[128:131], v[64:67]
    ds_read_b64_tr_b16 v[40:41], v6 offset:0
    v_add_u32 v7, s86, v13
    v_mfma_f32_16x16x32_bf16 v[64:67], v[164:167], a[144:147], v[64:67]
    s_add_u32 m0, s47, s87
    v_mfma_f32_16x16x32_bf16 v[68:71], v[160:163], a[132:135], v[68:71]
    ds_read_b64_tr_b16 v[42:43], v6 offset:2048
    buffer_load_dwordx4 v10, s[28:31], s48 offen lds
    v_mfma_f32_16x16x32_bf16 v[68:71], v[164:167], a[148:151], v[68:71]
    v_mfma_f32_16x16x32_bf16 v[72:75], v[160:163], a[136:139], v[72:75]
    ds_read_b64_tr_b16 v[44:45], v6 offset:4096
    buffer_load_dwordx4 v38, s[28:31], s48 offen offset:1024 lds
    v_mfma_f32_16x16x32_bf16 v[72:75], v[164:167], a[152:155], v[72:75]
    s_add_u32 s48, s48, 0x12000
    s_add_u32 s86, s86, 8192
    v_mfma_f32_16x16x32_bf16 v[76:79], v[160:163], a[140:143], v[76:79]
    ds_read_b64_tr_b16 v[46:47], v6 offset:6144
    s_cmp_ge_u32 s86, 73728
    s_cselect_b32 s86, 0, s86
    v_mfma_f32_16x16x32_bf16 v[76:79], v[164:167], a[156:159], v[76:79]
    s_add_u32 s87, s87, 8192
    s_waitcnt lgkmcnt(4)
    v_mfma_f32_16x16x32_bf16 v[80:83], v[168:171], a[128:131], v[80:83]
    ds_read_b64_tr_b16 v[48:49], v7 offset:0
    v_cvt_pk_bf16_f32 v192, v64, v65
    v_cvt_pk_bf16_f32 v193, v66, v67
    s_cmp_ge_u32 s87, 73728
    s_cselect_b32 s87, 0, s87
    v_mfma_f32_16x16x32_bf16 v[80:83], v[172:175], a[144:147], v[80:83]
    s_add_u32 m0, s3, 114688
    v_mfma_f32_16x16x32_bf16 v[84:87], v[168:171], a[132:135], v[84:87]
    ds_read_b64_tr_b16 v[50:51], v7 offset:2048
    v_cvt_pk_bf16_f32 v194, v68, v69
    v_cvt_pk_bf16_f32 v195, v70, v71
    buffer_load_dwordx4 v183, s[4:7], s74 offen sc1 lds
    v_mfma_f32_16x16x32_bf16 v[84:87], v[172:175], a[148:151], v[84:87]
    s_add_u32 m0, s3, 118784
    v_mfma_f32_16x16x32_bf16 v[88:91], v[168:171], a[136:139], v[88:91]
    ds_read_b64_tr_b16 v[52:53], v7 offset:4096
    v_cvt_pk_bf16_f32 v196, v72, v73
    v_cvt_pk_bf16_f32 v197, v74, v75
    buffer_load_dwordx4 v184, s[4:7], s74 offen sc1 lds
    v_mfma_f32_16x16x32_bf16 v[88:91], v[172:175], a[152:155], v[88:91]
    buffer_store_dwordx4 v[192:195], v18, s[40:43], s76 offen sc0 sc1
    s_add_u32 s76, s76, s55
    s_add_u32 m0, s3, 122880
    v_mfma_f32_16x16x32_bf16 v[92:95], v[168:171], a[140:143], v[92:95]
    ds_read_b64_tr_b16 v[54:55], v7 offset:6144
    buffer_load_dwordx4 v185, s[4:7], s74 offen sc1 lds
    v_mfma_f32_16x16x32_bf16 v[92:95], v[172:175], a[156:159], v[92:95]
    v_cvt_pk_bf16_f32 v198, v76, v77
    v_cvt_pk_bf16_f32 v199, v78, v79
    buffer_store_dwordx4 v[196:199], v18, s[40:43], s77 offen sc0 sc1
    s_add_u32 s77, s77, s55
K1_DL5:
    s_waitcnt lgkmcnt(4)
    v_add_u32 v6, s86, v11
    v_mfma_f32_16x16x32_bf16 v[64:67], v[40:43], a[0:3], 0
    ds_read_b64_tr_b16 v[56:57], v6 offset:0
    v_add_u32 v7, s86, v13
    v_mfma_f32_16x16x32_bf16 v[64:67], v[44:47], a[16:19], v[64:67]
    v_cvt_pk_bf16_f32 v200, v80, v81
    v_cvt_pk_bf16_f32 v201, v82, v83
    s_add_u32 m0, s47, s87
    v_mfma_f32_16x16x32_bf16 v[68:71], v[40:43], a[4:7], 0
    ds_read_b64_tr_b16 v[58:59], v6 offset:2048
    buffer_load_dwordx4 v10, s[28:31], s48 offen lds
    v_mfma_f32_16x16x32_bf16 v[68:71], v[44:47], a[20:23], v[68:71]
    v_cvt_pk_bf16_f32 v202, v84, v85
    v_cvt_pk_bf16_f32 v203, v86, v87
    v_mfma_f32_16x16x32_bf16 v[72:75], v[40:43], a[8:11], 0
    ds_read_b64_tr_b16 v[60:61], v6 offset:4096
    v_mfma_f32_16x16x32_bf16 v[72:75], v[44:47], a[24:27], v[72:75]
    v_cvt_pk_bf16_f32 v204, v88, v89
    v_cvt_pk_bf16_f32 v205, v90, v91
    v_mfma_f32_16x16x32_bf16 v[76:79], v[40:43], a[12:15], 0
    ds_read_b64_tr_b16 v[62:63], v6 offset:6144
    buffer_load_dwordx4 v38, s[28:31], s48 offen offset:1024 lds
    v_mfma_f32_16x16x32_bf16 v[76:79], v[44:47], a[28:31], v[76:79]
    s_add_u32 s48, s48, 0x12000
    s_waitcnt lgkmcnt(4)
    v_mfma_f32_16x16x32_bf16 v[80:83], v[48:51], a[0:3], 0
    ds_read_b64_tr_b16 v[160:161], v7 offset:0
    s_add_u32 s86, s86, 8192
    v_mfma_f32_16x16x32_bf16 v[80:83], v[52:55], a[16:19], v[80:83]
    v_cvt_pk_bf16_f32 v206, v92, v93
    v_cvt_pk_bf16_f32 v207, v94, v95
    s_cmp_ge_u32 s86, 73728
    s_cselect_b32 s86, 0, s86
    v_mfma_f32_16x16x32_bf16 v[84:87], v[48:51], a[4:7], 0
    ds_read_b64_tr_b16 v[162:163], v7 offset:2048
    s_add_u32 s87, s87, 8192
    v_mfma_f32_16x16x32_bf16 v[84:87], v[52:55], a[20:23], v[84:87]
    s_cmp_ge_u32 s87, 73728
    s_cselect_b32 s87, 0, s87
    v_mfma_f32_16x16x32_bf16 v[88:91], v[48:51], a[8:11], 0
    ds_read_b64_tr_b16 v[164:165], v7 offset:4096
    v_mfma_f32_16x16x32_bf16 v[88:91], v[52:55], a[24:27], v[88:91]
    buffer_store_dwordx4 v[200:203], v18, s[40:43], s78 offen sc0 sc1
    s_add_u32 s78, s78, s50
    v_mfma_f32_16x16x32_bf16 v[92:95], v[48:51], a[12:15], 0
    ds_read_b64_tr_b16 v[166:167], v7 offset:6144
    v_mfma_f32_16x16x32_bf16 v[92:95], v[52:55], a[28:31], v[92:95]
    s_waitcnt vmcnt(9) lgkmcnt(4)
    s_barrier
    v_add_u32 v6, s86, v11
    v_mfma_f32_16x16x32_bf16 v[64:67], v[56:59], a[32:35], v[64:67]
    ds_read_b64_tr_b16 v[168:169], v6 offset:0
    v_add_u32 v7, s86, v13
    v_mfma_f32_16x16x32_bf16 v[64:67], v[60:63], a[48:51], v[64:67]
    s_add_u32 m0, s47, s87
    v_mfma_f32_16x16x32_bf16 v[68:71], v[56:59], a[36:39], v[68:71]
    ds_read_b64_tr_b16 v[170:171], v6 offset:2048
    buffer_load_dwordx4 v10, s[28:31], s48 offen lds
    v_mfma_f32_16x16x32_bf16 v[68:71], v[60:63], a[52:55], v[68:71]
    v_mfma_f32_16x16x32_bf16 v[72:75], v[56:59], a[40:43], v[72:75]
    ds_read_b64_tr_b16 v[172:173], v6 offset:4096
    v_mfma_f32_16x16x32_bf16 v[72:75], v[60:63], a[56:59], v[72:75]
    buffer_store_dwordx4 v[204:207], v18, s[40:43], s79 offen sc0 sc1
    s_add_u32 s79, s79, s50
    v_mfma_f32_16x16x32_bf16 v[76:79], v[56:59], a[44:47], v[76:79]
    ds_read_b64_tr_b16 v[174:175], v6 offset:6144
    buffer_load_dwordx4 v38, s[28:31], s48 offen offset:1024 lds
    v_mfma_f32_16x16x32_bf16 v[76:79], v[60:63], a[60:63], v[76:79]
    s_add_u32 s48, s48, 0x12000
    s_waitcnt lgkmcnt(4)
    v_mfma_f32_16x16x32_bf16 v[80:83], v[160:163], a[32:35], v[80:83]
    ds_read_b64_tr_b16 v[40:41], v7 offset:0
    s_add_u32 s86, s86, 8192
    v_mfma_f32_16x16x32_bf16 v[80:83], v[164:167], a[48:51], v[80:83]
    s_cmp_ge_u32 s86, 73728
    s_cselect_b32 s86, 0, s86
    v_mfma_f32_16x16x32_bf16 v[84:87], v[160:163], a[36:39], v[84:87]
    ds_read_b64_tr_b16 v[42:43], v7 offset:2048
    s_add_u32 s87, s87, 8192
    v_mfma_f32_16x16x32_bf16 v[84:87], v[164:167], a[52:55], v[84:87]
    s_cmp_ge_u32 s87, 73728
    s_cselect_b32 s87, 0, s87
    v_mfma_f32_16x16x32_bf16 v[88:91], v[160:163], a[40:43], v[88:91]
    ds_read_b64_tr_b16 v[44:45], v7 offset:4096
    v_mfma_f32_16x16x32_bf16 v[88:91], v[164:167], a[56:59], v[88:91]
    v_mfma_f32_16x16x32_bf16 v[92:95], v[160:163], a[44:47], v[92:95]
    ds_read_b64_tr_b16 v[46:47], v7 offset:6144
    v_mfma_f32_16x16x32_bf16 v[92:95], v[164:167], a[60:63], v[92:95]
    s_waitcnt lgkmcnt(4)
    v_add_u32 v6, s86, v11
    v_mfma_f32_16x16x32_bf16 v[64:67], v[168:171], a[64:67], v[64:67]
    ds_read_b64_tr_b16 v[48:49], v6 offset:0
    v_add_u32 v7, s86, v13
    v_mfma_f32_16x16x32_bf16 v[64:67], v[172:175], a[80:83], v[64:67]
    s_add_u32 m0, s47, s87
    v_mfma_f32_16x16x32_bf16 v[68:71], v[168:171], a[68:71], v[68:71]
    ds_read_b64_tr_b16 v[50:51], v6 offset:2048
    buffer_load_dwordx4 v10, s[28:31], s48 offen lds
    v_mfma_f32_16x16x32_bf16 v[68:71], v[172:175], a[84:87], v[68:71]
    v_mfma_f32_16x16x32_bf16 v[72:75], v[168:171], a[72:75], v[72:75]
    ds_read_b64_tr_b16 v[52:53], v6 offset:4096
    v_mfma_f32_16x16x32_bf16 v[72:75], v[172:175], a[88:91], v[72:75]
    v_mfma_f32_16x16x32_bf16 v[76:79], v[168:171], a[76:79], v[76:79]
    ds_read_b64_tr_b16 v[54:55], v6 offset:6144
    buffer_load_dwordx4 v38, s[28:31], s48 offen offset:1024 lds
    v_mfma_f32_16x16x32_bf16 v[76:79], v[172:175], a[92:95], v[76:79]
    s_add_u32 s48, s48, s54
    s_waitcnt lgkmcnt(4)
    v_mfma_f32_16x16x32_bf16 v[80:83], v[40:43], a[64:67], v[80:83]
    ds_read_b64_tr_b16 v[56:57], v7 offset:0
    s_add_u32 s86, s86, 8192
    v_mfma_f32_16x16x32_bf16 v[80:83], v[44:47], a[80:83], v[80:83]
    s_cmp_ge_u32 s86, 73728
    s_cselect_b32 s86, 0, s86
    v_mfma_f32_16x16x32_bf16 v[84:87], v[40:43], a[68:71], v[84:87]
    ds_read_b64_tr_b16 v[58:59], v7 offset:2048
    s_add_u32 s87, s87, 8192
    v_mfma_f32_16x16x32_bf16 v[84:87], v[44:47], a[84:87], v[84:87]
    s_cmp_ge_u32 s87, 73728
    s_cselect_b32 s87, 0, s87
    v_mfma_f32_16x16x32_bf16 v[88:91], v[40:43], a[72:75], v[88:91]
    ds_read_b64_tr_b16 v[60:61], v7 offset:4096
    v_mfma_f32_16x16x32_bf16 v[88:91], v[44:47], a[88:91], v[88:91]
    v_mfma_f32_16x16x32_bf16 v[92:95], v[40:43], a[76:79], v[92:95]
    ds_read_b64_tr_b16 v[62:63], v7 offset:6144
    v_mfma_f32_16x16x32_bf16 v[92:95], v[44:47], a[92:95], v[92:95]
    s_waitcnt vmcnt(12) lgkmcnt(4)
    s_barrier
    v_add_u32 v6, s86, v11
    v_mfma_f32_16x16x32_bf16 v[64:67], v[48:51], a[96:99], v[64:67]
    ds_read_b64_tr_b16 v[160:161], v6 offset:0
    v_add_u32 v7, s86, v13
    v_mfma_f32_16x16x32_bf16 v[64:67], v[52:55], a[112:115], v[64:67]
    s_add_u32 m0, s47, s87
    v_mfma_f32_16x16x32_bf16 v[68:71], v[48:51], a[100:103], v[68:71]
    ds_read_b64_tr_b16 v[162:163], v6 offset:2048
    buffer_load_dwordx4 v10, s[28:31], s48 offen lds
    v_mfma_f32_16x16x32_bf16 v[68:71], v[52:55], a[116:119], v[68:71]
    v_mfma_f32_16x16x32_bf16 v[72:75], v[48:51], a[104:107], v[72:75]
    ds_read_b64_tr_b16 v[164:165], v6 offset:4096
    v_mfma_f32_16x16x32_bf16 v[72:75], v[52:55], a[120:123], v[72:75]
    v_mfma_f32_16x16x32_bf16 v[76:79], v[48:51], a[108:111], v[76:79]
    ds_read_b64_tr_b16 v[166:167], v6 offset:6144
    buffer_load_dwordx4 v38, s[28:31], s48 offen offset:1024 lds
    v_mfma_f32_16x16x32_bf16 v[76:79], v[52:55], a[124:127], v[76:79]
    s_add_u32 s48, s48, 0x12000
    s_waitcnt lgkmcnt(4)
    v_mfma_f32_16x16x32_bf16 v[80:83], v[56:59], a[96:99], v[80:83]
    ds_read_b64_tr_b16 v[168:169], v7 offset:0
    s_add_u32 s86, s86, 8192
    v_mfma_f32_16x16x32_bf16 v[80:83], v[60:63], a[112:115], v[80:83]
    s_cmp_ge_u32 s86, 73728
    s_cselect_b32 s86, 0, s86
    v_mfma_f32_16x16x32_bf16 v[84:87], v[56:59], a[100:103], v[84:87]
    ds_read_b64_tr_b16 v[170:171], v7 offset:2048
    s_add_u32 s87, s87, 8192
    v_mfma_f32_16x16x32_bf16 v[84:87], v[60:63], a[116:119], v[84:87]
    s_cmp_ge_u32 s87, 73728
    s_cselect_b32 s87, 0, s87
    v_mfma_f32_16x16x32_bf16 v[88:91], v[56:59], a[104:107], v[88:91]
    ds_read_b64_tr_b16 v[172:173], v7 offset:4096
    s_mov_b32 s56, 131072
    v_mfma_f32_16x16x32_bf16 v[88:91], v[60:63], a[120:123], v[88:91]
    s_cmp_eq_u32 s52, 5
    s_cselect_b32 s55, 0xfff90000, s56
    v_mfma_f32_16x16x32_bf16 v[92:95], v[56:59], a[108:111], v[92:95]
    ds_read_b64_tr_b16 v[174:175], v7 offset:6144
    v_mfma_f32_16x16x32_bf16 v[92:95], v[60:63], a[124:127], v[92:95]
    s_waitcnt vmcnt(10) lgkmcnt(4)
    s_barrier
    v_add_u32 v6, s86, v11
    v_mfma_f32_16x16x32_bf16 v[64:67], v[160:163], a[128:131], v[64:67]
    ds_read_b64_tr_b16 v[40:41], v6 offset:0
    v_add_u32 v7, s86, v13
    v_mfma_f32_16x16x32_bf16 v[64:67], v[164:167], a[144:147], v[64:67]
    s_add_u32 m0, s47, s87
    v_mfma_f32_16x16x32_bf16 v[68:71], v[160:163], a[132:135], v[68:71]
    ds_read_b64_tr_b16 v[42:43], v6 offset:2048
    buffer_load_dwordx4 v10, s[28:31], s48 offen lds
    v_mfma_f32_16x16x32_bf16 v[68:71], v[164:167], a[148:151], v[68:71]
    v_mfma_f32_16x16x32_bf16 v[72:75], v[160:163], a[136:139], v[72:75]
    ds_read_b64_tr_b16 v[44:45], v6 offset:4096
    v_mfma_f32_16x16x32_bf16 v[72:75], v[164:167], a[152:155], v[72:75]
    v_mfma_f32_16x16x32_bf16 v[76:79], v[160:163], a[140:143], v[76:79]
    ds_read_b64_tr_b16 v[46:47], v6 offset:6144
    buffer_load_dwordx4 v38, s[28:31], s48 offen offset:1024 lds
    v_mfma_f32_16x16x32_bf16 v[76:79], v[164:167], a[156:159], v[76:79]
    s_add_u32 s48, s48, 0x12000
    s_waitcnt lgkmcnt(4)
    v_mfma_f32_16x16x32_bf16 v[80:83], v[168:171], a[128:131], v[80:83]
    ds_read_b64_tr_b16 v[48:49], v7 offset:0
    v_cvt_pk_bf16_f32 v192, v64, v65
    v_cvt_pk_bf16_f32 v193, v66, v67
    s_add_u32 s86, s86, 8192
    v_mfma_f32_16x16x32_bf16 v[80:83], v[172:175], a[144:147], v[80:83]
    s_cmp_ge_u32 s86, 73728
    s_cselect_b32 s86, 0, s86
    v_mfma_f32_16x16x32_bf16 v[84:87], v[168:171], a[132:135], v[84:87]
    ds_read_b64_tr_b16 v[50:51], v7 offset:2048
    v_cvt_pk_bf16_f32 v194, v68, v69
    v_cvt_pk_bf16_f32 v195, v70, v71
    s_add_u32 s87, s87, 8192
    v_mfma_f32_16x16x32_bf16 v[84:87], v[172:175], a[148:151], v[84:87]
    s_cmp_ge_u32 s87, 73728
    s_cselect_b32 s87, 0, s87
    v_mfma_f32_16x16x32_bf16 v[88:91], v[168:171], a[136:139], v[88:91]
    ds_read_b64_tr_b16 v[52:53], v7 offset:4096
    v_cvt_pk_bf16_f32 v196, v72, v73
    v_cvt_pk_bf16_f32 v197, v74, v75
    s_mov_b32 s56, 0xfffb8100
    v_mfma_f32_16x16x32_bf16 v[88:91], v[172:175], a[152:155], v[88:91]
    buffer_store_dwordx4 v[192:195], v18, s[40:43], s76 offen sc0 sc1
    s_add_u32 s76, s76, s55
    s_cmp_eq_u32 s52, 7
    s_cselect_b32 s54, 0xfffb7c80, s56
    v_mfma_f32_16x16x32_bf16 v[92:95], v[168:171], a[140:143], v[92:95]
    ds_read_b64_tr_b16 v[54:55], v7 offset:6144
    s_mov_b32 s56, 131072
    v_mfma_f32_16x16x32_bf16 v[92:95], v[172:175], a[156:159], v[92:95]
    v_cvt_pk_bf16_f32 v198, v76, v77
    v_cvt_pk_bf16_f32 v199, v78, v79
    s_cmp_eq_u32 s52, 5
    s_cselect_b32 s50, 0xfff90000, s56
    buffer_store_dwordx4 v[196:199], v18, s[40:43], s77 offen sc0 sc1
    s_add_u32 s77, s77, s55
    s_cmp_lg_u32 s52, 4
    s_cbranch_scc1 ERP_1
    s_or_b32 s19, s19, 4
    s_cmp_lg_u32 s44, 0
    s_cbranch_scc1 PUB_2
    s_lshl_b32 s57, s64, 7
    s_add_u32 s57, s57, s65
    s_mov_b64 exec, 1
    v_mov_b32 v2, s19
    buffer_store_byte v2, v9, s[12:15], s57 offen sc0 sc1
    s_mov_b64 exec, -1
PUB_2:
ERP_1:
    s_sub_u32 s52, s52, 1
    s_cmp_lg_u32 s52, 0
    s_cbranch_scc1 K1_DL5
    s_branch K1_DEND
K1_D4:
    s_mov_b32 s54, 0xfffca100
    s_mov_b32 s55, 131072
    s_mov_b32 s50, 131072
    s_waitcnt lgkmcnt(4)
    v_add_u32 v6, s86, v11
    v_mfma_f32_16x16x32_bf16 v[64:67], v[40:43], a[0:3], 0
    ds_read_b64_tr_b16 v[56:57], v6 offset:0
    v_add_u32 v7, s86, v13
    s_add_u32 m0, s47, s87
    v_mfma_f32_16x16x32_bf16 v[64:67], v[44:47], a[16:19], v[64:67]
    ds_read2st64_b64 a[32:35], v16 offset0:32 offset1:33
    buffer_load_dwordx4 v10, s[28:31], s48 offen lds
    v_mfma_f32_16x16x32_bf16 v[68:71], v[40:43], a[4:7], 0
    ds_read_b64_tr_b16 v[58:59], v6 offset:2048
    v_mfma_f32_16x16x32_bf16 v[68:71], v[44:47], a[20:23], v[68:71]
    ds_read2st64_b64 a[48:51], v16 offset0:40 offset1:41
    v_mfma_f32_16x16x32_bf16 v[72:75], v[40:43], a[8:11], 0
    ds_read_b64_tr_b16 v[60:61], v6 offset:4096
    v_rcp_f32 v128, v128
    v_rcp_f32 v129, v129
    v_mfma_f32_16x16x32_bf16 v[72:75], v[44:47], a[24:27], v[72:75]
    ds_read2st64_b64 a[36:39], v16 offset0:34 offset1:35
    buffer_load_dwordx4 v38, s[28:31], s48 offen offset:1024 lds
    s_add_u32 s48, s48, s54
    s_add_u32 s86, s86, 8192
    s_cmp_ge_u32 s86, 73728
    s_cselect_b32 s86, 0, s86
    v_mfma_f32_16x16x32_bf16 v[76:79], v[40:43], a[12:15], 0
    ds_read_b64_tr_b16 v[62:63], v6 offset:6144
    s_add_u32 s87, s87, 8192
    s_cmp_ge_u32 s87, 73728
    s_cselect_b32 s87, 0, s87
    v_bfe_u32 v5, v1, 2, 2
    s_lshl_b32 s58, s17, 1
    v_mfma_f32_16x16x32_bf16 v[76:79], v[44:47], a[28:31], v[76:79]
    ds_read2st64_b64 a[52:55], v16 offset0:42 offset1:43
    s_sub_u32 s58, s58, 2
    v_add_u32 v5, s58, v5
    v_max_i32 v5, 0, v5
    v_lshlrev_b32 v5, 7, v5
    s_waitcnt lgkmcnt(8)
    v_mfma_f32_16x16x32_bf16 v[80:83], v[48:51], a[0:3], 0
    ds_read_b64_tr_b16 v[160:161], v7 offset:0
    v_and_b32 v4, 3, v1
    v_lshl_add_u32 v5, v4, 2, v5
    v_rcp_f32 v130, v130
    v_mfma_f32_16x16x32_bf16 v[80:83], v[52:55], a[16:19], v[80:83]
    ds_read2st64_b64 a[40:43], v16 offset0:36 offset1:37
    buffer_load_dword v39, v5, s[12:15], 0 offen sc1
    v_rcp_f32 v131, v131
    v_mul_f32 v128, v128, v96
    v_mfma_f32_16x16x32_bf16 v[84:87], v[48:51], a[4:7], 0
    ds_read_b64_tr_b16 v[162:163], v7 offset:2048
    v_rcp_f32 v144, v144
    v_rcp_f32 v145, v145
    v_mfma_f32_16x16x32_bf16 v[84:87], v[52:55], a[20:23], v[84:87]
    ds_read2st64_b64 a[56:59], v16 offset0:44 offset1:45
    v_rcp_f32 v146, v146
    v_rcp_f32 v147, v147
    v_mfma_f32_16x16x32_bf16 v[88:91], v[48:51], a[8:11], 0
    ds_read_b64_tr_b16 v[164:165], v7 offset:4096
    v_rcp_f32 v132, v132
    v_rcp_f32 v133, v133
    v_mfma_f32_16x16x32_bf16 v[88:91], v[52:55], a[24:27], v[88:91]
    ds_read2st64_b64 a[44:47], v16 offset0:38 offset1:39
    v_rcp_f32 v134, v134
    v_rcp_f32 v135, v135
    v_mfma_f32_16x16x32_bf16 v[92:95], v[48:51], a[12:15], 0
    ds_read_b64_tr_b16 v[166:167], v7 offset:6144
    v_rcp_f32 v148, v148
    v_rcp_f32 v149, v149
    v_mfma_f32_16x16x32_bf16 v[92:95], v[52:55], a[28:31], v[92:95]
    ds_read2st64_b64 a[60:63], v16 offset0:46 offset1:47
    v_rcp_f32 v150, v150
    v_mul_f32 v129, v129, v97
    s_waitcnt vmcnt(9) lgkmcnt(9)
    s_barrier
    v_add_u32 v6, s86, v11
    s_waitcnt lgkmcnt(0)
    v_mfma_f32_16x16x32_bf16 v[64:67], v[56:59], a[32:35], v[64:67]
    ds_read_b64_tr_b16 v[40:41], v6 offset:0
    v_add_u32 v7, s86, v13
    s_add_u32 m0, s47, s87
    v_rcp_f32 v151, v151
    v_mfma_f32_16x16x32_bf16 v[64:67], v[60:63], a[48:51], v[64:67]
    ds_read2st64_b64 a[64:67], v16 offset0:64 offset1:65
    buffer_load_dwordx4 v10, s[28:31], s48 offen lds
    v_rcp_f32 v136, v136
    v_mul_f32 v130, v130, v98
    v_mfma_f32_16x16x32_bf16 v[68:71], v[56:59], a[36:39], v[68:71]
    ds_read_b64_tr_b16 v[42:43], v6 offset:2048
    v_rcp_f32 v137, v137
    v_rcp_f32 v138, v138
    v_mfma_f32_16x16x32_bf16 v[68:71], v[60:63], a[52:55], v[68:71]
    ds_read2st64_b64 a[80:83], v16 offset0:72 offset1:73
    v_rcp_f32 v139, v139
    v_rcp_f32 v152, v152
    v_mfma_f32_16x16x32_bf16 v[72:75], v[56:59], a[40:43], v[72:75]
    ds_read_b64_tr_b16 v[44:45], v6 offset:4096
    v_rcp_f32 v153, v153
    v_rcp_f32 v154, v154
    v_mfma_f32_16x16x32_bf16 v[72:75], v[60:63], a[56:59], v[72:75]
    ds_read2st64_b64 a[68:71], v16 offset0:66 offset1:67
    buffer_load_dwordx4 v38, s[28:31], s48 offen offset:1024 lds
    s_add_u32 s48, s48, 0x12000
    s_add_u32 s86, s86, 8192
    s_cmp_ge_u32 s86, 73728
    s_cselect_b32 s86, 0, s86
    v_mfma_f32_16x16x32_bf16 v[76:79], v[56:59], a[44:47], v[76:79]
    ds_read_b64_tr_b16 v[46:47], v6 offset:6144
    s_add_u32 s87, s87, 8192
    s_cmp_ge_u32 s87, 73728
    s_cselect_b32 s87, 0, s87
    v_mul_f32 v131, v131, v99
    v_mfma_f32_16x16x32_bf16 v[76:79], v[60:63], a[60:63], v[76:79]
    ds_read2st64_b64 a[84:87], v16 offset0:74 offset1:75
    v_rcp_f32 v155, v155
    v_cvt_pk_bf16_f32 v240, v128, v129
    v_mfma_f32_16x16x32_bf16 v[80:83], v[160:163], a[32:35], v[80:83]
    ds_read_b64_tr_b16 v[48:49], v7 offset:0
    v_rcp_f32 v140, v140
    v_rcp_f32 v141, v141
    v_mfma_f32_16x16x32_bf16 v[80:83], v[164:167], a[48:51], v[80:83]
    ds_read2st64_b64 a[72:75], v16 offset0:68 offset1:69
    v_rcp_f32 v142, v142
    v_rcp_f32 v143, v143
    v_mfma_f32_16x16x32_bf16 v[84:87], v[160:163], a[36:39], v[84:87]
    ds_read_b64_tr_b16 v[50:51], v7 offset:2048
    v_rcp_f32 v156, v156
    v_rcp_f32 v157, v157
    v_mfma_f32_16x16x32_bf16 v[84:87], v[164:167], a[52:55], v[84:87]
    ds_read2st64_b64 a[88:91], v16 offset0:76 offset1:77
    v_rcp_f32 v158, v158
    v_rcp_f32 v159, v159
    v_mfma_f32_16x16x32_bf16 v[88:91], v[160:163], a[40:43], v[88:91]
    ds_read_b64_tr_b16 v[52:53], v7 offset:4096
    v_cvt_pk_bf16_f32 v241, v130, v131
    v_mul_f32 v144, v144, v112
    v_mul_f32 v145, v145, v113
    v_mul_f32 v146, v146, v114
    v_mfma_f32_16x16x32_bf16 v[88:91], v[164:167], a[56:59], v[88:91]
    ds_read2st64_b64 a[76:79], v16 offset0:70 offset1:71
    ds_write_b64 v15, v[240:241] offset:0
    v_mul_f32 v147, v147, v115
    v_cvt_pk_bf16_f32 v242, v144, v145
    v_mfma_f32_16x16x32_bf16 v[92:95], v[160:163], a[44:47], v[92:95]
    ds_read_b64_tr_b16 v[54:55], v7 offset:6144
    v_cvt_pk_bf16_f32 v243, v146, v147
    v_mul_f32 v132, v132, v100
    v_mul_f32 v133, v133, v101
    v_mul_f32 v134, v134, v102
    v_mfma_f32_16x16x32_bf16 v[92:95], v[164:167], a[60:63], v[92:95]
    ds_read2st64_b64 a[92:95], v16 offset0:78 offset1:79
    ds_write_b64 v15, v[242:243] offset:512
    v_mul_f32 v135, v135, v103
    s_waitcnt lgkmcnt(11)
    v_add_u32 v6, s86, v11
    s_waitcnt lgkmcnt(1)
    v_mfma_f32_16x16x32_bf16 v[64:67], v[40:43], a[64:67], v[64:67]
    ds_read_b64_tr_b16 v[56:57], v6 offset:0
    v_add_u32 v7, s86, v13
    s_add_u32 m0, s47, s87
    v_cvt_pk_bf16_f32 v244, v132, v133
    v_cvt_pk_bf16_f32 v245, v134, v135
    v_mfma_f32_16x16x32_bf16 v[64:67], v[44:47], a[80:83], v[64:67]
    buffer_load_dwordx4 v10, s[28:31], s48 offen lds
    ds_write_b64 v15, v[244:245] offset:1024
    v_mul_f32 v148, v148, v116
    v_mul_f32 v149, v149, v117
    v_mfma_f32_16x16x32_bf16 v[68:71], v[40:43], a[68:71], v[68:71]
    ds_read_b64_tr_b16 v[58:59], v6 offset:2048
    v_mul_f32 v150, v150, v118
    v_mul_f32 v151, v151, v119
    v_cvt_pk_bf16_f32 v246, v148, v149
    v_mul_f32 v136, v136, v104
    v_mfma_f32_16x16x32_bf16 v[68:71], v[44:47], a[84:87], v[68:71]
    v_cvt_pk_bf16_f32 v247, v150, v151
    v_mul_f32 v137, v137, v105
    v_mul_f32 v138, v138, v106
    v_mul_f32 v139, v139, v107
    v_mul_f32 v152, v152, v120
    v_mfma_f32_16x16x32_bf16 v[72:75], v[40:43], a[72:75], v[72:75]
    ds_read_b64_tr_b16 v[60:61], v6 offset:4096
    ds_write_b64 v15, v[246:247] offset:1536
    v_cvt_pk_bf16_f32 v248, v136, v137
    v_cvt_pk_bf16_f32 v249, v138, v139
    v_mfma_f32_16x16x32_bf16 v[72:75], v[44:47], a[88:91], v[72:75]
    buffer_load_dwordx4 v38, s[28:31], s48 offen offset:1024 lds
    s_add_u32 s48, s48, 0x12000
    s_add_u32 s86, s86, 8192
    s_cmp_ge_u32 s86, 73728
    s_cselect_b32 s86, 0, s86
    v_mfma_f32_16x16x32_bf16 v[76:79], v[40:43], a[76:79], v[76:79]
    ds_read_b64_tr_b16 v[62:63], v6 offset:6144
    s_add_u32 s87, s87, 8192
    s_cmp_ge_u32 s87, 73728
    s_cselect_b32 s87, 0, s87
    v_mul_f32 v153, v153, v121
    v_mfma_f32_16x16x32_bf16 v[76:79], v[44:47], a[92:95], v[76:79]
    ds_write_b64 v15, v[248:249] offset:2048
    v_mul_f32 v154, v154, v122
    v_mul_f32 v155, v155, v123
    v_mfma_f32_16x16x32_bf16 v[80:83], v[48:51], a[64:67], v[80:83]
    ds_read_b64_tr_b16 v[160:161], v7 offset:0
    v_cvt_pk_bf16_f32 v250, v152, v153
    v_cvt_pk_bf16_f32 v251, v154, v155
    v_mul_f32 v140, v140, v108
    v_mul_f32 v141, v141, v109
    v_mfma_f32_16x16x32_bf16 v[80:83], v[52:55], a[80:83], v[80:83]
    ds_write_b64 v15, v[250:251] offset:2560
    v_mul_f32 v142, v142, v110
    v_mul_f32 v143, v143, v111
    v_cvt_pk_bf16_f32 v252, v140, v141
    v_mfma_f32_16x16x32_bf16 v[84:87], v[48:51], a[68:71], v[84:87]
    ds_read_b64_tr_b16 v[162:163], v7 offset:2048
    v_cvt_pk_bf16_f32 v253, v142, v143
    v_mul_f32 v156, v156, v124
    v_mfma_f32_16x16x32_bf16 v[84:87], v[52:55], a[84:87], v[84:87]
    ds_write_b64 v15, v[252:253] offset:3072
    v_mul_f32 v157, v157, v125
    v_mfma_f32_16x16x32_bf16 v[88:91], v[48:51], a[72:75], v[88:91]
    ds_read_b64_tr_b16 v[164:165], v7 offset:4096
    v_mul_f32 v158, v158, v126
    v_mul_f32 v159, v159, v127
    v_mfma_f32_16x16x32_bf16 v[88:91], v[52:55], a[88:91], v[88:91]
    v_cvt_pk_bf16_f32 v254, v156, v157
    v_cvt_pk_bf16_f32 v255, v158, v159
    v_mfma_f32_16x16x32_bf16 v[92:95], v[48:51], a[76:79], v[92:95]
    ds_read_b64_tr_b16 v[166:167], v7 offset:6144
    v_mfma_f32_16x16x32_bf16 v[92:95], v[52:55], a[92:95], v[92:95]
    ds_write_b64 v15, v[254:255] offset:3584
    s_waitcnt lgkmcnt(8)
    s_waitcnt vmcnt(9) lgkmcnt(0)
    s_barrier
    ds_read2st64_b64 a[96:99], v16 offset0:96 offset1:97
    ds_read2st64_b64 a[112:115], v16 offset0:104 offset1:105
    ds_read2st64_b64 a[100:103], v16 offset0:98 offset1:99
    ds_read2st64_b64 a[116:119], v16 offset0:106 offset1:107
    ds_read2st64_b64 a[104:107], v16 offset0:100 offset1:101
    ds_read2st64_b64 a[120:123], v16 offset0:108 offset1:109
    ds_read2st64_b64 a[108:111], v16 offset0:102 offset1:103
    ds_read2st64_b64 a[124:127], v16 offset0:110 offset1:111
    v_add_u32 v6, s86, v11
    s_waitcnt lgkmcnt(0)
    v_mfma_f32_16x16x32_bf16 v[64:67], v[56:59], a[96:99], v[64:67]
    ds_read_b64_tr_b16 v[40:41], v6 offset:0
    v_add_u32 v7, s86, v13
    v_mfma_f32_16x16x32_bf16 v[64:67], v[60:63], a[112:115], v[64:67]
    s_add_u32 m0, s47, s87
    v_mfma_f32_16x16x32_bf16 v[68:71], v[56:59], a[100:103], v[68:71]
    ds_read_b64_tr_b16 v[42:43], v6 offset:2048
    buffer_load_dwordx4 v10, s[28:31], s48 offen lds
    v_mfma_f32_16x16x32_bf16 v[68:71], v[60:63], a[116:119], v[68:71]
    v_mfma_f32_16x16x32_bf16 v[72:75], v[56:59], a[104:107], v[72:75]
    ds_read_b64_tr_b16 v[44:45], v6 offset:4096
    v_mfma_f32_16x16x32_bf16 v[72:75], v[60:63], a[120:123], v[72:75]
    v_mfma_f32_16x16x32_bf16 v[76:79], v[56:59], a[108:111], v[76:79]
    ds_read_b64_tr_b16 v[46:47], v6 offset:6144
    buffer_load_dwordx4 v38, s[28:31], s48 offen offset:1024 lds
    s_add_u32 s48, s48, 0x12000
    s_add_u32 s86, s86, 8192
    s_cmp_ge_u32 s86, 73728
    s_cselect_b32 s86, 0, s86
    v_mfma_f32_16x16x32_bf16 v[76:79], v[60:63], a[124:127], v[76:79]
    s_add_u32 s87, s87, 8192
    s_cmp_ge_u32 s87, 73728
    s_cselect_b32 s87, 0, s87
    v_mfma_f32_16x16x32_bf16 v[80:83], v[160:163], a[96:99], v[80:83]
    ds_read_b64_tr_b16 v[48:49], v7 offset:0
    v_cvt_pk_bf16_f32 v192, v64, v65
    v_cvt_pk_bf16_f32 v193, v66, v67
    v_mfma_f32_16x16x32_bf16 v[80:83], v[164:167], a[112:115], v[80:83]
    v_mfma_f32_16x16x32_bf16 v[84:87], v[160:163], a[100:103], v[84:87]
    ds_read_b64_tr_b16 v[50:51], v7 offset:2048
    v_cvt_pk_bf16_f32 v194, v68, v69
    v_cvt_pk_bf16_f32 v195, v70, v71
    v_mfma_f32_16x16x32_bf16 v[84:87], v[164:167], a[116:119], v[84:87]
    v_mfma_f32_16x16x32_bf16 v[88:91], v[160:163], a[104:107], v[88:91]
    ds_read_b64_tr_b16 v[52:53], v7 offset:4096
    v_cvt_pk_bf16_f32 v196, v72, v73
    v_cvt_pk_bf16_f32 v197, v74, v75
    v_mfma_f32_16x16x32_bf16 v[88:91], v[164:167], a[120:123], v[88:91]
    buffer_store_dwordx4 v[192:195], v18, s[40:43], s76 offen sc0 sc1
    s_add_u32 s76, s76, s55
    v_mfma_f32_16x16x32_bf16 v[92:95], v[160:163], a[108:111], v[92:95]
    ds_read_b64_tr_b16 v[54:55], v7 offset:6144
    v_mfma_f32_16x16x32_bf16 v[92:95], v[164:167], a[124:127], v[92:95]
    v_cvt_pk_bf16_f32 v198, v76, v77
    v_cvt_pk_bf16_f32 v199, v78, v79
    buffer_store_dwordx4 v[196:199], v18, s[40:43], s77 offen sc0 sc1
    s_add_u32 s77, s77, s55
    v_and_b32 v39, 0x02000200, v39
    v_cmp_ne_u32 vcc, 0x02000200, v39
    s_nop 4
    s_cmp_eq_u64 vcc, 0
    s_cselect_b32 s56, 128, 0
    s_mov_b32 s57, 0
K1_POLL4:
    s_cmp_ge_u32 s56, 128
    s_cbranch_scc1 K1_READY4
    s_add_u32 s57, s57, 1
    s_cmp_ge_u32 s57, 0x200000
    s_cbranch_scc1 K1_READY4
    s_sleep 8
    buffer_load_dword v39, v5, s[12:15], 0 offen sc1
    s_waitcnt vmcnt(0)
    v_and_b32 v39, 0x02000200, v39
    v_cmp_ne_u32 vcc, 0x02000200, v39
    s_nop 4
    s_cmp_eq_u64 vcc, 0
    s_cselect_b32 s56, 128, 0
    s_branch K1_POLL4
K1_READY4:
    s_lshl_b32 s56, s44, 6
    s_lshl_b32 s57, s17, 3
    s_sub_u32 s57, s57, 8
    s_mul_i32 s57, s57, 110592
    s_mov_b32 s58, 14564
    s_mov_b32 s59, 109440
    v_add_u32 v2, s56, v1
    v_mul_u32_u24 v3, s58, v2
    v_lshrrev_b32 v3, 20, v3
    v_lshlrev_b32 v4, 4, v2
    v_mad_u32_u24 v4, v3, s59, v4
    v_add_u32 v176, s57, v4
    v_mul_u32_u24 v3, 72, v3
    v_sub_u32 v3, v2, v3
    v_bfe_u32 v3, v3, 4, 2
    v_lshlrev_b32 v3, 4, v3
    v_xor_b32 v181, v176, v3
    v_add_u32 v186, 884736, v176
    v_add_u32 v2, s56, v1
    v_add_u32 v2, 256, v2
    v_mul_u32_u24 v3, s58, v2
    v_lshrrev_b32 v3, 20, v3
    v_lshlrev_b32 v4, 4, v2
    v_mad_u32_u24 v4, v3, s59, v4
    v_add_u32 v177, s57, v4
    v_mul_u32_u24 v3, 72, v3
    v_sub_u32 v3, v2, v3
    v_bfe_u32 v3, v3, 4, 2
    v_lshlrev_b32 v3, 4, v3
    v_xor_b32 v182, v177, v3
    v_add_u32 v187, 884736, v177
    v_add_u32 v2, s56, v1
    v_add_u32 v2, 512, v2
    v_mul_u32_u24 v3, s58, v2
    v_lshrrev_b32 v3, 20, v3
    v_lshlrev_b32 v4, 4, v2
    v_mad_u32_u24 v4, v3, s59, v4
    v_add_u32 v178, s57, v4
    v_mul_u32_u24 v3, 72, v3
    v_sub_u32 v3, v2, v3
    v_bfe_u32 v3, v3, 4, 2
    v_lshlrev_b32 v3, 4, v3
    v_xor_b32 v183, v178, v3
    v_add_u32 v188, 884736, v178
    v_add_u32 v2, s56, v1
    v_add_u32 v2, 768, v2
    v_mul_u32_u24 v3, s58, v2
    v_lshrrev_b32 v3, 20, v3
    v_lshlrev_b32 v4, 4, v2
    v_mad_u32_u24 v4, v3, s59, v4
    v_add_u32 v179, s57, v4
    v_mul_u32_u24 v3, 72, v3
    v_sub_u32 v3, v2, v3
    v_bfe_u32 v3, v3, 4, 2
    v_lshlrev_b32 v3, 4, v3
    v_xor_b32 v184, v179, v3
    v_add_u32 v2, s56, v1
    v_add_u32 v2, 1024, v2
    v_mul_u32_u24 v3, s58, v2
    v_lshrrev_b32 v3, 20, v3
    v_lshlrev_b32 v4, 4, v2
    v_mad_u32_u24 v4, v3, s59, v4
    v_add_u32 v180, s57, v4
    v_mul_u32_u24 v3, 72, v3
    v_sub_u32 v3, v2, v3
    v_bfe_u32 v3, v3, 4, 2
    v_lshlrev_b32 v3, 4, v3
    v_xor_b32 v185, v180, v3
    s_mul_i32 s72, s16, 1152
    s_add_u32 s73, s72, 36864
    s_add_u32 s74, s72, 73728
    s_lshl_b32 s3, s44, 10
    s_waitcnt lgkmcnt(4)
    v_add_u32 v6, s86, v11
    v_mfma_f32_16x16x32_bf16 v[64:67], v[40:43], a[0:3], 0
    ds_read_b64_tr_b16 v[56:57], v6 offset:0
    v_add_u32 v7, s86, v13
    v_mfma_f32_16x16x32_bf16 v[64:67], v[44:47], a[16:19], v[64:67]
    v_cvt_pk_bf16_f32 v200, v80, v81
    v_cvt_pk_bf16_f32 v201, v82, v83
    s_add_u32 m0, s47, s87
    v_mfma_f32_16x16x32_bf16 v[68:71], v[40:43], a[4:7], 0
    ds_read_b64_tr_b16 v[58:59], v6 offset:2048
    buffer_load_dwordx4 v10, s[28:31], s48 offen lds
    v_mfma_f32_16x16x32_bf16 v[68:71], v[44:47], a[20:23], v[68:71]
    v_cvt_pk_bf16_f32 v202, v84, v85
    v_cvt_pk_bf16_f32 v203, v86, v87
    v_mfma_f32_16x16x32_bf16 v[72:75], v[40:43], a[8:11], 0
    ds_read_b64_tr_b16 v[60:61], v6 offset:4096
    v_mfma_f32_16x16x32_bf16 v[72:75], v[44:47], a[24:27], v[72:75]
    v_cvt_pk_bf16_f32 v204, v88, v89
    v_cvt_pk_bf16_f32 v205, v90, v91
    v_mfma_f32_16x16x32_bf16 v[76:79], v[40:43], a[12:15], 0
    ds_read_b64_tr_b16 v[62:63], v6 offset:6144
    buffer_load_dwordx4 v38, s[28:31], s48 offen offset:1024 lds
    v_mfma_f32_16x16x32_bf16 v[76:79], v[44:47], a[28:31], v[76:79]
    s_add_u32 s48, s48, s54
    s_waitcnt lgkmcnt(4)
    v_mfma_f32_16x16x32_bf16 v[80:83], v[48:51], a[0:3], 0
    ds_read_b64_tr_b16 v[160:161], v7 offset:0
    s_add_u32 s86, s86, 8192
    v_mfma_f32_16x16x32_bf16 v[80:83], v[52:55], a[16:19], v[80:83]
    v_cvt_pk_bf16_f32 v206, v92, v93
    v_cvt_pk_bf16_f32 v207, v94, v95
    s_cmp_ge_u32 s86, 73728
    s_cselect_b32 s86, 0, s86
    v_mfma_f32_16x16x32_bf16 v[84:87], v[48:51], a[4:7], 0
    ds_read_b64_tr_b16 v[162:163], v7 offset:2048
    s_add_u32 s87, s87, 8192
    v_mfma_f32_16x16x32_bf16 v[84:87], v[52:55], a[20:23], v[84:87]
    s_cmp_ge_u32 s87, 73728
    s_cselect_b32 s87, 0, s87
    v_mfma_f32_16x16x32_bf16 v[88:91], v[48:51], a[8:11], 0
    ds_read_b64_tr_b16 v[164:165], v7 offset:4096
    v_mfma_f32_16x16x32_bf16 v[88:91], v[52:55], a[24:27], v[88:91]
    buffer_store_dwordx4 v[200:203], v18, s[40:43], s78 offen sc0 sc1
    s_add_u32 s78, s78, s50
    v_mfma_f32_16x16x32_bf16 v[92:95], v[48:51], a[12:15], 0
    ds_read_b64_tr_b16 v[166:167], v7 offset:6144
    v_mfma_f32_16x16x32_bf16 v[92:95], v[52:55], a[28:31], v[92:95]
    s_waitcnt vmcnt(9) lgkmcnt(4)
    s_barrier
    v_add_u32 v6, s86, v11
    v_mfma_f32_16x16x32_bf16 v[64:67], v[56:59], a[32:35], v[64:67]
    ds_read_b64_tr_b16 v[40:41], v6 offset:0
    v_add_u32 v7, s86, v13
    v_mfma_f32_16x16x32_bf16 v[64:67], v[60:63], a[48:51], v[64:67]
    s_add_u32 m0, s47, s87
    v_mfma_f32_16x16x32_bf16 v[68:71], v[56:59], a[36:39], v[68:71]
    ds_read_b64_tr_b16 v[42:43], v6 offset:2048
    buffer_load_dwordx4 v10, s[28:31], s48 offen lds
    v_mfma_f32_16x16x32_bf16 v[68:71], v[60:63], a[52:55], v[68:71]
    v_mfma_f32_16x16x32_bf16 v[72:75], v[56:59], a[40:43], v[72:75]
    ds_read_b64_tr_b16 v[44:45], v6 offset:4096
    buffer_load_dwordx4 v38, s[28:31], s48 offen offset:1024 lds
    v_mfma_f32_16x16x32_bf16 v[72:75], v[60:63], a[56:59], v[72:75]
    buffer_store_dwordx4 v[204:207], v18, s[40:43], s79 offen sc0 sc1
    s_add_u32 s79, s79, s50
    s_add_u32 s48, s48, 0x12000
    v_mfma_f32_16x16x32_bf16 v[76:79], v[56:59], a[44:47], v[76:79]
    ds_read_b64_tr_b16 v[46:47], v6 offset:6144
    s_add_u32 s86, s86, 8192
    v_mfma_f32_16x16x32_bf16 v[76:79], v[60:63], a[60:63], v[76:79]
    s_cmp_ge_u32 s86, 73728
    s_cselect_b32 s86, 0, s86
    s_waitcnt lgkmcnt(4)
    v_mfma_f32_16x16x32_bf16 v[80:83], v[160:163], a[32:35], v[80:83]
    ds_read_b64_tr_b16 v[48:49], v7 offset:0
    s_add_u32 s87, s87, 8192
    v_mfma_f32_16x16x32_bf16 v[80:83], v[164:167], a[48:51], v[80:83]
    s_cmp_ge_u32 s87, 73728
    s_cselect_b32 s87, 0, s87
    v_mfma_f32_16x16x32_bf16 v[84:87], v[160:163], a[36:39], v[84:87]
    ds_read_b64_tr_b16 v[50:51], v7 offset:2048
    s_add_u32 m0, s3, 86016
    v_mfma_f32_16x16x32_bf16 v[84:87], v[164:167], a[52:55], v[84:87]
    buffer_load_dwordx4 v176, s[4:7], s73 offen sc1 lds
    s_add_u32 m0, s3, 90112
    v_mfma_f32_16x16x32_bf16 v[88:91], v[160:163], a[40:43], v[88:91]
    ds_read_b64_tr_b16 v[52:53], v7 offset:4096
    v_mfma_f32_16x16x32_bf16 v[88:91], v[164:167], a[56:59], v[88:91]
    buffer_load_dwordx4 v177, s[4:7], s73 offen sc1 lds
    s_add_u32 m0, s3, 94208
    v_mfma_f32_16x16x32_bf16 v[92:95], v[160:163], a[44:47], v[92:95]
    ds_read_b64_tr_b16 v[54:55], v7 offset:6144
    v_mfma_f32_16x16x32_bf16 v[92:95], v[164:167], a[60:63], v[92:95]
    buffer_load_dwordx4 v178, s[4:7], s73 offen sc1 lds
    s_waitcnt lgkmcnt(4)
    v_add_u32 v6, s86, v11
    v_mfma_f32_16x16x32_bf16 v[64:67], v[40:43], a[64:67], v[64:67]
    ds_read_b64_tr_b16 v[56:57], v6 offset:0
    v_add_u32 v7, s86, v13
    s_add_u32 m0, s47, s87
    v_mfma_f32_16x16x32_bf16 v[64:67], v[44:47], a[80:83], v[64:67]
    buffer_load_dwordx4 v10, s[28:31], s48 offen lds
    v_mfma_f32_16x16x32_bf16 v[68:71], v[40:43], a[68:71], v[68:71]
    ds_read_b64_tr_b16 v[58:59], v6 offset:2048
    v_mfma_f32_16x16x32_bf16 v[68:71], v[44:47], a[84:87], v[68:71]
    buffer_load_dwordx4 v38, s[28:31], s48 offen offset:1024 lds
    s_add_u32 s48, s48, 0x12000
    s_add_u32 s86, s86, 8192
    v_mfma_f32_16x16x32_bf16 v[72:75], v[40:43], a[72:75], v[72:75]
    ds_read_b64_tr_b16 v[60:61], v6 offset:4096
    s_cmp_ge_u32 s86, 73728
    s_cselect_b32 s86, 0, s86
    v_mfma_f32_16x16x32_bf16 v[72:75], v[44:47], a[88:91], v[72:75]
    s_add_u32 s87, s87, 8192
    s_cmp_ge_u32 s87, 73728
    s_cselect_b32 s87, 0, s87
    v_mfma_f32_16x16x32_bf16 v[76:79], v[40:43], a[76:79], v[76:79]
    ds_read_b64_tr_b16 v[62:63], v6 offset:6144
    s_add_u32 m0, s3, 98304
    v_mfma_f32_16x16x32_bf16 v[76:79], v[44:47], a[92:95], v[76:79]
    buffer_load_dwordx4 v179, s[4:7], s73 offen sc1 lds
    s_waitcnt lgkmcnt(4)
    v_mfma_f32_16x16x32_bf16 v[80:83], v[48:51], a[64:67], v[80:83]
    ds_read_b64_tr_b16 v[160:161], v7 offset:0
    s_add_u32 m0, s3, 102400
    v_mfma_f32_16x16x32_bf16 v[80:83], v[52:55], a[80:83], v[80:83]
    buffer_load_dwordx4 v180, s[4:7], s73 offen sc1 lds
    s_add_u32 m0, s3, 73728
    v_mfma_f32_16x16x32_bf16 v[84:87], v[48:51], a[68:71], v[84:87]
    ds_read_b64_tr_b16 v[162:163], v7 offset:2048
    v_mfma_f32_16x16x32_bf16 v[84:87], v[52:55], a[84:87], v[84:87]
    buffer_load_dwordx4 v186, s[4:7], s72 offen sc1 lds
    s_add_u32 m0, s3, 77824
    v_mfma_f32_16x16x32_bf16 v[88:91], v[48:51], a[72:75], v[88:91]
    ds_read_b64_tr_b16 v[164:165], v7 offset:4096
    v_mfma_f32_16x16x32_bf16 v[88:91], v[52:55], a[88:91], v[88:91]
    buffer_load_dwordx4 v187, s[4:7], s72 offen sc1 lds
    s_add_u32 m0, s3, 81920
    v_mfma_f32_16x16x32_bf16 v[92:95], v[48:51], a[76:79], v[92:95]
    ds_read_b64_tr_b16 v[166:167], v7 offset:6144
    v_mfma_f32_16x16x32_bf16 v[92:95], v[52:55], a[92:95], v[92:95]
    buffer_load_dwordx4 v188, s[4:7], s72 offen sc1 lds
    s_waitcnt vmcnt(18) lgkmcnt(4)
    s_barrier
    v_add_u32 v6, s86, v11
    v_mfma_f32_16x16x32_bf16 v[64:67], v[56:59], a[96:99], v[64:67]
    ds_read_b64_tr_b16 v[40:41], v6 offset:0
    v_add_u32 v7, s86, v13
    s_add_u32 m0, s47, s87
    v_mfma_f32_16x16x32_bf16 v[64:67], v[60:63], a[112:115], v[64:67]
    buffer_load_dwordx4 v10, s[28:31], s48 offen lds
    v_mfma_f32_16x16x32_bf16 v[68:71], v[56:59], a[100:103], v[68:71]
    ds_read_b64_tr_b16 v[42:43], v6 offset:2048
    v_mfma_f32_16x16x32_bf16 v[68:71], v[60:63], a[116:119], v[68:71]
    buffer_load_dwordx4 v38, s[28:31], s48 offen offset:1024 lds
    s_add_u32 s48, s48, 0x12000
    s_add_u32 s86, s86, 8192
    v_mfma_f32_16x16x32_bf16 v[72:75], v[56:59], a[104:107], v[72:75]
    ds_read_b64_tr_b16 v[44:45], v6 offset:4096
    s_cmp_ge_u32 s86, 73728
    s_cselect_b32 s86, 0, s86
    v_mfma_f32_16x16x32_bf16 v[72:75], v[60:63], a[120:123], v[72:75]
    s_add_u32 s87, s87, 8192
    s_cmp_ge_u32 s87, 73728
    s_cselect_b32 s87, 0, s87
    v_mfma_f32_16x16x32_bf16 v[76:79], v[56:59], a[108:111], v[76:79]
    ds_read_b64_tr_b16 v[46:47], v6 offset:6144
    s_add_u32 m0, s3, 106496
    v_mfma_f32_16x16x32_bf16 v[76:79], v[60:63], a[124:127], v[76:79]
    buffer_load_dwordx4 v181, s[4:7], s74 offen sc1 lds
    s_waitcnt lgkmcnt(4)
    v_mfma_f32_16x16x32_bf16 v[80:83], v[160:163], a[96:99], v[80:83]
    ds_read_b64_tr_b16 v[48:49], v7 offset:0
    v_cvt_pk_bf16_f32 v192, v64, v65
    v_cvt_pk_bf16_f32 v193, v66, v67
    s_add_u32 m0, s3, 110592
    v_mfma_f32_16x16x32_bf16 v[80:83], v[164:167], a[112:115], v[80:83]
    buffer_load_dwordx4 v182, s[4:7], s74 offen sc1 lds
    s_add_u32 m0, s3, 114688
    v_mfma_f32_16x16x32_bf16 v[84:87], v[160:163], a[100:103], v[84:87]
    ds_read_b64_tr_b16 v[50:51], v7 offset:2048
    v_cvt_pk_bf16_f32 v194, v68, v69
    v_cvt_pk_bf16_f32 v195, v70, v71
    v_mfma_f32_16x16x32_bf16 v[84:87], v[164:167], a[116:119], v[84:87]
    buffer_load_dwordx4 v183, s[4:7], s74 offen sc1 lds
    s_add_u32 m0, s3, 118784
    v_mfma_f32_16x16x32_bf16 v[88:91], v[160:163], a[104:107], v[88:91]
    ds_read_b64_tr_b16 v[52:53], v7 offset:4096
    v_cvt_pk_bf16_f32 v196, v72, v73
    v_cvt_pk_bf16_f32 v197, v74, v75
    v_mfma_f32_16x16x32_bf16 v[88:91], v[164:167], a[120:123], v[88:91]
    buffer_store_dwordx4 v[192:195], v18, s[40:43], s76 offen sc0 sc1
    s_add_u32 s76, s76, s55
    buffer_load_dwordx4 v184, s[4:7], s74 offen sc1 lds
    v_mfma_f32_16x16x32_bf16 v[92:95], v[160:163], a[108:111], v[92:95]
    ds_read_b64_tr_b16 v[54:55], v7 offset:6144
    s_add_u32 m0, s3, 122880
    v_mfma_f32_16x16x32_bf16 v[92:95], v[164:167], a[124:127], v[92:95]
    v_cvt_pk_bf16_f32 v198, v76, v77
    v_cvt_pk_bf16_f32 v199, v78, v79
    buffer_load_dwordx4 v185, s[4:7], s74 offen sc1 lds
    buffer_store_dwordx4 v[196:199], v18, s[40:43], s77 offen sc0 sc1
    s_add_u32 s77, s77, s55
K1_DL4:
    s_waitcnt lgkmcnt(4)
    v_add_u32 v6, s86, v11
    v_mfma_f32_16x16x32_bf16 v[64:67], v[40:43], a[0:3], 0
    ds_read_b64_tr_b16 v[56:57], v6 offset:0
    v_add_u32 v7, s86, v13
    v_mfma_f32_16x16x32_bf16 v[64:67], v[44:47], a[16:19], v[64:67]
    v_cvt_pk_bf16_f32 v200, v80, v81
    v_cvt_pk_bf16_f32 v201, v82, v83
    s_add_u32 m0, s47, s87
    v_mfma_f32_16x16x32_bf16 v[68:71], v[40:43], a[4:7], 0
    ds_read_b64_tr_b16 v[58:59], v6 offset:2048
    buffer_load_dwordx4 v10, s[28:31], s48 offen lds
    v_mfma_f32_16x16x32_bf16 v[68:71], v[44:47], a[20:23], v[68:71]
    v_cvt_pk_bf16_f32 v202, v84, v85
    v_cvt_pk_bf16_f32 v203, v86, v87
    v_mfma_f32_16x16x32_bf16 v[72:75], v[40:43], a[8:11], 0
    ds_read_b64_tr_b16 v[60:61], v6 offset:4096
    v_mfma_f32_16x16x32_bf16 v[72:75], v[44:47], a[24:27], v[72:75]
    v_cvt_pk_bf16_f32 v204, v88, v89
    v_cvt_pk_bf16_f32 v205, v90, v91
    v_mfma_f32_16x16x32_bf16 v[76:79], v[40:43], a[12:15], 0
    ds_read_b64_tr_b16 v[62:63], v6 offset:6144
    buffer_load_dwordx4 v38, s[28:31], s48 offen offset:1024 lds
    v_mfma_f32_16x16x32_bf16 v[76:79], v[44:47], a[28:31], v[76:79]
    s_add_u32 s48, s48, s54
    s_waitcnt lgkmcnt(4)
    v_mfma_f32_16x16x32_bf16 v[80:83], v[48:51], a[0:3], 0
    ds_read_b64_tr_b16 v[160:161], v7 offset:0
    s_add_u32 s86, s86, 8192
    v_mfma_f32_16x16x32_bf16 v[80:83], v[52:55], a[16:19], v[80:83]
    v_cvt_pk_bf16_f32 v206, v92, v93
    v_cvt_pk_bf16_f32 v207, v94, v95
    s_cmp_ge_u32 s86, 73728
    s_cselect_b32 s86, 0, s86
    v_mfma_f32_16x16x32_bf16 v[84:87], v[48:51], a[4:7], 0
    ds_read_b64_tr_b16 v[162:163], v7 offset:2048
    s_add_u32 s87, s87, 8192
    v_mfma_f32_16x16x32_bf16 v[84:87], v[52:55], a[20:23], v[84:87]
    s_cmp_ge_u32 s87, 73728
    s_cselect_b32 s87, 0, s87
    v_mfma_f32_16x16x32_bf16 v[88:91], v[48:51], a[8:11], 0
    ds_read_b64_tr_b16 v[164:165], v7 offset:4096
    v_mfma_f32_16x16x32_bf16 v[88:91], v[52:55], a[24:27], v[88:91]
    buffer_store_dwordx4 v[200:203], v18, s[40:43], s78 offen sc0 sc1
    s_add_u32 s78, s78, s50
    v_mfma_f32_16x16x32_bf16 v[92:95], v[48:51], a[12:15], 0
    ds_read_b64_tr_b16 v[166:167], v7 offset:6144
    v_mfma_f32_16x16x32_bf16 v[92:95], v[52:55], a[28:31], v[92:95]
    s_waitcnt vmcnt(9) lgkmcnt(4)
    s_barrier
    v_add_u32 v6, s86, v11
    v_mfma_f32_16x16x32_bf16 v[64:67], v[56:59], a[32:35], v[64:67]
    ds_read_b64_tr_b16 v[40:41], v6 offset:0
    v_add_u32 v7, s86, v13
    v_mfma_f32_16x16x32_bf16 v[64:67], v[60:63], a[48:51], v[64:67]
    s_add_u32 m0, s47, s87
    v_mfma_f32_16x16x32_bf16 v[68:71], v[56:59], a[36:39], v[68:71]
    ds_read_b64_tr_b16 v[42:43], v6 offset:2048
    buffer_load_dwordx4 v10, s[28:31], s48 offen lds
    v_mfma_f32_16x16x32_bf16 v[68:71], v[60:63], a[52:55], v[68:71]
    v_mfma_f32_16x16x32_bf16 v[72:75], v[56:59], a[40:43], v[72:75]
    ds_read_b64_tr_b16 v[44:45], v6 offset:4096
    v_mfma_f32_16x16x32_bf16 v[72:75], v[60:63], a[56:59], v[72:75]
    buffer_store_dwordx4 v[204:207], v18, s[40:43], s79 offen sc0 sc1
    s_add_u32 s79, s79, s50
    v_mfma_f32_16x16x32_bf16 v[76:79], v[56:59], a[44:47], v[76:79]
    ds_read_b64_tr_b16 v[46:47], v6 offset:6144
    buffer_load_dwordx4 v38, s[28:31], s48 offen offset:1024 lds
    v_mfma_f32_16x16x32_bf16 v[76:79], v[60:63], a[60:63], v[76:79]
    s_add_u32 s48, s48, 0x12000
    s_waitcnt lgkmcnt(4)
    v_mfma_f32_16x16x32_bf16 v[80:83], v[160:163], a[32:35], v[80:83]
    ds_read_b64_tr_b16 v[48:49], v7 offset:0
    s_add_u32 s86, s86, 8192
    v_mfma_f32_16x16x32_bf16 v[80:83], v[164:167], a[48:51], v[80:83]
    s_cmp_ge_u32 s86, 73728
    s_cselect_b32 s86, 0, s86
    v_mfma_f32_16x16x32_bf16 v[84:87], v[160:163], a[36:39], v[84:87]
    ds_read_b64_tr_b16 v[50:51], v7 offset:2048
    s_add_u32 s87, s87, 8192
    v_mfma_f32_16x16x32_bf16 v[84:87], v[164:167], a[52:55], v[84:87]
    s_cmp_ge_u32 s87, 73728
    s_cselect_b32 s87, 0, s87
    v_mfma_f32_16x16x32_bf16 v[88:91], v[160:163], a[40:43], v[88:91]
    ds_read_b64_tr_b16 v[52:53], v7 offset:4096
    v_mfma_f32_16x16x32_bf16 v[88:91], v[164:167], a[56:59], v[88:91]
    v_mfma_f32_16x16x32_bf16 v[92:95], v[160:163], a[44:47], v[92:95]
    ds_read_b64_tr_b16 v[54:55], v7 offset:6144
    v_mfma_f32_16x16x32_bf16 v[92:95], v[164:167], a[60:63], v[92:95]
    s_waitcnt lgkmcnt(4)
    v_add_u32 v6, s86, v11
    v_mfma_f32_16x16x32_bf16 v[64:67], v[40:43], a[64:67], v[64:67]
    ds_read_b64_tr_b16 v[56:57], v6 offset:0
    v_add_u32 v7, s86, v13
    v_mfma_f32_16x16x32_bf16 v[64:67], v[44:47], a[80:83], v[64:67]
    s_add_u32 m0, s47, s87
    v_mfma_f32_16x16x32_bf16 v[68:71], v[40:43], a[68:71], v[68:71]
    ds_read_b64_tr_b16 v[58:59], v6 offset:2048
    buffer_load_dwordx4 v10, s[28:31], s48 offen lds
    v_mfma_f32_16x16x32_bf16 v[68:71], v[44:47], a[84:87], v[68:71]
    v_mfma_f32_16x16x32_bf16 v[72:75], v[40:43], a[72:75], v[72:75]
    ds_read_b64_tr_b16 v[60:61], v6 offset:4096
    v_mfma_f32_16x16x32_bf16 v[72:75], v[44:47], a[88:91], v[72:75]
    v_mfma_f32_16x16x32_bf16 v[76:79], v[40:43], a[76:79], v[76:79]
    ds_read_b64_tr_b16 v[62:63], v6 offset:6144
    buffer_load_dwordx4 v38, s[28:31], s48 offen offset:1024 lds
    v_mfma_f32_16x16x32_bf16 v[76:79], v[44:47], a[92:95], v[76:79]
    s_add_u32 s48, s48, 0x12000
    s_waitcnt lgkmcnt(4)
    v_mfma_f32_16x16x32_bf16 v[80:83], v[48:51], a[64:67], v[80:83]
    ds_read_b64_tr_b16 v[160:161], v7 offset:0
    s_add_u32 s86, s86, 8192
    v_mfma_f32_16x16x32_bf16 v[80:83], v[52:55], a[80:83], v[80:83]
    s_cmp_ge_u32 s86, 73728
    s_cselect_b32 s86, 0, s86
    v_mfma_f32_16x16x32_bf16 v[84:87], v[48:51], a[68:71], v[84:87]
    ds_read_b64_tr_b16 v[162:163], v7 offset:2048
    s_add_u32 s87, s87, 8192
    v_mfma_f32_16x16x32_bf16 v[84:87], v[52:55], a[84:87], v[84:87]
    s_cmp_ge_u32 s87, 73728
    s_cselect_b32 s87, 0, s87
    v_mfma_f32_16x16x32_bf16 v[88:91], v[48:51], a[72:75], v[88:91]
    ds_read_b64_tr_b16 v[164:165], v7 offset:4096
    s_mov_b32 s56, 131072
    v_mfma_f32_16x16x32_bf16 v[88:91], v[52:55], a[88:91], v[88:91]
    s_cmp_eq_u32 s52, 5
    s_cselect_b32 s55, 0xfff90000, s56
    v_mfma_f32_16x16x32_bf16 v[92:95], v[48:51], a[76:79], v[92:95]
    ds_read_b64_tr_b16 v[166:167], v7 offset:6144
    v_mfma_f32_16x16x32_bf16 v[92:95], v[52:55], a[92:95], v[92:95]
    s_waitcnt vmcnt(10) lgkmcnt(4)
    s_barrier
    v_add_u32 v6, s86, v11
    v_mfma_f32_16x16x32_bf16 v[64:67], v[56:59], a[96:99], v[64:67]
    ds_read_b64_tr_b16 v[40:41], v6 offset:0
    v_add_u32 v7, s86, v13
    v_mfma_f32_16x16x32_bf16 v[64:67], v[60:63], a[112:115], v[64:67]
    s_add_u32 m0, s47, s87
    v_mfma_f32_16x16x32_bf16 v[68:71], v[56:59], a[100:103], v[68:71]
    ds_read_b64_tr_b16 v[42:43], v6 offset:2048
    buffer_load_dwordx4 v10, s[28:31], s48 offen lds
    v_mfma_f32_16x16x32_bf16 v[68:71], v[60:63], a[116:119], v[68:71]
    v_mfma_f32_16x16x32_bf16 v[72:75], v[56:59], a[104:107], v[72:75]
    ds_read_b64_tr_b16 v[44:45], v6 offset:4096
    v_mfma_f32_16x16x32_bf16 v[72:75], v[60:63], a[120:123], v[72:75]
    v_mfma_f32_16x16x32_bf16 v[76:79], v[56:59], a[108:111], v[76:79]
    ds_read_b64_tr_b16 v[46:47], v6 offset:6144
    buffer_load_dwordx4 v38, s[28:31], s48 offen offset:1024 lds
    v_mfma_f32_16x16x32_bf16 v[76:79], v[60:63], a[124:127], v[76:79]
    s_add_u32 s48, s48, 0x12000
    s_waitcnt lgkmcnt(4)
    v_mfma_f32_16x16x32_bf16 v[80:83], v[160:163], a[96:99], v[80:83]
    ds_read_b64_tr_b16 v[48:49], v7 offset:0
    v_cvt_pk_bf16_f32 v192, v64, v65
    v_cvt_pk_bf16_f32 v193, v66, v67
    s_add_u32 s86, s86, 8192
    v_mfma_f32_16x16x32_bf16 v[80:83], v[164:167], a[112:115], v[80:83]
    s_cmp_ge_u32 s86, 73728
    s_cselect_b32 s86, 0, s86
    v_mfma_f32_16x16x32_bf16 v[84:87], v[160:163], a[100:103], v[84:87]
    ds_read_b64_tr_b16 v[50:51], v7 offset:2048
    v_cvt_pk_bf16_f32 v194, v68, v69
    v_cvt_pk_bf16_f32 v195, v70, v71
    s_add_u32 s87, s87, 8192
    v_mfma_f32_16x16x32_bf16 v[84:87], v[164:167], a[116:119], v[84:87]
    s_cmp_ge_u32 s87, 73728
    s_cselect_b32 s87, 0, s87
    v_mfma_f32_16x16x32_bf16 v[88:91], v[160:163], a[104:107], v[88:91]
    ds_read_b64_tr_b16 v[52:53], v7 offset:4096
    v_cvt_pk_bf16_f32 v196, v72, v73
    v_cvt_pk_bf16_f32 v197, v74, v75
    s_mov_b32 s56, 0xfffca100
    v_mfma_f32_16x16x32_bf16 v[88:91], v[164:167], a[120:123], v[88:91]
    buffer_store_dwordx4 v[192:195], v18, s[40:43], s76 offen sc0 sc1
    s_add_u32 s76, s76, s55
    s_cmp_eq_u32 s52, 7
    s_cselect_b32 s54, 0xfffc9c80, s56
    v_mfma_f32_16x16x32_bf16 v[92:95], v[160:163], a[108:111], v[92:95]
    ds_read_b64_tr_b16 v[54:55], v7 offset:6144
    s_mov_b32 s56, 131072
    v_mfma_f32_16x16x32_bf16 v[92:95], v[164:167], a[124:127], v[92:95]
    v_cvt_pk_bf16_f32 v198, v76, v77
    v_cvt_pk_bf16_f32 v199, v78, v79
    s_cmp_eq_u32 s52, 5
    s_cselect_b32 s50, 0xfff90000, s56
    buffer_store_dwordx4 v[196:199], v18, s[40:43], s77 offen sc0 sc1
    s_add_u32 s77, s77, s55
    s_cmp_lg_u32 s52, 4
    s_cbranch_scc1 ERP_3
    s_or_b32 s19, s19, 4
    s_cmp_lg_u32 s44, 0
    s_cbranch_scc1 PUB_4
    s_lshl_b32 s57, s64, 7
    s_add_u32 s57, s57, s65
    s_mov_b64 exec, 1
    v_mov_b32 v2, s19
    buffer_store_byte v2, v9, s[12:15], s57 offen sc0 sc1
    s_mov_b64 exec, -1
PUB_4:
ERP_3:
    s_sub_u32 s52, s52, 1
    s_cmp_lg_u32 s52, 0
    s_cbranch_scc1 K1_DL4
K1_DEND:
    s_nop 7
    v_cvt_pk_bf16_f32 v200, v80, v81
    v_cvt_pk_bf16_f32 v201, v82, v83
    v_cvt_pk_bf16_f32 v202, v84, v85
    v_cvt_pk_bf16_f32 v203, v86, v87
    v_cvt_pk_bf16_f32 v204, v88, v89
    v_cvt_pk_bf16_f32 v205, v90, v91
    v_cvt_pk_bf16_f32 v206, v92, v93
    v_cvt_pk_bf16_f32 v207, v94, v95
    buffer_store_dwordx4 v[200:203], v18, s[40:43], s78 offen sc0 sc1
    s_add_u32 s78, s78, s50
    buffer_store_dwordx4 v[204:207], v18, s[40:43], s79 offen sc0 sc1
    s_add_u32 s79, s79, s50
    s_getpc_b64 s[32:33]
K1_PC:
    s_add_u32 s32, s32, k2_kernel-K1_PC
    s_addc_u32 s33, s33, 0
    s_mov_b32 s34, ALL_CODE_END-k2_kernel
    v_lshlrev_b32 v2, 7, v0
    buffer_load_dword v31, v2, s[32:35], 0 offen
    s_load_dwordx2 s[88:89], s[0:1], 0
    s_lshl_b32 s25, s64, 7
    s_add_u32 s24, s25, s65
    buffer_load_dwordx4 v[216:219], v9, s[12:15], s25 offen sc1
    s_lshl_b32 s26, s64, 2
    s_lshr_b32 s27, s65, 2
    s_add_u32 s26, s26, s27
    s_mul_i32 s26, s26, 36
    s_and_b32 s27, s65, 3
    s_add_u32 s26, s26, s27
    s_lshl_b32 s27, s44, 3
    s_add_u32 s26, s26, s27
    s_lshl_b32 s36, s26, 10
    s_add_u32 s37, s36, 16384
    s_lshl_b32 s26, s26, 14
    s_add_u32 s27, s26, 262144
    s_mov_b32 s38, s19
    s_mov_b32 s39, 0xbfb8aa3b
    s_add_u32 s28, s22, 62914560
    s_addc_u32 s29, s23, 0
    s_mov_b32 s30, 2359296
    s_mov_b32 s31, 0x00020000
    v_and_b32 v5, 15, v1
    v_lshrrev_b32 v6, 4, v1
    v_lshrrev_b32 v2, 2, v5
    v_cmp_eq_u32 vcc, v2, v6
    v_and_b32 v3, 1, v5
    v_lshlrev_b32 v3, 4, v3
    v_mov_b32 v4, 0x3f80
    v_lshlrev_b32 v4, v3, v4
    v_cndmask_b32 v4, 0, v4, vcc
    v_bfe_u32 v3, v5, 1, 1
    v_cmp_eq_u32 vcc, 0, v3
    v_mov_b32 v226, 0
    v_mov_b32 v227, 0
    v_cndmask_b32 v224, 0, v4, vcc
    v_cndmask_b32 v225, v4, 0, vcc
    v_mov_b32 v228, 0
    v_mov_b32 v229, 0
    v_mov_b32 v230, v224
    v_mov_b32 v231, v225
    v_and_b32 v6, 31, v1
    v_lshrrev_b32 v7, 5, v1
    s_cmp_lg_u32 s44, 0
    s_cbranch_scc1 AT_5
    v_lshrrev_b32 v2, 2, v1
    s_cmp_eq_u32 s17, 0
    s_cselect_b32 s80, 8, 0
    v_cmp_gt_u32 vcc, s80, v2
    v_mov_b32 v3, 0xf149f149
    v_mul_u32_u24 v2, 1152, v2
    v_cndmask_b32 v20, v9, v3, vcc
    v_and_b32 v3, 3, v1
    v_lshl_add_u32 v2, v3, 4, v2
    v_mov_b32 v21, v20
    v_mov_b32 v22, v20
    v_mov_b32 v23, v20
    v_add_u32 v2, 126976, v2
    ds_write_b128 v2, v[20:23]
    v_mov_b32 v24, 0x3f803f80
    v_mov_b32 v25, 0x3f803f80
    v_mov_b32 v26, 0x3f803f80
    v_mov_b32 v27, 0x3f803f80
    ds_write_b128 v2, v[24:27] offset:64
AT_5:
    v_lshlrev_b32 v8, 2, v7
    v_sub_u32 v8, v6, v8
    v_mov_b32 v19, 0xf149f2ca
    v_cmp_gt_i32 s[48:49], 0, v8
    v_cmp_gt_i32 s[50:51], 1, v8
    v_cmp_gt_i32 s[52:53], 2, v8
    v_cmp_gt_i32 s[54:55], 3, v8
    v_cmp_gt_i32 s[56:57], 16, v8
    v_cmp_gt_i32 s[58:59], 17, v8
    v_cmp_gt_i32 s[60:61], 18, v8
    v_cmp_gt_i32 s[62:63], 19, v8
    v_cmp_gt_i32 s[64:65], 8, v8
    v_cmp_gt_i32 s[66:67], 9, v8
    v_cmp_gt_i32 s[68:69], 10, v8
    v_cmp_gt_i32 s[70:71], 11, v8
    v_cmp_gt_i32 s[72:73], 24, v8
    v_cmp_gt_i32 s[74:75], 25, v8
    v_cmp_gt_i32 s[76:77], 26, v8
    v_cmp_gt_i32 s[78:79], 27, v8
    v_bfe_u32 v2, v1, 2, 2
    v_lshl_add_u32 v3, v7, 3, v2
    v_lshlrev_b32 v3, 6, v3
    v_and_b32 v4, 1, v2
    v_add_u32 v4, 16, v4
    v_lshlrev_b32 v4, 6, v4
    v_bfe_u32 v5, v1, 4, 1
    v_and_b32 v20, 1, v1
    v_bfe_u32 v21, v1, 1, 1
    v_lshlrev_b32 v22, 5, v5
    v_lshl_add_u32 v22, v20, 4, v22
    v_lshl_add_u32 v22, v21, 3, v22
    s_mul_i32 s81, s44, 2304
    s_add_u32 s80, s81, 86016
    v_add_u32 v22, s80, v22
    v_add_u32 v10, v3, v22
    v_mov_b32 v23, 40960
    v_cmp_gt_u32 vcc, 2, v2
    s_nop 1
    v_cndmask_b32 v23, v23, v4, vcc
    v_add_u32 v11, v23, v22
    v_and_b32 v22, 3, v1
    v_lshlrev_b32 v22, 4, v22
    v_lshl_add_u32 v22, v5, 3, v22
    s_add_u32 s80, s81, 73728
    v_add_u32 v22, s80, v22
    v_add_u32 v12, v3, v22
    v_add_u32 v13, v4, v22
    v_bfe_u32 v22, v6, 2, 2
    v_xor_b32 v22, v22, v7
    v_lshlrev_b32 v23, 6, v6
    v_cmp_gt_u32 vcc, 18, v6
    v_mov_b32 v24, 20544
    s_nop 0
    v_cndmask_b32 v23, v24, v23, vcc
    s_add_u32 s80, s81, 106496
    v_add_u32 v23, s80, v23
    v_lshl_add_u32 v14, v22, 4, v23
    v_xor_b32 v22, 2, v22
    v_lshl_add_u32 v15, v22, 4, v23
    s_lshl_b32 s80, s17, 8
    s_lshl_b32 s81, s44, 6
    s_add_u32 s80, s80, s81
    v_add_u32 v16, s80, v6
    v_mul_u32_u24 v16, 1152, v16
    v_lshl_add_u32 v16, v7, 3, v16
    s_mul_i32 s81, s16, 36
    v_add_u32 v16, s81, v16
    v_lshlrev_b32 v17, 30, v7
    v_add_u32 v17, v17, v16
    v_cmp_eq_u32 s[18:19], 0, v7
    v_mov_b32 v2, 0x3f803f80
    v_mov_b32 v3, 0x00003f80
    v_accvgpr_write_b32 a60, v9
    v_accvgpr_write_b32 a61, v9
    v_mov_b32 v46, 0
    v_mov_b32 v47, 0
    v_mov_b32 v54, 0
    v_mov_b32 v55, 0
    s_mov_b32 s80, 36864
    s_waitcnt lgkmcnt(0)
    s_barrier
    ds_read_b64_tr_b16 v[40:41], v12 offset:0
    ds_read_b64_tr_b16 v[42:43], v12 offset:256
    ds_read_b64_tr_b16 v[44:45], v13 offset:0
    ds_read_b64_tr_b16 v[48:49], v12 offset:1152
    ds_read_b64_tr_b16 v[50:51], v12 offset:1408
    ds_read_b64_tr_b16 v[52:53], v13 offset:1152
    ds_read_b64_tr_b16 a[0:1], v10 offset:0
    ds_read_b64_tr_b16 a[2:3], v10 offset:256
    ds_read_b64_tr_b16 a[4:5], v11 offset:0
    ds_read_b64_tr_b16 a[6:7], v10 offset:1152
    ds_read_b64_tr_b16 a[8:9], v10 offset:1408
    ds_read_b64_tr_b16 a[10:11], v11 offset:1152
    ds_read_b64_tr_b16 a[12:13], v10 offset:2304
    ds_read_b64_tr_b16 a[14:15], v10 offset:2560
    ds_read_b64_tr_b16 a[16:17], v11 offset:2304
    v_cndmask_b32 v64, v19, v9, s[48:49]
    v_cndmask_b32 v65, v19, v9, s[50:51]
    v_cndmask_b32 v66, v19, v9, s[52:53]
    v_cndmask_b32 v67, v19, v9, s[54:55]
    v_cndmask_b32 v68, v19, v9, s[56:57]
    v_cndmask_b32 v69, v19, v9, s[58:59]
    v_cndmask_b32 v70, v19, v9, s[60:61]
    v_cndmask_b32 v71, v19, v9, s[62:63]
    v_cndmask_b32 v72, v19, v9, s[64:65]
    v_cndmask_b32 v73, v19, v9, s[66:67]
    v_cndmask_b32 v74, v19, v9, s[68:69]
    v_cndmask_b32 v75, v19, v9, s[70:71]
    v_cndmask_b32 v76, v19, v9, s[72:73]
    v_cndmask_b32 v77, v19, v9, s[74:75]
    v_cndmask_b32 v78, v19, v9, s[76:77]
    v_cndmask_b32 v79, v19, v9, s[78:79]
    s_waitcnt lgkmcnt(9)
    v_cndmask_b32 v44, 0, v44, s[18:19]
    v_cndmask_b32 v45, 0, v3, s[18:19]
    v_cndmask_b32 v52, 0, v52, s[18:19]
    v_cndmask_b32 v53, 0, v3, s[18:19]
    v_cndmask_b32 v80, v19, v9, s[48:49]
    v_cndmask_b32 v81, v19, v9, s[50:51]
    v_cndmask_b32 v82, v19, v9, s[52:53]
    v_cndmask_b32 v83, v19, v9, s[54:55]
    v_cndmask_b32 v84, v19, v9, s[56:57]
    v_cndmask_b32 v85, v19, v9, s[58:59]
    v_cndmask_b32 v86, v19, v9, s[60:61]
    v_cndmask_b32 v87, v19, v9, s[62:63]
    v_cndmask_b32 v88, v19, v9, s[64:65]
    v_cndmask_b32 v89, v19, v9, s[66:67]
    v_cndmask_b32 v90, v19, v9, s[68:69]
    v_cndmask_b32 v91, v19, v9, s[70:71]
    v_cndmask_b32 v92, v19, v9, s[72:73]
    v_cndmask_b32 v93, v19, v9, s[74:75]
    v_cndmask_b32 v94, v19, v9, s[76:77]
    v_cndmask_b32 v95, v19, v9, s[78:79]
    ds_read_b64_tr_b16 a[18:19], v10 offset:3456
    ds_read_b64_tr_b16 a[20:21], v10 offset:3712
    ds_read_b64_tr_b16 a[22:23], v11 offset:3456
    s_waitcnt lgkmcnt(3)
    v_mfma_f32_32x32x16_bf16 v[64:79], a[0:3], v[40:43], v[64:79]
    v_mfma_f32_32x32x16_bf16 v[80:95], a[6:9], v[48:51], v[80:95]
    v_mfma_f32_32x32x16_bf16 v[64:79], a[4:7], v[44:47], v[64:79]
    v_mfma_f32_32x32x16_bf16 v[80:95], a[10:13], v[52:55], v[80:95]
    ds_read_b64_tr_b16 a[24:25], v10 offset:4608
    ds_read_b64_tr_b16 a[26:27], v10 offset:4864
    ds_read_b64_tr_b16 a[28:29], v11 offset:4608
    s_waitcnt lgkmcnt(3)
    v_mfma_f32_32x32x16_bf16 v[96:111], a[6:9], v[40:43], 0
    s_nop 5
    v_max_f32 v56, v64, v65
    v_max_f32 v57, v66, v67
    v_max3_f32 v56, v56, v68, v69
    v_max3_f32 v57, v57, v70, v71
    v_mfma_f32_32x32x16_bf16 v[112:127], a[12:15], v[48:51], 0
    v_max3_f32 v56, v56, v72, v73
    v_max3_f32 v57, v57, v74, v75
    v_max3_f32 v56, v56, v76, v77
    v_max3_f32 v57, v57, v78, v79
    v_mfma_f32_32x32x16_bf16 v[96:111], a[10:13], v[44:47], v[96:111]
    v_max_f32 v58, v80, v81
    v_max_f32 v59, v82, v83
    v_max3_f32 v58, v58, v84, v85
    v_max3_f32 v59, v59, v86, v87
    v_mfma_f32_32x32x16_bf16 v[112:127], a[16:19], v[52:55], v[112:127]
    v_max3_f32 v58, v58, v88, v89
    v_max3_f32 v59, v59, v90, v91
    v_max3_f32 v58, v58, v92, v93
    v_max3_f32 v59, v59, v94, v95
    ds_read_b64_tr_b16 a[30:31], v10 offset:5760
    ds_read_b64_tr_b16 a[32:33], v10 offset:6016
    ds_read_b64_tr_b16 a[34:35], v11 offset:5760
    s_waitcnt lgkmcnt(3)
    v_mfma_f32_32x32x16_bf16 v[64:79], a[12:15], v[40:43], 0
    v_max3_f32 v56, v56, v96, v97
    v_max3_f32 v57, v57, v98, v99
    v_max3_f32 v56, v56, v100, v101
    v_max3_f32 v57, v57, v102, v103
    v_mfma_f32_32x32x16_bf16 v[80:95], a[18:21], v[48:51], 0
    v_max3_f32 v56, v56, v104, v105
    v_max3_f32 v57, v57, v106, v107
    v_max3_f32 v56, v56, v108, v109
    v_max3_f32 v57, v57, v110, v111
    v_mfma_f32_32x32x16_bf16 v[64:79], a[16:19], v[44:47], v[64:79]
    v_max3_f32 v58, v58, v112, v113
    v_max3_f32 v59, v59, v114, v115
    v_max3_f32 v58, v58, v116, v117
    v_max3_f32 v59, v59, v118, v119
    v_mfma_f32_32x32x16_bf16 v[80:95], a[22:25], v[52:55], v[80:95]
    v_max3_f32 v58, v58, v120, v121
    v_max3_f32 v59, v59, v122, v123
    v_max3_f32 v58, v58, v124, v125
    v_max3_f32 v59, v59, v126, v127
    ds_read_b64_tr_b16 a[36:37], v10 offset:6912
    ds_read_b64_tr_b16 a[38:39], v10 offset:7168
    ds_read_b64_tr_b16 a[40:41], v11 offset:6912
    s_waitcnt lgkmcnt(3)
    v_mfma_f32_32x32x16_bf16 v[96:111], a[18:21], v[40:43], 0
    v_max3_f32 v56, v56, v64, v65
    v_max3_f32 v57, v57, v66, v67
    v_max3_f32 v56, v56, v68, v69
    v_max3_f32 v57, v57, v70, v71
    v_mfma_f32_32x32x16_bf16 v[112:127], a[24:27], v[48:51], 0
    v_max3_f32 v56, v56, v72, v73
    v_max3_f32 v57, v57, v74, v75
    v_max3_f32 v56, v56, v76, v77
    v_max3_f32 v57, v57, v78, v79
    v_mfma_f32_32x32x16_bf16 v[96:111], a[22:25], v[44:47], v[96:111]
    v_max3_f32 v58, v58, v80, v81
    v_max3_f32 v59, v59, v82, v83
    v_max3_f32 v58, v58, v84, v85
    v_max3_f32 v59, v59, v86, v87
    v_mfma_f32_32x32x16_bf16 v[112:127], a[28:31], v[52:55], v[112:127]
    v_max3_f32 v58, v58, v88, v89
    v_max3_f32 v59, v59, v90, v91
    v_max3_f32 v58, v58, v92, v93
    v_max3_f32 v59, v59, v94, v95
    ds_read_b64_tr_b16 a[42:43], v10 offset:8064
    ds_read_b64_tr_b16 a[44:45], v10 offset:8320
    ds_read_b64_tr_b16 a[46:47], v11 offset:8064
    s_waitcnt lgkmcnt(3)
    v_mfma_f32_32x32x16_bf16 v[64:79], a[24:27], v[40:43], 0
    v_max3_f32 v56, v56, v96, v97
    v_max3_f32 v57, v57, v98, v99
    v_max3_f32 v56, v56, v100, v101
    v_max3_f32 v57, v57, v102, v103
    v_mfma_f32_32x32x16_bf16 v[80:95], a[30:33], v[48:51], 0
    v_max3_f32 v56, v56, v104, v105
    v_max3_f32 v57, v57, v106, v107
    v_max3_f32 v56, v56, v108, v109
    v_max3_f32 v57, v57, v110, v111
    v_mfma_f32_32x32x16_bf16 v[64:79], a[28:31], v[44:47], v[64:79]
    v_max3_f32 v58, v58, v112, v113
    v_max3_f32 v59, v59, v114, v115
    v_max3_f32 v58, v58, v116, v117
    v_max3_f32 v59, v59, v118, v119
    v_mfma_f32_32x32x16_bf16 v[80:95], a[34:37], v[52:55], v[80:95]
    v_max3_f32 v58, v58, v120, v121
    v_max3_f32 v59, v59, v122, v123
    v_max3_f32 v58, v58, v124, v125
    v_max3_f32 v59, v59, v126, v127
    s_waitcnt vmcnt(0)
    s_mov_b32 s83, 0
ER1:
    v_and_b32 v216, v216, v217
    v_and_b32 v218, v218, v219
    v_and_b32 v216, v216, v218
    v_and_b32 v216, 0x4040404, v216
    s_nop 0
    v_readfirstlane_b32 s82, v216
    s_add_u32 s83, s83, 1
    s_cmp_eq_u32 s82, 0x4040404
    s_cbranch_scc1 ER1_OK
    s_cmp_ge_u32 s83, 0x200000
    s_cbranch_scc1 ER1_OK
    s_sleep 16
    buffer_load_dwordx4 v[216:219], v9, s[12:15], s25 offen sc1
    s_waitcnt vmcnt(0)
    s_branch ER1
ER1_OK:
    buffer_load_dwordx4 a[160:163], v18, s[40:43], s26 offen offset:0 sc1
    buffer_load_dwordx4 a[164:167], v18, s[40:43], s26 offen offset:1024 sc1
    buffer_load_dwordx4 a[168:171], v18, s[40:43], s26 offen offset:2048 sc1
    buffer_load_dwordx4 a[172:175], v18, s[40:43], s26 offen offset:3072 sc1
    s_add_u32 s26, s26, 4096
    buffer_load_dwordx4 a[176:179], v18, s[40:43], s26 offen offset:0 sc1
    buffer_load_dwordx4 a[180:183], v18, s[40:43], s26 offen offset:1024 sc1
    buffer_load_dwordx4 a[184:187], v18, s[40:43], s26 offen offset:2048 sc1
    buffer_load_dwordx4 a[188:191], v18, s[40:43], s26 offen offset:3072 sc1
    s_add_u32 s26, s26, 4096
    ds_read_b128 a[64:67], v14 offset:0
    ds_read_b128 a[68:71], v15 offset:0
    ds_read_b128 a[72:75], v14 offset:1152
    ds_read_b128 a[76:79], v15 offset:1152
    ds_read_b64_tr_b16 a[48:49], v10 offset:9216
    ds_read_b64_tr_b16 a[50:51], v10 offset:9472
    ds_read_b64_tr_b16 a[52:53], v11 offset:9216
    s_waitcnt lgkmcnt(7)
    v_mfma_f32_32x32x16_bf16 v[96:111], a[30:33], v[40:43], 0
    v_max3_f32 v56, v56, v64, v65
    v_max3_f32 v57, v57, v66, v67
    v_max3_f32 v56, v56, v68, v69
    v_max3_f32 v57, v57, v70, v71
    v_mfma_f32_32x32x16_bf16 v[112:127], a[36:39], v[48:51], 0
    v_max3_f32 v56, v56, v72, v73
    v_max3_f32 v57, v57, v74, v75
    v_max3_f32 v56, v56, v76, v77
    v_max3_f32 v57, v57, v78, v79
    v_mfma_f32_32x32x16_bf16 v[96:111], a[34:37], v[44:47], v[96:111]
    v_max3_f32 v58, v58, v80, v81
    v_max3_f32 v59, v59, v82, v83
    v_max3_f32 v58, v58, v84, v85
    v_max3_f32 v59, v59, v86, v87
    v_mfma_f32_32x32x16_bf16 v[112:127], a[40:43], v[52:55], v[112:127]
    v_max3_f32 v58, v58, v88, v89
    v_max3_f32 v59, v59, v90, v91
    v_max3_f32 v58, v58, v92, v93
    v_max3_f32 v59, v59, v94, v95
    ds_read_b128 a[80:83], v14 offset:2304
    ds_read_b128 a[84:87], v15 offset:2304
    ds_read_b128 a[88:91], v14 offset:3456
    ds_read_b128 a[92:95], v15 offset:3456
    ds_read_b64_tr_b16 a[54:55], v10 offset:10368
    ds_read_b64_tr_b16 a[56:57], v10 offset:10624
    ds_read_b64_tr_b16 a[58:59], v11 offset:10368
    s_waitcnt lgkmcnt(7)
    v_mfma_f32_32x32x16_bf16 v[64:79], a[36:39], v[40:43], 0
    v_max3_f32 v56, v56, v96, v97
    v_max3_f32 v57, v57, v98, v99
    v_max3_f32 v56, v56, v100, v101
    v_max3_f32 v57, v57, v102, v103
    v_mfma_f32_32x32x16_bf16 v[80:95], a[42:45], v[48:51], 0
    v_max3_f32 v56, v56, v104, v105
    v_max3_f32 v57, v57, v106, v107
    v_max3_f32 v56, v56, v108, v109
    v_max3_f32 v57, v57, v110, v111
    v_mfma_f32_32x32x16_bf16 v[64:79], a[40:43], v[44:47], v[64:79]
    v_max3_f32 v58, v58, v112, v113
    v_max3_f32 v59, v59, v114, v115
    v_max3_f32 v58, v58, v116, v117
    v_max3_f32 v59, v59, v118, v119
    v_mfma_f32_32x32x16_bf16 v[80:95], a[46:49], v[52:55], v[80:95]
    v_max3_f32 v58, v58, v120, v121
    v_max3_f32 v59, v59, v122, v123
    v_max3_f32 v58, v58, v124, v125
    v_max3_f32 v59, v59, v126, v127
    ds_read_b128 a[96:99], v14 offset:4608
    ds_read_b128 a[100:103], v15 offset:4608
    ds_read_b128 a[104:107], v14 offset:5760
    ds_read_b128 a[108:111], v15 offset:5760
    s_waitcnt lgkmcnt(4)
    v_mfma_f32_32x32x16_bf16 v[96:111], a[42:45], v[40:43], 0
    v_max3_f32 v56, v56, v64, v65
    v_max3_f32 v57, v57, v66, v67
    v_max3_f32 v56, v56, v68, v69
    v_max3_f32 v57, v57, v70, v71
    v_mfma_f32_32x32x16_bf16 v[112:127], a[48:51], v[48:51], 0
    v_max3_f32 v56, v56, v72, v73
    v_max3_f32 v57, v57, v74, v75
    v_max3_f32 v56, v56, v76, v77
    v_max3_f32 v57, v57, v78, v79
    v_mfma_f32_32x32x16_bf16 v[96:111], a[46:49], v[44:47], v[96:111]
    v_max3_f32 v58, v58, v80, v81
    v_max3_f32 v59, v59, v82, v83
    v_max3_f32 v58, v58, v84, v85
    v_max3_f32 v59, v59, v86, v87
    v_mfma_f32_32x32x16_bf16 v[112:127], a[52:55], v[52:55], v[112:127]
    v_max3_f32 v58, v58, v88, v89
    v_max3_f32 v59, v59, v90, v91
    v_max3_f32 v58, v58, v92, v93
    v_max3_f32 v59, v59, v94, v95
    ds_read_b128 a[112:115], v14 offset:6912
    ds_read_b128 a[116:119], v15 offset:6912
    ds_read_b128 a[120:123], v14 offset:8064
    ds_read_b128 a[124:127], v15 offset:8064
    v_cndmask_b32 v64, v9, v19, s[48:49]
    v_cndmask_b32 v65, v9, v19, s[50:51]
    v_cndmask_b32 v66, v9, v19, s[52:53]
    v_cndmask_b32 v67, v9, v19, s[54:55]
    v_cndmask_b32 v68, v9, v19, s[56:57]
    v_cndmask_b32 v69, v9, v19, s[58:59]
    v_cndmask_b32 v70, v9, v19, s[60:61]
    v_cndmask_b32 v71, v9, v19, s[62:63]
    v_cndmask_b32 v72, v9, v19, s[64:65]
    v_cndmask_b32 v73, v9, v19, s[66:67]
    v_cndmask_b32 v74, v9, v19, s[68:69]
    v_cndmask_b32 v75, v9, v19, s[70:71]
    v_cndmask_b32 v76, v9, v19, s[72:73]
    v_cndmask_b32 v77, v9, v19, s[74:75]
    v_cndmask_b32 v78, v9, v19, s[76:77]
    v_cndmask_b32 v79, v9, v19, s[78:79]
    v_cndmask_b32 v80, v9, v19, s[48:49]
    v_cndmask_b32 v81, v9, v19, s[50:51]
    v_cndmask_b32 v82, v9, v19, s[52:53]
    v_cndmask_b32 v83, v9, v19, s[54:55]
    v_cndmask_b32 v84, v9, v19, s[56:57]
    v_cndmask_b32 v85, v9, v19, s[58:59]
    v_cndmask_b32 v86, v9, v19, s[60:61]
    v_cndmask_b32 v87, v9, v19, s[62:63]
    v_cndmask_b32 v88, v9, v19, s[64:65]
    v_cndmask_b32 v89, v9, v19, s[66:67]
    v_cndmask_b32 v90, v9, v19, s[68:69]
    v_cndmask_b32 v91, v9, v19, s[70:71]
    v_cndmask_b32 v92, v9, v19, s[72:73]
    v_cndmask_b32 v93, v9, v19, s[74:75]
    v_cndmask_b32 v94, v9, v19, s[76:77]
    v_cndmask_b32 v95, v9, v19, s[78:79]
    s_nop 1
    v_mfma_f32_32x32x16_bf16 v[64:79], a[48:51], v[40:43], v[64:79]
    v_max3_f32 v56, v56, v96, v97
    v_max3_f32 v57, v57, v98, v99
    v_max3_f32 v56, v56, v100, v101
    v_max3_f32 v57, v57, v102, v103
    v_mfma_f32_32x32x16_bf16 v[80:95], a[54:57], v[48:51], v[80:95]
    v_max3_f32 v56, v56, v104, v105
    v_max3_f32 v57, v57, v106, v107
    v_max3_f32 v56, v56, v108, v109
    v_max3_f32 v57, v57, v110, v111
    v_mfma_f32_32x32x16_bf16 v[64:79], a[52:55], v[44:47], v[64:79]
    v_max3_f32 v58, v58, v112, v113
    v_max3_f32 v59, v59, v114, v115
    v_max3_f32 v58, v58, v116, v117
    v_max3_f32 v59, v59, v118, v119
    v_mfma_f32_32x32x16_bf16 v[80:95], a[58:61], v[52:55], v[80:95]
    v_max3_f32 v58, v58, v120, v121
    v_max3_f32 v59, v59, v122, v123
    v_max3_f32 v58, v58, v124, v125
    v_max3_f32 v59, v59, v126, v127
    ds_read_b128 a[128:131], v14 offset:9216
    ds_read_b128 a[132:135], v15 offset:9216
    ds_read_b128 a[136:139], v14 offset:10368
    ds_read_b128 a[140:143], v15 offset:10368
    s_nop 7
    v_max3_f32 v56, v56, v64, v65
    v_max3_f32 v57, v57, v66, v67
    v_max3_f32 v56, v56, v68, v69
    v_max3_f32 v57, v57, v70, v71
    v_max3_f32 v56, v56, v72, v73
    v_max3_f32 v57, v57, v74, v75
    v_max3_f32 v56, v56, v76, v77
    v_max3_f32 v57, v57, v78, v79
    v_max_f32 v56, v56, v57
    v_mov_b32 v57, v56
    s_nop 1
    v_permlane32_swap_b32 v56, v57
    s_nop 1
    v_max_f32 v56, v56, v57
    v_sub_f32 v56, 0, v56
    v_mov_b32 v144, v56
    v_mov_b32 v145, v56
    v_mov_b32 v146, v56
    v_mov_b32 v147, v56
    v_mov_b32 v148, v56
    v_mov_b32 v149, v56
    v_mov_b32 v150, v56
    v_mov_b32 v151, v56
    v_mov_b32 v152, v56
    v_mov_b32 v153, v56
    v_mov_b32 v154, v56
    v_mov_b32 v155, v56
    v_mov_b32 v156, v56
    v_mov_b32 v157, v56
    v_mov_b32 v158, v56
    v_mov_b32 v159, v56
    v_max3_f32 v58, v58, v80, v81
    v_max3_f32 v59, v59, v82, v83
    v_max3_f32 v58, v58, v84, v85
    v_max3_f32 v59, v59, v86, v87
    v_max3_f32 v58, v58, v88, v89
    v_max3_f32 v59, v59, v90, v91
    v_max3_f32 v58, v58, v92, v93
    v_max3_f32 v59, v59, v94, v95
    v_max_f32 v58, v58, v59
    v_mov_b32 v59, v58
    s_nop 1
    v_permlane32_swap_b32 v58, v59
    s_nop 1
    v_max_f32 v58, v58, v59
    v_sub_f32 v58, 0, v58
    v_mov_b32 v160, v58
    v_mov_b32 v161, v58
    v_mov_b32 v162, v58
    v_mov_b32 v163, v58
    v_mov_b32 v164, v58
    v_mov_b32 v165, v58
    v_mov_b32 v166, v58
    v_mov_b32 v167, v58
    v_mov_b32 v168, v58
    v_mov_b32 v169, v58
    v_mov_b32 v170, v58
    v_mov_b32 v171, v58
    v_mov_b32 v172, v58
    v_mov_b32 v173, v58
    v_mov_b32 v174, v58
    v_mov_b32 v175, v58
    s_waitcnt lgkmcnt(0)
    v_cndmask_b32 v64, v19, v56, s[48:49]
    v_cndmask_b32 v65, v19, v56, s[50:51]
    v_cndmask_b32 v66, v19, v56, s[52:53]
    v_cndmask_b32 v67, v19, v56, s[54:55]
    v_cndmask_b32 v68, v19, v56, s[56:57]
    v_cndmask_b32 v69, v19, v56, s[58:59]
    v_cndmask_b32 v70, v19, v56, s[60:61]
    v_cndmask_b32 v71, v19, v56, s[62:63]
    v_cndmask_b32 v72, v19, v56, s[64:65]
    v_cndmask_b32 v73, v19, v56, s[66:67]
    v_cndmask_b32 v74, v19, v56, s[68:69]
    v_cndmask_b32 v75, v19, v56, s[70:71]
    v_cndmask_b32 v76, v19, v56, s[72:73]
    v_cndmask_b32 v77, v19, v56, s[74:75]
    v_cndmask_b32 v78, v19, v56, s[76:77]
    v_cndmask_b32 v79, v19, v56, s[78:79]
    s_nop 1
    v_mfma_f32_32x32x16_bf16 v[64:79], a[0:3], v[40:43], v[64:79]
    v_mfma_f32_32x32x16_bf16 v[64:79], a[4:7], v[44:47], v[64:79]
    s_nop 1
    v_mfma_f32_32x32x16_bf16 v[80:95], a[6:9], v[40:43], v[144:159]
    v_mfma_f32_32x32x16_bf16 v[80:95], a[10:13], v[44:47], v[80:95]
    s_nop 11
    v_exp_f32 v64, v64
    v_exp_f32 v65, v65
    v_exp_f32 v66, v66
    v_exp_f32 v67, v67
    v_exp_f32 v68, v68
    v_exp_f32 v69, v69
    v_exp_f32 v70, v70
    v_exp_f32 v71, v71
    v_mfma_f32_32x32x16_bf16 v[96:111], a[12:15], v[40:43], v[144:159]
    v_cvt_pk_bf16_f32 v64, v64, v65
    v_cvt_pk_bf16_f32 v65, v66, v67
    v_cvt_pk_bf16_f32 v66, v68, v69
    v_cvt_pk_bf16_f32 v67, v70, v71
    v_exp_f32 v72, v72
    v_exp_f32 v73, v73
    v_mfma_f32_32x32x16_bf16 v[176:191], a[64:67], v[64:67], 0
    v_exp_f32 v74, v74
    v_exp_f32 v75, v75
    v_exp_f32 v76, v76
    v_exp_f32 v77, v77
    v_exp_f32 v78, v78
    v_exp_f32 v79, v79
    v_mfma_f32_32x32x16_bf16 v[96:111], a[16:19], v[44:47], v[96:111]
    v_cvt_pk_bf16_f32 v68, v72, v73
    v_cvt_pk_bf16_f32 v69, v74, v75
    v_cvt_pk_bf16_f32 v70, v76, v77
    v_cvt_pk_bf16_f32 v71, v78, v79
    v_exp_f32 v80, v80
    v_exp_f32 v81, v81
    v_exp_f32 v82, v82
    v_exp_f32 v83, v83
    v_mfma_f32_32x32x16_bf16 v[176:191], a[68:71], v[68:71], v[176:191]
    v_exp_f32 v84, v84
    v_exp_f32 v85, v85
    v_exp_f32 v86, v86
    v_exp_f32 v87, v87
    v_mfma_f32_32x32x16_bf16 v[64:79], a[18:21], v[40:43], v[144:159]
    v_cvt_pk_bf16_f32 v80, v80, v81
    v_cvt_pk_bf16_f32 v81, v82, v83
    v_cvt_pk_bf16_f32 v82, v84, v85
    v_cvt_pk_bf16_f32 v83, v86, v87
    v_exp_f32 v88, v88
    v_exp_f32 v89, v89
    v_mfma_f32_32x32x16_bf16 v[176:191], a[72:75], v[80:83], v[176:191]
    v_exp_f32 v90, v90
    v_exp_f32 v91, v91
    v_exp_f32 v92, v92
    v_exp_f32 v93, v93
    v_exp_f32 v94, v94
    v_exp_f32 v95, v95
    v_mfma_f32_32x32x16_bf16 v[64:79], a[22:25], v[44:47], v[64:79]
    v_cvt_pk_bf16_f32 v84, v88, v89
    v_cvt_pk_bf16_f32 v85, v90, v91
    v_cvt_pk_bf16_f32 v86, v92, v93
    v_cvt_pk_bf16_f32 v87, v94, v95
    s_waitcnt vmcnt(7)
    v_mfma_f32_16x16x32_bf16 v[232:235], v[224:227], a[160:163], 0
    v_mfma_f32_16x16x32_bf16 v[236:239], v[228:231], a[160:163], 0
    buffer_load_dwordx4 a[160:163], v18, s[40:43], s26 offen offset:0 sc1
    v_exp_f32 v96, v96
    v_exp_f32 v97, v97
    v_exp_f32 v98, v98
    v_exp_f32 v99, v99
    v_mfma_f32_32x32x16_bf16 v[176:191], a[76:79], v[84:87], v[176:191]
    v_exp_f32 v100, v100
    v_exp_f32 v101, v101
    v_exp_f32 v102, v102
    v_exp_f32 v103, v103
    v_mfma_f32_32x32x16_bf16 v[80:95], a[24:27], v[40:43], v[144:159]
    v_cvt_pk_bf16_f32 v96, v96, v97
    v_cvt_pk_bf16_f32 v97, v98, v99
    v_cvt_pk_bf16_f32 v98, v100, v101
    v_cvt_pk_bf16_f32 v99, v102, v103
    v_exp_f32 v104, v104
    v_exp_f32 v105, v105
    v_mfma_f32_32x32x16_bf16 v[176:191], a[80:83], v[96:99], v[176:191]
    v_exp_f32 v106, v106
    v_exp_f32 v107, v107
    v_exp_f32 v108, v108
    v_exp_f32 v109, v109
    v_exp_f32 v110, v110
    v_exp_f32 v111, v111
    v_mfma_f32_32x32x16_bf16 v[80:95], a[28:31], v[44:47], v[80:95]
    v_cvt_pk_bf16_f32 v100, v104, v105
    v_cvt_pk_bf16_f32 v101, v106, v107
    v_cvt_pk_bf16_f32 v102, v108, v109
    v_cvt_pk_bf16_f32 v103, v110, v111
    s_waitcnt vmcnt(7)
    v_mfma_f32_16x16x32_bf16 v[232:235], v[224:227], a[164:167], v[232:235]
    v_mfma_f32_16x16x32_bf16 v[236:239], v[228:231], a[164:167], v[236:239]
    buffer_load_dwordx4 a[164:167], v18, s[40:43], s26 offen offset:1024 sc1
    v_exp_f32 v64, v64
    v_exp_f32 v65, v65
    v_exp_f32 v66, v66
    v_exp_f32 v67, v67
    v_mfma_f32_32x32x16_bf16 v[176:191], a[84:87], v[100:103], v[176:191]
    v_exp_f32 v68, v68
    v_exp_f32 v69, v69
    v_exp_f32 v70, v70
    v_exp_f32 v71, v71
    v_mfma_f32_32x32x16_bf16 v[96:111], a[30:33], v[40:43], v[144:159]
    v_cvt_pk_bf16_f32 v64, v64, v65
    v_cvt_pk_bf16_f32 v65, v66, v67
    v_cvt_pk_bf16_f32 v66, v68, v69
    v_cvt_pk_bf16_f32 v67, v70, v71
    v_exp_f32 v72, v72
    v_exp_f32 v73, v73
    v_mfma_f32_32x32x16_bf16 v[176:191], a[88:91], v[64:67], v[176:191]
    v_exp_f32 v74, v74
    v_exp_f32 v75, v75
    v_exp_f32 v76, v76
    v_exp_f32 v77, v77
    v_exp_f32 v78, v78
    v_exp_f32 v79, v79
    v_mfma_f32_32x32x16_bf16 v[96:111], a[34:37], v[44:47], v[96:111]
    v_cvt_pk_bf16_f32 v68, v72, v73
    v_cvt_pk_bf16_f32 v69, v74, v75
    v_cvt_pk_bf16_f32 v70, v76, v77
    v_cvt_pk_bf16_f32 v71, v78, v79
    s_waitcnt vmcnt(7)
    v_mfma_f32_16x16x32_bf16 v[232:235], v[224:227], a[168:171], v[232:235]
    v_mfma_f32_16x16x32_bf16 v[236:239], v[228:231], a[168:171], v[236:239]
    buffer_load_dwordx4 a[168:171], v18, s[40:43], s26 offen offset:2048 sc1
    v_exp_f32 v80, v80
    v_exp_f32 v81, v81
    v_exp_f32 v82, v82
    v_exp_f32 v83, v83
    v_mfma_f32_32x32x16_bf16 v[176:191], a[92:95], v[68:71], v[176:191]
    v_exp_f32 v84, v84
    v_exp_f32 v85, v85
    v_exp_f32 v86, v86
    v_exp_f32 v87, v87
    v_mfma_f32_32x32x16_bf16 v[64:79], a[36:39], v[40:43], v[144:159]
    v_cvt_pk_bf16_f32 v80, v80, v81
    v_cvt_pk_bf16_f32 v81, v82, v83
    v_cvt_pk_bf16_f32 v82, v84, v85
    v_cvt_pk_bf16_f32 v83, v86, v87
    v_exp_f32 v88, v88
    v_exp_f32 v89, v89
    v_mfma_f32_32x32x16_bf16 v[176:191], a[96:99], v[80:83], v[176:191]
    v_exp_f32 v90, v90
    v_exp_f32 v91, v91
    v_exp_f32 v92, v92
    v_exp_f32 v93, v93
    v_exp_f32 v94, v94
    v_exp_f32 v95, v95
    v_mfma_f32_32x32x16_bf16 v[64:79], a[40:43], v[44:47], v[64:79]
    v_cvt_pk_bf16_f32 v84, v88, v89
    v_cvt_pk_bf16_f32 v85, v90, v91
    v_cvt_pk_bf16_f32 v86, v92, v93
    v_cvt_pk_bf16_f32 v87, v94, v95
    s_waitcnt vmcnt(7)
    v_mfma_f32_16x16x32_bf16 v[232:235], v[224:227], a[172:175], v[232:235]
    v_mfma_f32_16x16x32_bf16 v[236:239], v[228:231], a[172:175], v[236:239]
    buffer_load_dwordx4 a[172:175], v18, s[40:43], s26 offen offset:3072 sc1
    s_add_u32 s26, s26, 4096
    v_exp_f32 v96, v96
    v_exp_f32 v97, v97
    v_exp_f32 v98, v98
    v_exp_f32 v99, v99
    v_mfma_f32_32x32x16_bf16 v[176:191], a[100:103], v[84:87], v[176:191]
    v_exp_f32 v100, v100
    v_exp_f32 v101, v101
    v_exp_f32 v102, v102
    v_exp_f32 v103, v103
    v_mfma_f32_32x32x16_bf16 v[80:95], a[42:45], v[40:43], v[144:159]
    v_cvt_pk_bf16_f32 v96, v96, v97
    v_cvt_pk_bf16_f32 v97, v98, v99
    v_cvt_pk_bf16_f32 v98, v100, v101
    v_cvt_pk_bf16_f32 v99, v102, v103
    v_exp_f32 v104, v104
    v_exp_f32 v105, v105
    v_mfma_f32_32x32x16_bf16 v[176:191], a[104:107], v[96:99], v[176:191]
    v_exp_f32 v106, v106
    v_exp_f32 v107, v107
    v_exp_f32 v108, v108
    v_exp_f32 v109, v109
    v_exp_f32 v110, v110
    v_exp_f32 v111, v111
    v_mfma_f32_32x32x16_bf16 v[80:95], a[46:49], v[44:47], v[80:95]
    v_cvt_pk_bf16_f32 v100, v104, v105
    v_cvt_pk_bf16_f32 v101, v106, v107
    v_cvt_pk_bf16_f32 v102, v108, v109
    v_cvt_pk_bf16_f32 v103, v110, v111
    s_waitcnt vmcnt(7)
    v_mfma_f32_16x16x32_bf16 v[232:235], v[224:227], a[176:179], v[232:235]
    v_mfma_f32_16x16x32_bf16 v[236:239], v[228:231], a[176:179], v[236:239]
    buffer_load_dwordx4 a[176:179], v18, s[40:43], s26 offen offset:0 sc1
    v_exp_f32 v64, v64
    v_exp_f32 v65, v65
    v_exp_f32 v66, v66
    v_exp_f32 v67, v67
    v_mfma_f32_32x32x16_bf16 v[176:191], a[108:111], v[100:103], v[176:191]
    v_cndmask_b32 v96, v56, v19, s[48:49]
    v_cndmask_b32 v97, v56, v19, s[50:51]
    v_cndmask_b32 v98, v56, v19, s[52:53]
    v_cndmask_b32 v99, v56, v19, s[54:55]
    v_cndmask_b32 v100, v56, v19, s[56:57]
    v_cndmask_b32 v101, v56, v19, s[58:59]
    v_cndmask_b32 v102, v56, v19, s[60:61]
    v_cndmask_b32 v103, v56, v19, s[62:63]
    v_cndmask_b32 v104, v56, v19, s[64:65]
    v_cndmask_b32 v105, v56, v19, s[66:67]
    v_cndmask_b32 v106, v56, v19, s[68:69]
    v_cndmask_b32 v107, v56, v19, s[70:71]
    v_cndmask_b32 v108, v56, v19, s[72:73]
    v_cndmask_b32 v109, v56, v19, s[74:75]
    v_cndmask_b32 v110, v56, v19, s[76:77]
    v_cndmask_b32 v111, v56, v19, s[78:79]
    v_exp_f32 v68, v68
    v_exp_f32 v69, v69
    v_exp_f32 v70, v70
    v_exp_f32 v71, v71
    v_mfma_f32_32x32x16_bf16 v[96:111], a[48:51], v[40:43], v[96:111]
    v_cvt_pk_bf16_f32 v64, v64, v65
    v_cvt_pk_bf16_f32 v65, v66, v67
    v_cvt_pk_bf16_f32 v66, v68, v69
    v_cvt_pk_bf16_f32 v67, v70, v71
    v_exp_f32 v72, v72
    v_exp_f32 v73, v73
    v_mfma_f32_32x32x16_bf16 v[176:191], a[112:115], v[64:67], v[176:191]
    v_exp_f32 v74, v74
    v_exp_f32 v75, v75
    v_exp_f32 v76, v76
    v_exp_f32 v77, v77
    v_exp_f32 v78, v78
    v_exp_f32 v79, v79
    v_mfma_f32_32x32x16_bf16 v[96:111], a[52:55], v[44:47], v[96:111]
    v_cvt_pk_bf16_f32 v68, v72, v73
    v_cvt_pk_bf16_f32 v69, v74, v75
    v_cvt_pk_bf16_f32 v70, v76, v77
    v_cvt_pk_bf16_f32 v71, v78, v79
    s_waitcnt vmcnt(7)
    v_mfma_f32_16x16x32_bf16 v[232:235], v[224:227], a[180:183], v[232:235]
    v_mfma_f32_16x16x32_bf16 v[236:239], v[228:231], a[180:183], v[236:239]
    buffer_load_dwordx4 a[180:183], v18, s[40:43], s26 offen offset:1024 sc1
    v_exp_f32 v80, v80
    v_exp_f32 v81, v81
    v_exp_f32 v82, v82
    v_exp_f32 v83, v83
    v_mfma_f32_32x32x16_bf16 v[176:191], a[116:119], v[68:71], v[176:191]
    v_cndmask_b32 v64, v19, v58, s[48:49]
    v_cndmask_b32 v65, v19, v58, s[50:51]
    v_cndmask_b32 v66, v19, v58, s[52:53]
    v_cndmask_b32 v67, v19, v58, s[54:55]
    v_cndmask_b32 v68, v19, v58, s[56:57]
    v_cndmask_b32 v69, v19, v58, s[58:59]
    v_cndmask_b32 v70, v19, v58, s[60:61]
    v_cndmask_b32 v71, v19, v58, s[62:63]
    v_cndmask_b32 v72, v19, v58, s[64:65]
    v_cndmask_b32 v73, v19, v58, s[66:67]
    v_cndmask_b32 v74, v19, v58, s[68:69]
    v_cndmask_b32 v75, v19, v58, s[70:71]
    v_cndmask_b32 v76, v19, v58, s[72:73]
    v_cndmask_b32 v77, v19, v58, s[74:75]
    v_cndmask_b32 v78, v19, v58, s[76:77]
    v_cndmask_b32 v79, v19, v58, s[78:79]
    v_exp_f32 v84, v84
    v_exp_f32 v85, v85
    v_exp_f32 v86, v86
    v_exp_f32 v87, v87
    v_mfma_f32_32x32x16_bf16 v[64:79], a[6:9], v[48:51], v[64:79]
    v_cvt_pk_bf16_f32 v80, v80, v81
    v_cvt_pk_bf16_f32 v81, v82, v83
    v_cvt_pk_bf16_f32 v82, v84, v85
    v_cvt_pk_bf16_f32 v83, v86, v87
    v_exp_f32 v88, v88
    v_exp_f32 v89, v89
    v_mfma_f32_32x32x16_bf16 v[176:191], a[120:123], v[80:83], v[176:191]
    v_exp_f32 v90, v90
    v_exp_f32 v91, v91
    v_exp_f32 v92, v92
    v_exp_f32 v93, v93
    v_exp_f32 v94, v94
    v_exp_f32 v95, v95
    v_mfma_f32_32x32x16_bf16 v[64:79], a[10:13], v[52:55], v[64:79]
    v_cvt_pk_bf16_f32 v84, v88, v89
    v_cvt_pk_bf16_f32 v85, v90, v91
    v_cvt_pk_bf16_f32 v86, v92, v93
    v_cvt_pk_bf16_f32 v87, v94, v95
    s_waitcnt vmcnt(7)
    v_mfma_f32_16x16x32_bf16 v[232:235], v[224:227], a[184:187], v[232:235]
    v_mfma_f32_16x16x32_bf16 v[236:239], v[228:231], a[184:187], v[236:239]
    buffer_load_dwordx4 a[184:187], v18, s[40:43], s26 offen offset:2048 sc1
    v_exp_f32 v96, v96
    v_exp_f32 v97, v97
    v_exp_f32 v98, v98
    v_exp_f32 v99, v99
    v_mfma_f32_32x32x16_bf16 v[176:191], a[124:127], v[84:87], v[176:191]
    v_exp_f32 v100, v100
    v_exp_f32 v101, v101
    v_exp_f32 v102, v102
    v_exp_f32 v103, v103
    v_mfma_f32_32x32x16_bf16 v[80:95], a[12:15], v[48:51], v[160:175]
    v_cvt_pk_bf16_f32 v96, v96, v97
    v_cvt_pk_bf16_f32 v97, v98, v99
    v_cvt_pk_bf16_f32 v98, v100, v101
    v_cvt_pk_bf16_f32 v99, v102, v103
    v_exp_f32 v104, v104
    v_exp_f32 v105, v105
    v_mfma_f32_32x32x16_bf16 v[176:191], a[128:131], v[96:99], v[176:191]
    v_exp_f32 v106, v106
    v_exp_f32 v107, v107
    v_exp_f32 v108, v108
    v_exp_f32 v109, v109
    v_exp_f32 v110, v110
    v_exp_f32 v111, v111
    v_mfma_f32_32x32x16_bf16 v[80:95], a[16:19], v[52:55], v[80:95]
    v_cvt_pk_bf16_f32 v100, v104, v105
    v_cvt_pk_bf16_f32 v101, v106, v107
    v_cvt_pk_bf16_f32 v102, v108, v109
    v_cvt_pk_bf16_f32 v103, v110, v111
    s_waitcnt vmcnt(7)
    v_mfma_f32_16x16x32_bf16 v[232:235], v[224:227], a[188:191], v[232:235]
    v_mfma_f32_16x16x32_bf16 v[236:239], v[228:231], a[188:191], v[236:239]
    buffer_load_dwordx4 a[188:191], v18, s[40:43], s26 offen offset:3072 sc1
    s_add_u32 s26, s26, 4096
    v_exp_f32 v64, v64
    v_exp_f32 v65, v65
    v_exp_f32 v66, v66
    v_exp_f32 v67, v67
    v_mfma_f32_32x32x16_bf16 v[176:191], a[132:135], v[100:103], v[176:191]
    v_exp_f32 v68, v68
    v_exp_f32 v69, v69
    v_exp_f32 v70, v70
    v_exp_f32 v71, v71
    v_mfma_f32_32x32x16_bf16 v[96:111], a[18:21], v[48:51], v[160:175]
    v_cvt_pk_bf16_f32 v64, v64, v65
    v_cvt_pk_bf16_f32 v65, v66, v67
    v_cvt_pk_bf16_f32 v66, v68, v69
    v_cvt_pk_bf16_f32 v67, v70, v71
    v_exp_f32 v72, v72
    v_exp_f32 v73, v73
    v_mfma_f32_32x32x16_bf16 v[192:207], a[72:75], v[64:67], 0
    v_exp_f32 v74, v74
    v_exp_f32 v75, v75
    v_exp_f32 v76, v76
    v_exp_f32 v77, v77
    v_exp_f32 v78, v78
    v_exp_f32 v79, v79
    v_mfma_f32_32x32x16_bf16 v[96:111], a[22:25], v[52:55], v[96:111]
    v_cvt_pk_bf16_f32 v68, v72, v73
    v_cvt_pk_bf16_f32 v69, v74, v75
    v_cvt_pk_bf16_f32 v70, v76, v77
    v_cvt_pk_bf16_f32 v71, v78, v79
    s_waitcnt vmcnt(7)
    v_mfma_f32_16x16x32_bf16 v[232:235], v[224:227], a[160:163], v[232:235]
    v_mfma_f32_16x16x32_bf16 v[236:239], v[228:231], a[160:163], v[236:239]
    v_exp_f32 v80, v80
    v_exp_f32 v81, v81
    v_exp_f32 v82, v82
    v_exp_f32 v83, v83
    v_mfma_f32_32x32x16_bf16 v[192:207], a[76:79], v[68:71], v[192:207]
    v_exp_f32 v84, v84
    v_exp_f32 v85, v85
    v_exp_f32 v86, v86
    v_exp_f32 v87, v87
    v_mfma_f32_32x32x16_bf16 v[64:79], a[24:27], v[48:51], v[160:175]
    v_cvt_pk_bf16_f32 v80, v80, v81
    v_cvt_pk_bf16_f32 v81, v82, v83
    v_cvt_pk_bf16_f32 v82, v84, v85
    v_cvt_pk_bf16_f32 v83, v86, v87
    v_exp_f32 v88, v88
    v_exp_f32 v89, v89
    v_mfma_f32_32x32x16_bf16 v[192:207], a[80:83], v[80:83], v[192:207]
    v_exp_f32 v90, v90
    v_exp_f32 v91, v91
    v_exp_f32 v92, v92
    v_exp_f32 v93, v93
    v_exp_f32 v94, v94
    v_exp_f32 v95, v95
    v_mfma_f32_32x32x16_bf16 v[64:79], a[28:31], v[52:55], v[64:79]
    v_cvt_pk_bf16_f32 v84, v88, v89
    v_cvt_pk_bf16_f32 v85, v90, v91
    v_cvt_pk_bf16_f32 v86, v92, v93
    v_cvt_pk_bf16_f32 v87, v94, v95
    s_waitcnt vmcnt(6)
    v_mfma_f32_16x16x32_bf16 v[232:235], v[224:227], a[164:167], v[232:235]
    v_mfma_f32_16x16x32_bf16 v[236:239], v[228:231], a[164:167], v[236:239]
    v_exp_f32 v96, v96
    v_exp_f32 v97, v97
    v_exp_f32 v98, v98
    v_exp_f32 v99, v99
    v_mfma_f32_32x32x16_bf16 v[192:207], a[84:87], v[84:87], v[192:207]
    v_exp_f32 v100, v100
    v_exp_f32 v101, v101
    v_exp_f32 v102, v102
    v_exp_f32 v103, v103
    v_mfma_f32_32x32x16_bf16 v[80:95], a[30:33], v[48:51], v[160:175]
    v_cvt_pk_bf16_f32 v96, v96, v97
    v_cvt_pk_bf16_f32 v97, v98, v99
    v_cvt_pk_bf16_f32 v98, v100, v101
    v_cvt_pk_bf16_f32 v99, v102, v103
    v_exp_f32 v104, v104
    v_exp_f32 v105, v105
    v_mfma_f32_32x32x16_bf16 v[192:207], a[88:91], v[96:99], v[192:207]
    v_exp_f32 v106, v106
    v_exp_f32 v107, v107
    v_exp_f32 v108, v108
    v_exp_f32 v109, v109
    v_exp_f32 v110, v110
    v_exp_f32 v111, v111
    v_mfma_f32_32x32x16_bf16 v[80:95], a[34:37], v[52:55], v[80:95]
    v_cvt_pk_bf16_f32 v100, v104, v105
    v_cvt_pk_bf16_f32 v101, v106, v107
    v_cvt_pk_bf16_f32 v102, v108, v109
    v_cvt_pk_bf16_f32 v103, v110, v111
    s_waitcnt vmcnt(5)
    v_mfma_f32_16x16x32_bf16 v[232:235], v[224:227], a[168:171], v[232:235]
    v_mfma_f32_16x16x32_bf16 v[236:239], v[228:231], a[168:171], v[236:239]
    v_rcp_f32 v214, v186
    s_nop 0
    v_mul_f32 v176, v176, v214
    v_mul_f32 v177, v177, v214
    v_mul_f32 v178, v178, v214
    v_mul_f32 v179, v179, v214
    v_mul_f32 v180, v180, v214
    v_mul_f32 v181, v181, v214
    v_mul_f32 v182, v182, v214
    v_mul_f32 v183, v183, v214
    v_mul_f32 v184, v184, v214
    v_mul_f32 v185, v185, v214
    v_cvt_pk_bf16_f32 v176, v176, v177
    v_cvt_pk_bf16_f32 v177, v178, v179
    v_cvt_pk_bf16_f32 v178, v180, v181
    v_cvt_pk_bf16_f32 v179, v182, v183
    v_cvt_pk_bf16_f32 v180, v184, v185
    buffer_store_dwordx2 v[176:177], v16, s[8:11], 0 offen
    buffer_store_dwordx2 v[178:179], v16, s[8:11], 0 offen offset:16
    buffer_store_dword v180, v17, s[8:11], 0 offen offset:32
    v_exp_f32 v64, v64
    v_exp_f32 v65, v65
    v_exp_f32 v66, v66
    v_exp_f32 v67, v67
    v_mfma_f32_32x32x16_bf16 v[192:207], a[92:95], v[100:103], v[192:207]
    v_exp_f32 v68, v68
    v_exp_f32 v69, v69
    v_exp_f32 v70, v70
    v_exp_f32 v71, v71
    v_mfma_f32_32x32x16_bf16 v[96:111], a[36:39], v[48:51], v[160:175]
    v_cvt_pk_bf16_f32 v64, v64, v65
    v_cvt_pk_bf16_f32 v65, v66, v67
    v_cvt_pk_bf16_f32 v66, v68, v69
    v_cvt_pk_bf16_f32 v67, v70, v71
    v_exp_f32 v72, v72
    v_exp_f32 v73, v73
    v_mfma_f32_32x32x16_bf16 v[192:207], a[96:99], v[64:67], v[192:207]
    v_exp_f32 v74, v74
    v_exp_f32 v75, v75
    v_exp_f32 v76, v76
    v_exp_f32 v77, v77
    v_exp_f32 v78, v78
    v_exp_f32 v79, v79
    v_mfma_f32_32x32x16_bf16 v[96:111], a[40:43], v[52:55], v[96:111]
    v_cvt_pk_bf16_f32 v68, v72, v73
    v_cvt_pk_bf16_f32 v69, v74, v75
    v_cvt_pk_bf16_f32 v70, v76, v77
    v_cvt_pk_bf16_f32 v71, v78, v79
    s_waitcnt vmcnt(4)
    v_mfma_f32_16x16x32_bf16 v[232:235], v[224:227], a[172:175], v[232:235]
    v_mfma_f32_16x16x32_bf16 v[236:239], v[228:231], a[172:175], v[236:239]
    v_exp_f32 v80, v80
    v_exp_f32 v81, v81
    v_exp_f32 v82, v82
    v_exp_f32 v83, v83
    v_mfma_f32_32x32x16_bf16 v[192:207], a[100:103], v[68:71], v[192:207]
    v_exp_f32 v84, v84
    v_exp_f32 v85, v85
    v_exp_f32 v86, v86
    v_exp_f32 v87, v87
    v_mfma_f32_32x32x16_bf16 v[64:79], a[42:45], v[48:51], v[160:175]
    v_cvt_pk_bf16_f32 v80, v80, v81
    v_cvt_pk_bf16_f32 v81, v82, v83
    v_cvt_pk_bf16_f32 v82, v84, v85
    v_cvt_pk_bf16_f32 v83, v86, v87
    v_exp_f32 v88, v88
    v_exp_f32 v89, v89
    v_mfma_f32_32x32x16_bf16 v[192:207], a[104:107], v[80:83], v[192:207]
    v_exp_f32 v90, v90
    v_exp_f32 v91, v91
    v_exp_f32 v92, v92
    v_exp_f32 v93, v93
    v_exp_f32 v94, v94
    v_exp_f32 v95, v95
    v_mfma_f32_32x32x16_bf16 v[64:79], a[46:49], v[52:55], v[64:79]
    v_cvt_pk_bf16_f32 v84, v88, v89
    v_cvt_pk_bf16_f32 v85, v90, v91
    v_cvt_pk_bf16_f32 v86, v92, v93
    v_cvt_pk_bf16_f32 v87, v94, v95
    s_waitcnt vmcnt(3)
    v_mfma_f32_16x16x32_bf16 v[232:235], v[224:227], a[176:179], v[232:235]
    v_mfma_f32_16x16x32_bf16 v[236:239], v[228:231], a[176:179], v[236:239]
    s_lshr_b32 s90, s2, 3
    s_lshl_b32 s90, s90, 2
    s_add_u32 s90, s90, s44
    s_add_u32 s32, s22, 15728640
    s_addc_u32 s33, s23, 0
    s_mov_b32 s34, 663552
    s_mov_b32 s35, 0x00020000
    v_min_u32 v2, 40, v1
    v_lshlrev_b32 v2, 7, v2
    s_mul_i32 s91, s90, 5248
    buffer_load_dword v31, v2, s[32:35], s91 offen
    v_min_u32 v2, 17, v1
    v_lshlrev_b32 v2, 7, v2
    s_mul_i32 s91, s90, 2304
    s_and_b32 s90, s2, 7
    s_mul_i32 s90, s90, 294912
    s_add_u32 s91, s91, s90
    s_mov_b32 s32, s88
    s_mov_b32 s33, s89
    s_mov_b32 s34, 2359296
    s_mov_b32 s35, 0x00020000
    buffer_load_dword v31, v2, s[32:35], s91 offen
    v_exp_f32 v96, v96
    v_exp_f32 v97, v97
    v_exp_f32 v98, v98
    v_exp_f32 v99, v99
    v_mfma_f32_32x32x16_bf16 v[192:207], a[108:111], v[84:87], v[192:207]
    v_exp_f32 v100, v100
    v_exp_f32 v101, v101
    v_exp_f32 v102, v102
    v_exp_f32 v103, v103
    v_mfma_f32_32x32x16_bf16 v[80:95], a[48:51], v[48:51], v[160:175]
    v_cvt_pk_bf16_f32 v96, v96, v97
    v_cvt_pk_bf16_f32 v97, v98, v99
    v_cvt_pk_bf16_f32 v98, v100, v101
    v_cvt_pk_bf16_f32 v99, v102, v103
    v_exp_f32 v104, v104
    v_exp_f32 v105, v105
    v_mfma_f32_32x32x16_bf16 v[192:207], a[112:115], v[96:99], v[192:207]
    v_exp_f32 v106, v106
    v_exp_f32 v107, v107
    v_exp_f32 v108, v108
    v_exp_f32 v109, v109
    v_exp_f32 v110, v110
    v_exp_f32 v111, v111
    v_mfma_f32_32x32x16_bf16 v[80:95], a[52:55], v[52:55], v[80:95]
    v_cvt_pk_bf16_f32 v100, v104, v105
    v_cvt_pk_bf16_f32 v101, v106, v107
    v_cvt_pk_bf16_f32 v102, v108, v109
    v_cvt_pk_bf16_f32 v103, v110, v111
    s_waitcnt vmcnt(4)
    v_mfma_f32_16x16x32_bf16 v[232:235], v[224:227], a[180:183], v[232:235]
    v_mfma_f32_16x16x32_bf16 v[236:239], v[228:231], a[180:183], v[236:239]
    v_exp_f32 v64, v64
    v_exp_f32 v65, v65
    v_exp_f32 v66, v66
    v_exp_f32 v67, v67
    v_mfma_f32_32x32x16_bf16 v[192:207], a[116:119], v[100:103], v[192:207]
    v_cndmask_b32 v96, v58, v19, s[48:49]
    v_cndmask_b32 v97, v58, v19, s[50:51]
    v_cndmask_b32 v98, v58, v19, s[52:53]
    v_cndmask_b32 v99, v58, v19, s[54:55]
    v_cndmask_b32 v100, v58, v19, s[56:57]
    v_cndmask_b32 v101, v58, v19, s[58:59]
    v_cndmask_b32 v102, v58, v19, s[60:61]
    v_cndmask_b32 v103, v58, v19, s[62:63]
    v_cndmask_b32 v104, v58, v19, s[64:65]
    v_cndmask_b32 v105, v58, v19, s[66:67]
    v_cndmask_b32 v106, v58, v19, s[68:69]
    v_cndmask_b32 v107, v58, v19, s[70:71]
    v_cndmask_b32 v108, v58, v19, s[72:73]
    v_cndmask_b32 v109, v58, v19, s[74:75]
    v_cndmask_b32 v110, v58, v19, s[76:77]
    v_cndmask_b32 v111, v58, v19, s[78:79]
    v_exp_f32 v68, v68
    v_exp_f32 v69, v69
    v_exp_f32 v70, v70
    v_exp_f32 v71, v71
    v_mfma_f32_32x32x16_bf16 v[96:111], a[54:57], v[48:51], v[96:111]
    v_cvt_pk_bf16_f32 v64, v64, v65
    v_cvt_pk_bf16_f32 v65, v66, v67
    v_cvt_pk_bf16_f32 v66, v68, v69
    v_cvt_pk_bf16_f32 v67, v70, v71
    v_exp_f32 v72, v72
    v_exp_f32 v73, v73
    v_mfma_f32_32x32x16_bf16 v[192:207], a[120:123], v[64:67], v[192:207]
    v_exp_f32 v74, v74
    v_exp_f32 v75, v75
    v_exp_f32 v76, v76
    v_exp_f32 v77, v77
    v_exp_f32 v78, v78
    v_exp_f32 v79, v79
    v_mfma_f32_32x32x16_bf16 v[96:111], a[58:61], v[52:55], v[96:111]
    v_cvt_pk_bf16_f32 v68, v72, v73
    v_cvt_pk_bf16_f32 v69, v74, v75
    v_cvt_pk_bf16_f32 v70, v76, v77
    v_cvt_pk_bf16_f32 v71, v78, v79
    s_waitcnt vmcnt(3)
    v_mfma_f32_16x16x32_bf16 v[232:235], v[224:227], a[184:187], v[232:235]
    v_mfma_f32_16x16x32_bf16 v[236:239], v[228:231], a[184:187], v[236:239]
    v_exp_f32 v80, v80
    v_exp_f32 v81, v81
    v_exp_f32 v82, v82
    v_exp_f32 v83, v83
    v_mfma_f32_32x32x16_bf16 v[192:207], a[124:127], v[68:71], v[192:207]
    v_exp_f32 v84, v84
    v_exp_f32 v85, v85
    v_exp_f32 v86, v86
    v_exp_f32 v87, v87
    s_nop 0
    v_cvt_pk_bf16_f32 v80, v80, v81
    v_cvt_pk_bf16_f32 v81, v82, v83
    v_cvt_pk_bf16_f32 v82, v84, v85
    v_cvt_pk_bf16_f32 v83, v86, v87
    v_exp_f32 v88, v88
    v_exp_f32 v89, v89
    v_mfma_f32_32x32x16_bf16 v[192:207], a[128:131], v[80:83], v[192:207]
    v_exp_f32 v90, v90
    v_exp_f32 v91, v91
    v_exp_f32 v92, v92
    v_exp_f32 v93, v93
    v_exp_f32 v94, v94
    v_exp_f32 v95, v95
    s_nop 0
    v_cvt_pk_bf16_f32 v84, v88, v89
    v_cvt_pk_bf16_f32 v85, v90, v91
    v_cvt_pk_bf16_f32 v86, v92, v93
    v_cvt_pk_bf16_f32 v87, v94, v95
    s_waitcnt vmcnt(2)
    v_mfma_f32_16x16x32_bf16 v[232:235], v[224:227], a[188:191], v[232:235]
    v_mfma_f32_16x16x32_bf16 v[236:239], v[228:231], a[188:191], v[236:239]
    v_exp_f32 v96, v96
    v_exp_f32 v97, v97
    v_exp_f32 v98, v98
    v_exp_f32 v99, v99
    v_mfma_f32_32x32x16_bf16 v[192:207], a[132:135], v[84:87], v[192:207]
    v_exp_f32 v100, v100
    v_exp_f32 v101, v101
    v_exp_f32 v102, v102
    v_exp_f32 v103, v103
    s_nop 0
    v_cvt_pk_bf16_f32 v96, v96, v97
    v_cvt_pk_bf16_f32 v97, v98, v99
    v_cvt_pk_bf16_f32 v98, v100, v101
    v_cvt_pk_bf16_f32 v99, v102, v103
    v_exp_f32 v104, v104
    v_exp_f32 v105, v105
    v_mfma_f32_32x32x16_bf16 v[192:207], a[136:139], v[96:99], v[192:207]
    v_exp_f32 v106, v106
    v_exp_f32 v107, v107
    v_exp_f32 v108, v108
    v_exp_f32 v109, v109
    v_exp_f32 v110, v110
    v_exp_f32 v111, v111
    s_nop 0
    v_cvt_pk_bf16_f32 v100, v104, v105
    v_cvt_pk_bf16_f32 v101, v106, v107
    v_cvt_pk_bf16_f32 v102, v108, v109
    v_cvt_pk_bf16_f32 v103, v110, v111
    s_nop 1
    v_mfma_f32_32x32x16_bf16 v[192:207], a[140:143], v[100:103], v[192:207]
    s_nop 15
    v_rcp_f32 v214, v202
    s_nop 0
    v_mul_f32 v192, v192, v214
    v_mul_f32 v193, v193, v214
    v_mul_f32 v194, v194, v214
    v_mul_f32 v195, v195, v214
    v_mul_f32 v196, v196, v214
    v_mul_f32 v197, v197, v214
    v_mul_f32 v198, v198, v214
    v_mul_f32 v199, v199, v214
    v_mul_f32 v200, v200, v214
    v_mul_f32 v201, v201, v214
    v_cvt_pk_bf16_f32 v192, v192, v193
    v_cvt_pk_bf16_f32 v193, v194, v195
    v_cvt_pk_bf16_f32 v194, v196, v197
    v_cvt_pk_bf16_f32 v195, v198, v199
    v_cvt_pk_bf16_f32 v196, v200, v201
    buffer_store_dwordx2 v[192:193], v16, s[8:11], s80 offen
    buffer_store_dwordx2 v[194:195], v16, s[8:11], s80 offen offset:16
    buffer_store_dword v196, v17, s[8:11], s80 offen offset:32
    v_cvt_pk_bf16_f32 v232, v232, v233
    v_and_b32 v233, 0xffff0000, v232
    v_lshlrev_b32 v232, 16, v232
    v_cvt_pk_bf16_f32 v234, v234, v235
    v_and_b32 v235, 0xffff0000, v234
    v_lshlrev_b32 v234, 16, v234
    v_cvt_pk_bf16_f32 v236, v236, v237
    v_and_b32 v237, 0xffff0000, v236
    v_lshlrev_b32 v236, 16, v236
    v_cvt_pk_bf16_f32 v238, v238, v239
    v_and_b32 v239, 0xffff0000, v238
    v_lshlrev_b32 v238, 16, v238
    v_mul_f32 v240, s39, v232
    v_mul_f32 v241, s39, v233
    v_mul_f32 v242, s39, v234
    v_mul_f32 v243, s39, v235
    v_mul_f32 v244, s39, v236
    v_mul_f32 v245, s39, v237
    v_mul_f32 v246, s39, v238
    v_mul_f32 v247, s39, v239
    v_exp_f32 v240, v240
    v_exp_f32 v241, v241
    v_exp_f32 v242, v242
    v_exp_f32 v243, v243
    v_exp_f32 v244, v244
    v_exp_f32 v245, v245
    v_exp_f32 v246, v246
    v_exp_f32 v247, v247
    v_add_f32 v240, 1.0, v240
    v_add_f32 v241, 1.0, v241
    v_add_f32 v242, 1.0, v242
    v_add_f32 v243, 1.0, v243
    v_add_f32 v244, 1.0, v244
    v_add_f32 v245, 1.0, v245
    v_add_f32 v246, 1.0, v246
    v_add_f32 v247, 1.0, v247
    v_rcp_f32 v240, v240
    v_rcp_f32 v241, v241
    v_rcp_f32 v242, v242
    v_rcp_f32 v243, v243
    v_rcp_f32 v244, v244
    v_rcp_f32 v245, v245
    v_rcp_f32 v246, v246
    v_rcp_f32 v247, v247
    v_mul_f32 v240, v232, v240
    v_mul_f32 v241, v233, v241
    v_mul_f32 v242, v234, v242
    v_mul_f32 v243, v235, v243
    v_mul_f32 v244, v236, v244
    v_mul_f32 v245, v237, v245
    v_mul_f32 v246, v238, v246
    v_mul_f32 v247, v239, v247
    v_cvt_pk_bf16_f32 v248, v240, v241
    v_cvt_pk_bf16_f32 v249, v242, v243
    v_cvt_pk_bf16_f32 v250, v244, v245
    v_cvt_pk_bf16_f32 v251, v246, v247
    buffer_store_dwordx4 v[248:251], v18, s[28:31], s36 offen
K1_END:
    s_endpgm
.section .rodata,"a"
.p2align 6
.amdhsa_kernel k1_kernel
  .amdhsa_next_free_vgpr 512
  .amdhsa_next_free_sgpr 102
  .amdhsa_accum_offset 256
  .amdhsa_group_segment_fixed_size 0
  .amdhsa_kernarg_size 80
  .amdhsa_user_sgpr_count 2
  .amdhsa_user_sgpr_kernarg_segment_ptr 1
  .amdhsa_system_sgpr_workgroup_id_x 1
  .amdhsa_float_denorm_mode_32 3
.end_amdhsa_kernel
.text

.globl k2_kernel
.p2align 8
.type k2_kernel,@function
k2_kernel:
    s_cmp_ge_u32 s2, 256
    s_cbranch_scc1 K2_END
    s_load_dwordx16 s[4:19], s[0:1], 0
    s_load_dwordx4 s[20:23], s[0:1], 64
    v_lshrrev_b32 v2, 6, v0
    v_and_b32 v1, 63, v0
    v_readfirstlane_b32 s43, v2
    v_mov_b32 v3, 0
    v_mov_b32 v15, 94208
    ds_write_b32 v15, v3
    s_and_b32 s40, s2, 7
    s_lshr_b32 s41, s2, 3
    s_lshl_b32 s40, s40, 2
    s_lshr_b32 s42, s41, 3
    s_add_u32 s40, s40, s42
    s_and_b32 s41, s41, 7
    s_cmp_ge_u32 s43, 5
    s_cselect_b32 s42, 1, 0
    s_cselect_b32 s44, 5, 0
    s_sub_u32 s44, s43, s44
    s_mul_i32 s45, s41, 9
    s_lshr_b32 s45, s45, 1
    s_add_u32 s45, s45, s44
    v_and_b32 v5, 15, v1
    v_lshrrev_b32 v6, 4, v1
    v_lshlrev_b32 v13, 4, v1
    s_and_b32 s46, s41, 1
    v_lshrrev_b32 v7, 5, v1
    s_lshl_b32 s47, s46, 2
    s_sub_u32 s47, 4, s47
    s_cmp_eq_u32 s47, s44
    s_cselect_b32 s48, 0x40000000, 0
    v_xor_b32 v7, s46, v7
    v_mul_lo_u32 v9, v7, s48
    v_add_u32 v14, v13, v9
    s_lshl_b32 s59, s44, 12
    s_add_u32 s59, s59, 73728
    v_add_u32 v8, s59, v13
    s_lshl_b32 s49, s40, 1
    s_add_u32 s49, s49, s42
    s_lshl_b32 s49, s49, 5
    v_add_u32 v12, s49, v5
    v_mul_u32_u24 v12, 1152, v12
    v_lshl_add_u32 v12, v6, 3, v12
    s_lshl_b32 s50, s45, 5
    v_add_u32 v12, s50, v12
    v_add_u32 v12, v12, v9
    s_mov_b32 s58, 18432
    s_mov_b32 s56, 0xbfb8aa3b
    s_waitcnt lgkmcnt(0)
    s_mov_b32 s36, s4
    s_mov_b32 s37, s5
    s_mov_b32 s38, 2359296
    s_mov_b32 s39, 0x00020000
    s_mov_b32 s60, s18
    s_mov_b32 s61, s19
    s_mov_b32 s62, 2359296
    s_mov_b32 s63, 0x00020000
    s_cmp_ge_u32 s43, 5
    s_cbranch_scc1 K2_RED
    s_mul_i32 s51, s45, 18432
    s_mul_i32 s52, s40, 73728
    s_lshl_b32 s53, s44, 10
    s_mov_b32 s57, 116509
    s_add_u32 s28, s22, 8388608
    s_addc_u32 s29, s23, 0
    s_mov_b32 s30, 2359296
    s_mov_b32 s31, 0x00020000
    s_add_u32 s24, s22, 15728640
    s_addc_u32 s25, s23, 0
    s_mov_b32 s26, 663552
    s_mov_b32 s27, 0x00020000
    v_add_u32 v18, s53, v13
    v_lshrrev_b32 v19, 4, v18
    v_mul_u32_u24 v19, s57, v19
    v_bfe_u32 v19, v19, 24, 3
    s_mov_b32 m0, s53
    v_lshlrev_b32 v19, 4, v19
    v_xor_b32 v18, v18, v19
    buffer_load_dwordx4 v18, s[28:31], s52 offen lds
    s_add_u32 s53, s53, 5120
    v_add_u32 v20, s53, v13
    v_lshrrev_b32 v21, 4, v20
    v_mul_u32_u24 v21, s57, v21
    v_bfe_u32 v21, v21, 24, 3
    s_mov_b32 m0, s53
    v_lshlrev_b32 v21, 4, v21
    v_xor_b32 v20, v20, v21
    buffer_load_dwordx4 v20, s[28:31], s52 offen lds
    s_add_u32 s53, s53, 5120
    v_add_u32 v18, s53, v13
    v_lshrrev_b32 v19, 4, v18
    v_mul_u32_u24 v19, s57, v19
    v_bfe_u32 v19, v19, 24, 3
    s_mov_b32 m0, s53
    v_lshlrev_b32 v19, 4, v19
    v_xor_b32 v18, v18, v19
    buffer_load_dwordx4 v18, s[28:31], s52 offen lds
    s_add_u32 s53, s53, 5120
    v_add_u32 v20, s53, v13
    v_lshrrev_b32 v21, 4, v20
    v_mul_u32_u24 v21, s57, v21
    v_bfe_u32 v21, v21, 24, 3
    s_mov_b32 m0, s53
    v_lshlrev_b32 v21, 4, v21
    v_xor_b32 v20, v20, v21
    buffer_load_dwordx4 v20, s[28:31], s52 offen lds
    s_add_u32 s53, s53, 5120
    v_add_u32 v18, s53, v13
    v_lshrrev_b32 v19, 4, v18
    v_mul_u32_u24 v19, s57, v19
    v_bfe_u32 v19, v19, 24, 3
    s_mov_b32 m0, s53
    v_lshlrev_b32 v19, 4, v19
    v_xor_b32 v18, v18, v19
    buffer_load_dwordx4 v18, s[28:31], s52 offen lds
    s_add_u32 s53, s53, 5120
    v_add_u32 v20, s53, v13
    v_lshrrev_b32 v21, 4, v20
    v_mul_u32_u24 v21, s57, v21
    v_bfe_u32 v21, v21, 24, 3
    s_mov_b32 m0, s53
    v_lshlrev_b32 v21, 4, v21
    v_xor_b32 v20, v20, v21
    buffer_load_dwordx4 v20, s[28:31], s52 offen lds
    s_add_u32 s53, s53, 5120
    v_add_u32 v18, s53, v13
    v_lshrrev_b32 v19, 4, v18
    v_mul_u32_u24 v19, s57, v19
    v_bfe_u32 v19, v19, 24, 3
    s_mov_b32 m0, s53
    v_lshlrev_b32 v19, 4, v19
    v_xor_b32 v18, v18, v19
    buffer_load_dwordx4 v18, s[28:31], s52 offen lds
    s_add_u32 s53, s53, 5120
    v_add_u32 v20, s53, v13
    v_lshrrev_b32 v21, 4, v20
    v_mul_u32_u24 v21, s57, v21
    v_bfe_u32 v21, v21, 24, 3
    s_mov_b32 m0, s53
    v_lshlrev_b32 v21, 4, v21
    v_xor_b32 v20, v20, v21
    buffer_load_dwordx4 v20, s[28:31], s52 offen lds
    s_add_u32 s53, s53, 5120
    v_add_u32 v18, s53, v13
    v_lshrrev_b32 v19, 4, v18
    v_mul_u32_u24 v19, s57, v19
    v_bfe_u32 v19, v19, 24, 3
    s_mov_b32 m0, s53
    v_lshlrev_b32 v19, 4, v19
    v_xor_b32 v18, v18, v19
    buffer_load_dwordx4 v18, s[28:31], s52 offen lds
    s_add_u32 s53, s53, 5120
    v_add_u32 v20, s53, v13
    v_lshrrev_b32 v21, 4, v20
    v_mul_u32_u24 v21, s57, v21
    v_bfe_u32 v21, v21, 24, 3
    s_mov_b32 m0, s53
    v_lshlrev_b32 v21, 4, v21
    v_xor_b32 v20, v20, v21
    buffer_load_dwordx4 v20, s[28:31], s52 offen lds
    s_add_u32 s53, s53, 5120
    v_add_u32 v18, s53, v13
    v_lshrrev_b32 v19, 4, v18
    v_mul_u32_u24 v19, s57, v19
    v_bfe_u32 v19, v19, 24, 3
    s_mov_b32 m0, s53
    v_lshlrev_b32 v19, 4, v19
    v_xor_b32 v18, v18, v19
    buffer_load_dwordx4 v18, s[28:31], s52 offen lds
    s_add_u32 s53, s53, 5120
    v_add_u32 v20, s53, v13
    v_lshrrev_b32 v21, 4, v20
    v_mul_u32_u24 v21, s57, v21
    v_bfe_u32 v21, v21, 24, 3
    s_mov_b32 m0, s53
    v_lshlrev_b32 v21, 4, v21
    v_xor_b32 v20, v20, v21
    buffer_load_dwordx4 v20, s[28:31], s52 offen lds
    s_add_u32 s53, s53, 5120
    v_add_u32 v18, s53, v13
    v_lshrrev_b32 v19, 4, v18
    v_mul_u32_u24 v19, s57, v19
    v_bfe_u32 v19, v19, 24, 3
    s_mov_b32 m0, s53
    v_lshlrev_b32 v19, 4, v19
    v_xor_b32 v18, v18, v19
    buffer_load_dwordx4 v18, s[28:31], s52 offen lds
    s_add_u32 s53, s53, 5120
    v_add_u32 v20, s53, v13
    v_lshrrev_b32 v21, 4, v20
    v_mul_u32_u24 v21, s57, v21
    v_bfe_u32 v21, v21, 24, 3
    s_mov_b32 m0, s53
    v_lshlrev_b32 v21, 4, v21
    v_xor_b32 v20, v20, v21
    buffer_load_dwordx4 v20, s[28:31], s52 offen lds
    s_add_u32 s53, s53, 5120
    s_cmp_ge_u32 s53, 73728
    s_cbranch_scc1 K2_ODONE
    v_add_u32 v18, s53, v13
    v_lshrrev_b32 v19, 4, v18
    v_mul_u32_u24 v19, s57, v19
    v_bfe_u32 v19, v19, 24, 3
    s_mov_b32 m0, s53
    v_lshlrev_b32 v19, 4, v19
    v_xor_b32 v18, v18, v19
    buffer_load_dwordx4 v18, s[28:31], s52 offen lds
    s_add_u32 s53, s53, 5120
K2_ODONE:
    s_barrier
    buffer_load_dwordx4 v[24:27], v13, s[24:27], s51 offen offset:0
    buffer_load_dwordx4 v[28:31], v13, s[24:27], s51 offen offset:1024
    buffer_load_dwordx4 v[32:35], v13, s[24:27], s51 offen offset:2048
    buffer_load_dwordx4 v[36:39], v13, s[24:27], s51 offen offset:3072
    s_add_u32 s51, s51, 4096
    buffer_load_dwordx4 v[40:43], v13, s[24:27], s51 offen offset:0
    buffer_load_dwordx4 v[44:47], v13, s[24:27], s51 offen offset:1024
    buffer_load_dwordx4 v[48:51], v13, s[24:27], s51 offen offset:2048
    buffer_load_dwordx4 v[52:55], v13, s[24:27], s51 offen offset:3072
    s_add_u32 s51, s51, 4096
    buffer_load_dwordx4 v[56:59], v13, s[24:27], s51 offen offset:0
    buffer_load_dwordx4 v[60:63], v13, s[24:27], s51 offen offset:1024
    buffer_load_dwordx4 v[64:67], v13, s[24:27], s51 offen offset:2048
    buffer_load_dwordx4 v[68:71], v13, s[24:27], s51 offen offset:3072
    s_add_u32 s51, s51, 4096
    buffer_load_dwordx4 v[72:75], v13, s[24:27], s51 offen offset:0
    buffer_load_dwordx4 v[76:79], v13, s[24:27], s51 offen offset:1024
    buffer_load_dwordx4 v[80:83], v13, s[24:27], s51 offen offset:2048
    buffer_load_dwordx4 v[84:87], v13, s[24:27], s51 offen offset:3072
    s_add_u32 s51, s51, 4096
    buffer_load_dwordx4 v[88:91], v13, s[24:27], s51 offen offset:0
    buffer_load_dwordx4 v[92:95], v13, s[24:27], s51 offen offset:1024
    buffer_load_dwordx2 v[160:161], v12, s[36:39], 0 offen
    buffer_load_dwordx2 v[162:163], v12, s[36:39], s58 offen
    v_bfe_u32 v2, v5, 1, 3
    v_xor_b32 v2, v2, v6
    v_mul_u32_u24 v7, 1152, v5
    v_lshl_add_u32 v16, v2, 4, v7
    v_xor_b32 v2, 4, v2
    v_lshl_add_u32 v17, v2, 4, v7
    v_mov_b32 v3, 1
    s_waitcnt vmcnt(20)
    s_mov_b64 exec, 1
    ds_add_u32 v15, v3
    s_mov_b64 exec, -1
K2_SPIN:
    ds_read_b32 v3, v15
    s_waitcnt lgkmcnt(0)
    v_readfirstlane_b32 s55, v3
    s_cmp_lt_u32 s55, 5
    s_cbranch_scc1 K2_SPIN
    ds_read_b128 v[96:99], v16 offset:0
    ds_read_b128 v[100:103], v16 offset:18432
    ds_read_b128 v[104:107], v16 offset:36864
    ds_read_b128 v[108:111], v16 offset:55296
    s_waitcnt lgkmcnt(0)
    ds_read_b128 v[112:115], v17 offset:0
    ds_read_b128 v[116:119], v17 offset:18432
    ds_read_b128 v[120:123], v17 offset:36864
    ds_read_b128 v[124:127], v17 offset:55296
    s_waitcnt vmcnt(19)
    v_mfma_f32_16x16x32_bf16 v[136:139], v[24:27], v[96:99], 0
    v_mfma_f32_16x16x32_bf16 v[140:143], v[24:27], v[100:103], 0
    v_mfma_f32_16x16x32_bf16 v[144:147], v[24:27], v[104:107], 0
    v_mfma_f32_16x16x32_bf16 v[148:151], v[24:27], v[108:111], 0
    s_waitcnt lgkmcnt(0)
    ds_read_b128 v[96:99], v16 offset:128
    ds_read_b128 v[100:103], v16 offset:18560
    ds_read_b128 v[104:107], v16 offset:36992
    ds_read_b128 v[108:111], v16 offset:55424
    s_waitcnt vmcnt(18)
    v_mfma_f32_16x16x32_bf16 v[136:139], v[28:31], v[112:115], v[136:139]
    v_mfma_f32_16x16x32_bf16 v[140:143], v[28:31], v[116:119], v[140:143]
    v_mfma_f32_16x16x32_bf16 v[144:147], v[28:31], v[120:123], v[144:147]
    v_mfma_f32_16x16x32_bf16 v[148:151], v[28:31], v[124:127], v[148:151]
    s_waitcnt lgkmcnt(0)
    ds_read_b128 v[112:115], v17 offset:128
    ds_read_b128 v[116:119], v17 offset:18560
    ds_read_b128 v[120:123], v17 offset:36992
    ds_read_b128 v[124:127], v17 offset:55424
    s_waitcnt vmcnt(17)
    v_mfma_f32_16x16x32_bf16 v[136:139], v[32:35], v[96:99], v[136:139]
    v_mfma_f32_16x16x32_bf16 v[140:143], v[32:35], v[100:103], v[140:143]
    v_mfma_f32_16x16x32_bf16 v[144:147], v[32:35], v[104:107], v[144:147]
    v_mfma_f32_16x16x32_bf16 v[148:151], v[32:35], v[108:111], v[148:151]
    s_waitcnt lgkmcnt(0)
    ds_read_b128 v[96:99], v16 offset:256
    ds_read_b128 v[100:103], v16 offset:18688
    ds_read_b128 v[104:107], v16 offset:37120
    ds_read_b128 v[108:111], v16 offset:55552
    s_waitcnt vmcnt(16)
    v_mfma_f32_16x16x32_bf16 v[136:139], v[36:39], v[112:115], v[136:139]
    v_mfma_f32_16x16x32_bf16 v[140:143], v[36:39], v[116:119], v[140:143]
    v_mfma_f32_16x16x32_bf16 v[144:147], v[36:39], v[120:123], v[144:147]
    v_mfma_f32_16x16x32_bf16 v[148:151], v[36:39], v[124:127], v[148:151]
    s_waitcnt lgkmcnt(0)
    ds_read_b128 v[112:115], v17 offset:256
    ds_read_b128 v[116:119], v17 offset:18688
    ds_read_b128 v[120:123], v17 offset:37120
    ds_read_b128 v[124:127], v17 offset:55552
    s_waitcnt vmcnt(15)
    v_mfma_f32_16x16x32_bf16 v[136:139], v[40:43], v[96:99], v[136:139]
    v_mfma_f32_16x16x32_bf16 v[140:143], v[40:43], v[100:103], v[140:143]
    v_mfma_f32_16x16x32_bf16 v[144:147], v[40:43], v[104:107], v[144:147]
    v_mfma_f32_16x16x32_bf16 v[148:151], v[40:43], v[108:111], v[148:151]
    s_waitcnt lgkmcnt(0)
    ds_read_b128 v[96:99], v16 offset:384
    ds_read_b128 v[100:103], v16 offset:18816
    ds_read_b128 v[104:107], v16 offset:37248
    ds_read_b128 v[108:111], v16 offset:55680
    s_waitcnt vmcnt(14)
    v_mfma_f32_16x16x32_bf16 v[136:139], v[44:47], v[112:115], v[136:139]
    v_mfma_f32_16x16x32_bf16 v[140:143], v[44:47], v[116:119], v[140:143]
    v_mfma_f32_16x16x32_bf16 v[144:147], v[44:47], v[120:123], v[144:147]
    v_mfma_f32_16x16x32_bf16 v[148:151], v[44:47], v[124:127], v[148:151]
    s_waitcnt lgkmcnt(0)
    ds_read_b128 v[112:115], v17 offset:384
    ds_read_b128 v[116:119], v17 offset:18816
    ds_read_b128 v[120:123], v17 offset:37248
    ds_read_b128 v[124:127], v17 offset:55680
    s_waitcnt vmcnt(13)
    v_mfma_f32_16x16x32_bf16 v[136:139], v[48:51], v[96:99], v[136:139]
    v_mfma_f32_16x16x32_bf16 v[140:143], v[48:51], v[100:103], v[140:143]
    v_mfma_f32_16x16x32_bf16 v[144:147], v[48:51], v[104:107], v[144:147]
    v_mfma_f32_16x16x32_bf16 v[148:151], v[48:51], v[108:111], v[148:151]
    s_waitcnt lgkmcnt(0)
    ds_read_b128 v[96:99], v16 offset:512
    ds_read_b128 v[100:103], v16 offset:18944
    ds_read_b128 v[104:107], v16 offset:37376
    ds_read_b128 v[108:111], v16 offset:55808
    s_waitcnt vmcnt(12)
    v_mfma_f32_16x16x32_bf16 v[136:139], v[52:55], v[112:115], v[136:139]
    v_mfma_f32_16x16x32_bf16 v[140:143], v[52:55], v[116:119], v[140:143]
    v_mfma_f32_16x16x32_bf16 v[144:147], v[52:55], v[120:123], v[144:147]
    v_mfma_f32_16x16x32_bf16 v[148:151], v[52:55], v[124:127], v[148:151]
    s_waitcnt lgkmcnt(0)
    ds_read_b128 v[112:115], v17 offset:512
    ds_read_b128 v[116:119], v17 offset:18944
    ds_read_b128 v[120:123], v17 offset:37376
    ds_read_b128 v[124:127], v17 offset:55808
    s_waitcnt vmcnt(11)
    v_mfma_f32_16x16x32_bf16 v[136:139], v[56:59], v[96:99], v[136:139]
    v_mfma_f32_16x16x32_bf16 v[140:143], v[56:59], v[100:103], v[140:143]
    v_mfma_f32_16x16x32_bf16 v[144:147], v[56:59], v[104:107], v[144:147]
    v_mfma_f32_16x16x32_bf16 v[148:151], v[56:59], v[108:111], v[148:151]
    s_waitcnt lgkmcnt(0)
    ds_read_b128 v[96:99], v16 offset:640
    ds_read_b128 v[100:103], v16 offset:19072
    ds_read_b128 v[104:107], v16 offset:37504
    ds_read_b128 v[108:111], v16 offset:55936
    s_waitcnt vmcnt(10)
    v_mfma_f32_16x16x32_bf16 v[136:139], v[60:63], v[112:115], v[136:139]
    v_mfma_f32_16x16x32_bf16 v[140:143], v[60:63], v[116:119], v[140:143]
    v_mfma_f32_16x16x32_bf16 v[144:147], v[60:63], v[120:123], v[144:147]
    v_mfma_f32_16x16x32_bf16 v[148:151], v[60:63], v[124:127], v[148:151]
    s_waitcnt lgkmcnt(0)
    ds_read_b128 v[112:115], v17 offset:640
    ds_read_b128 v[116:119], v17 offset:19072
    ds_read_b128 v[120:123], v17 offset:37504
    ds_read_b128 v[124:127], v17 offset:55936
    s_waitcnt vmcnt(9)
    v_mfma_f32_16x16x32_bf16 v[136:139], v[64:67], v[96:99], v[136:139]
    v_mfma_f32_16x16x32_bf16 v[140:143], v[64:67], v[100:103], v[140:143]
    v_mfma_f32_16x16x32_bf16 v[144:147], v[64:67], v[104:107], v[144:147]
    v_mfma_f32_16x16x32_bf16 v[148:151], v[64:67], v[108:111], v[148:151]
    s_waitcnt lgkmcnt(0)
    ds_read_b128 v[96:99], v16 offset:768
    ds_read_b128 v[100:103], v16 offset:19200
    ds_read_b128 v[104:107], v16 offset:37632
    ds_read_b128 v[108:111], v16 offset:56064
    s_waitcnt vmcnt(8)
    v_mfma_f32_16x16x32_bf16 v[136:139], v[68:71], v[112:115], v[136:139]
    v_mfma_f32_16x16x32_bf16 v[140:143], v[68:71], v[116:119], v[140:143]
    v_mfma_f32_16x16x32_bf16 v[144:147], v[68:71], v[120:123], v[144:147]
    v_mfma_f32_16x16x32_bf16 v[148:151], v[68:71], v[124:127], v[148:151]
    s_waitcnt lgkmcnt(0)
    ds_read_b128 v[112:115], v17 offset:768
    ds_read_b128 v[116:119], v17 offset:19200
    ds_read_b128 v[120:123], v17 offset:37632
    ds_read_b128 v[124:127], v17 offset:56064
    s_waitcnt vmcnt(7)
    v_mfma_f32_16x16x32_bf16 v[136:139], v[72:75], v[96:99], v[136:139]
    v_mfma_f32_16x16x32_bf16 v[140:143], v[72:75], v[100:103], v[140:143]
    v_mfma_f32_16x16x32_bf16 v[144:147], v[72:75], v[104:107], v[144:147]
    v_mfma_f32_16x16x32_bf16 v[148:151], v[72:75], v[108:111], v[148:151]
    s_waitcnt lgkmcnt(0)
    ds_read_b128 v[96:99], v16 offset:896
    ds_read_b128 v[100:103], v16 offset:19328
    ds_read_b128 v[104:107], v16 offset:37760
    ds_read_b128 v[108:111], v16 offset:56192
    s_waitcnt vmcnt(6)
    v_mfma_f32_16x16x32_bf16 v[136:139], v[76:79], v[112:115], v[136:139]
    v_mfma_f32_16x16x32_bf16 v[140:143], v[76:79], v[116:119], v[140:143]
    v_mfma_f32_16x16x32_bf16 v[144:147], v[76:79], v[120:123], v[144:147]
    v_mfma_f32_16x16x32_bf16 v[148:151], v[76:79], v[124:127], v[148:151]
    s_waitcnt lgkmcnt(0)
    ds_read_b128 v[112:115], v17 offset:896
    ds_read_b128 v[116:119], v17 offset:19328
    ds_read_b128 v[120:123], v17 offset:37760
    ds_read_b128 v[124:127], v17 offset:56192
    s_waitcnt vmcnt(5)
    v_mfma_f32_16x16x32_bf16 v[136:139], v[80:83], v[96:99], v[136:139]
    v_mfma_f32_16x16x32_bf16 v[140:143], v[80:83], v[100:103], v[140:143]
    v_mfma_f32_16x16x32_bf16 v[144:147], v[80:83], v[104:107], v[144:147]
    v_mfma_f32_16x16x32_bf16 v[148:151], v[80:83], v[108:111], v[148:151]
    s_waitcnt lgkmcnt(0)
    ds_read_b128 v[96:99], v16 offset:1024
    ds_read_b128 v[100:103], v16 offset:19456
    ds_read_b128 v[104:107], v16 offset:37888
    ds_read_b128 v[108:111], v16 offset:56320
    s_waitcnt vmcnt(4)
    v_mfma_f32_16x16x32_bf16 v[136:139], v[84:87], v[112:115], v[136:139]
    v_mfma_f32_16x16x32_bf16 v[140:143], v[84:87], v[116:119], v[140:143]
    v_mfma_f32_16x16x32_bf16 v[144:147], v[84:87], v[120:123], v[144:147]
    v_mfma_f32_16x16x32_bf16 v[148:151], v[84:87], v[124:127], v[148:151]
    s_waitcnt lgkmcnt(0)
    ds_read_b128 v[112:115], v17 offset:1024
    ds_read_b128 v[116:119], v17 offset:19456
    ds_read_b128 v[120:123], v17 offset:37888
    ds_read_b128 v[124:127], v17 offset:56320
    s_waitcnt vmcnt(3)
    v_mfma_f32_16x16x32_bf16 v[136:139], v[88:91], v[96:99], v[136:139]
    v_mfma_f32_16x16x32_bf16 v[140:143], v[88:91], v[100:103], v[140:143]
    v_mfma_f32_16x16x32_bf16 v[144:147], v[88:91], v[104:107], v[144:147]
    v_mfma_f32_16x16x32_bf16 v[148:151], v[88:91], v[108:111], v[148:151]
    s_waitcnt vmcnt(2) lgkmcnt(0)
    v_mfma_f32_16x16x32_bf16 v[136:139], v[92:95], v[112:115], v[136:139]
    v_mfma_f32_16x16x32_bf16 v[140:143], v[92:95], v[116:119], v[140:143]
    v_mfma_f32_16x16x32_bf16 v[144:147], v[92:95], v[120:123], v[144:147]
    v_mfma_f32_16x16x32_bf16 v[148:151], v[92:95], v[124:127], v[148:151]
    s_nop 7
    ds_write_b128 v8, v[144:147]
    ds_write_b128 v8, v[148:151] offset:1024
    s_waitcnt lgkmcnt(0)
    s_barrier
    ds_read_b128 v[152:155], v8 offset:2048
    ds_read_b128 v[156:159], v8 offset:3072
    s_waitcnt vmcnt(0) lgkmcnt(0)
    s_branch K2_FIN
K2_RED:
    s_mul_i32 s54, s40, 72
    s_add_u32 s54, s54, s45
    s_lshl_b32 s54, s54, 14
    s_add_u32 s32, s22, 16777216
    s_addc_u32 s33, s23, 0
    s_mov_b32 s34, 37748736
    s_mov_b32 s35, 0x00020000
    v_lshrrev_b32 v2, 2, v5
    v_cmp_eq_u32 vcc, v2, v6
    v_and_b32 v3, 1, v5
    v_lshlrev_b32 v3, 4, v3
    v_mov_b32 v4, 0x3f80
    v_lshlrev_b32 v4, v3, v4
    v_cndmask_b32 v4, 0, v4, vcc
    v_bfe_u32 v3, v5, 1, 1
    v_cmp_eq_u32 vcc, 0, v3
    v_mov_b32 v18, 0
    v_mov_b32 v19, 0
    v_cndmask_b32 v16, 0, v4, vcc
    v_cndmask_b32 v17, v4, 0, vcc
    v_mov_b32 v20, 0
    v_mov_b32 v21, 0
    v_mov_b32 v22, v16
    v_mov_b32 v23, v17
    s_and_b32 s55, s45, 0x24
    s_cmp_lg_u32 s55, 0
    s_cbranch_scc1 K2_HEAVY
    s_add_u32 s32, s22, 62914560
    s_addc_u32 s33, s23, 0
    s_mov_b32 s34, 2359296
    s_mov_b32 s35, 0x00020000
    s_lshr_b32 s54, s54, 4
    s_add_u32 s55, s54, 36864
    buffer_load_dwordx4 v[24:27], v14, s[32:35], s54 offen
    buffer_load_dwordx4 v[28:31], v14, s[32:35], s55 offen
    buffer_load_dwordx2 v[160:161], v12, s[36:39], 0 offen
    buffer_load_dwordx2 v[162:163], v12, s[36:39], s58 offen
    s_barrier
    s_waitcnt vmcnt(0)
    v_lshlrev_b32 v144, 16, v24
    v_and_b32 v145, 0xffff0000, v24
    v_lshlrev_b32 v146, 16, v25
    v_and_b32 v147, 0xffff0000, v25
    v_lshlrev_b32 v148, 16, v26
    v_and_b32 v149, 0xffff0000, v26
    v_lshlrev_b32 v150, 16, v27
    v_and_b32 v151, 0xffff0000, v27
    v_lshlrev_b32 v152, 16, v28
    v_and_b32 v153, 0xffff0000, v28
    v_lshlrev_b32 v154, 16, v29
    v_and_b32 v155, 0xffff0000, v29
    v_lshlrev_b32 v156, 16, v30
    v_and_b32 v157, 0xffff0000, v30
    v_lshlrev_b32 v158, 16, v31
    v_and_b32 v159, 0xffff0000, v31
    ds_write_b128 v8, v[144:147] offset:2048
    ds_write_b128 v8, v[148:151] offset:3072
    s_waitcnt lgkmcnt(0)
    s_barrier
    ds_read_b128 v[136:139], v8
    ds_read_b128 v[140:143], v8 offset:1024
    s_waitcnt lgkmcnt(0)
    s_branch K2_FIN
K2_HEAVY:
    buffer_load_dwordx4 v[24:27], v14, s[32:35], s54 offen offset:0
    buffer_load_dwordx4 v[28:31], v14, s[32:35], s54 offen offset:1024
    s_barrier
    buffer_load_dwordx4 v[32:35], v14, s[32:35], s54 offen offset:2048
    buffer_load_dwordx4 v[36:39], v14, s[32:35], s54 offen offset:3072
    s_add_u32 s54, s54, 4096
    buffer_load_dwordx4 v[40:43], v14, s[32:35], s54 offen offset:0
    buffer_load_dwordx4 v[44:47], v14, s[32:35], s54 offen offset:1024
    buffer_load_dwordx4 v[48:51], v14, s[32:35], s54 offen offset:2048
    buffer_load_dwordx4 v[52:55], v14, s[32:35], s54 offen offset:3072
    s_add_u32 s54, s54, 4096
    s_waitcnt vmcnt(7)
    v_mfma_f32_16x16x32_bf16 v[144:147], v[16:19], v[24:27], 0
    v_mfma_f32_16x16x32_bf16 v[148:151], v[20:23], v[24:27], 0
    buffer_load_dwordx4 v[24:27], v14, s[32:35], s54 offen offset:0
    s_waitcnt vmcnt(7)
    v_mfma_f32_16x16x32_bf16 v[144:147], v[16:19], v[28:31], v[144:147]
    v_mfma_f32_16x16x32_bf16 v[148:151], v[20:23], v[28:31], v[148:151]
    buffer_load_dwordx4 v[28:31], v14, s[32:35], s54 offen offset:1024
    s_waitcnt vmcnt(7)
    v_mfma_f32_16x16x32_bf16 v[144:147], v[16:19], v[32:35], v[144:147]
    v_mfma_f32_16x16x32_bf16 v[148:151], v[20:23], v[32:35], v[148:151]
    buffer_load_dwordx4 v[32:35], v14, s[32:35], s54 offen offset:2048
    s_waitcnt vmcnt(7)
    v_mfma_f32_16x16x32_bf16 v[144:147], v[16:19], v[36:39], v[144:147]
    v_mfma_f32_16x16x32_bf16 v[148:151], v[20:23], v[36:39], v[148:151]
    buffer_load_dwordx4 v[36:39], v14, s[32:35], s54 offen offset:3072
    s_add_u32 s54, s54, 4096
    s_waitcnt vmcnt(7)
    v_mfma_f32_16x16x32_bf16 v[144:147], v[16:19], v[40:43], v[144:147]
    v_mfma_f32_16x16x32_bf16 v[148:151], v[20:23], v[40:43], v[148:151]
    buffer_load_dwordx4 v[40:43], v14, s[32:35], s54 offen offset:0
    s_waitcnt vmcnt(7)
    v_mfma_f32_16x16x32_bf16 v[144:147], v[16:19], v[44:47], v[144:147]
    v_mfma_f32_16x16x32_bf16 v[148:151], v[20:23], v[44:47], v[148:151]
    buffer_load_dwordx4 v[44:47], v14, s[32:35], s54 offen offset:1024
    s_waitcnt vmcnt(7)
    v_mfma_f32_16x16x32_bf16 v[144:147], v[16:19], v[48:51], v[144:147]
    v_mfma_f32_16x16x32_bf16 v[148:151], v[20:23], v[48:51], v[148:151]
    buffer_load_dwordx4 v[48:51], v14, s[32:35], s54 offen offset:2048
    s_waitcnt vmcnt(7)
    v_mfma_f32_16x16x32_bf16 v[144:147], v[16:19], v[52:55], v[144:147]
    v_mfma_f32_16x16x32_bf16 v[148:151], v[20:23], v[52:55], v[148:151]
    buffer_load_dwordx4 v[52:55], v14, s[32:35], s54 offen offset:3072
    s_add_u32 s54, s54, 577536
    s_waitcnt vmcnt(7)
    v_mfma_f32_16x16x32_bf16 v[144:147], v[16:19], v[24:27], v[144:147]
    v_mfma_f32_16x16x32_bf16 v[148:151], v[20:23], v[24:27], v[148:151]
    buffer_load_dwordx4 v[24:27], v14, s[32:35], s54 offen offset:0
    buffer_load_dwordx2 v[160:161], v12, s[36:39], 0 offen
    buffer_load_dwordx2 v[162:163], v12, s[36:39], s58 offen
    s_waitcnt vmcnt(9)
    v_mfma_f32_16x16x32_bf16 v[144:147], v[16:19], v[28:31], v[144:147]
    v_mfma_f32_16x16x32_bf16 v[148:151], v[20:23], v[28:31], v[148:151]
    buffer_load_dwordx4 v[28:31], v14, s[32:35], s54 offen offset:1024
    s_waitcnt vmcnt(9)
    v_mfma_f32_16x16x32_bf16 v[144:147], v[16:19], v[32:35], v[144:147]
    v_mfma_f32_16x16x32_bf16 v[148:151], v[20:23], v[32:35], v[148:151]
    buffer_load_dwordx4 v[32:35], v14, s[32:35], s54 offen offset:2048
    s_waitcnt vmcnt(9)
    v_mfma_f32_16x16x32_bf16 v[144:147], v[16:19], v[36:39], v[144:147]
    v_mfma_f32_16x16x32_bf16 v[148:151], v[20:23], v[36:39], v[148:151]
    buffer_load_dwordx4 v[36:39], v14, s[32:35], s54 offen offset:3072
    s_add_u32 s54, s54, 4096
    s_waitcnt vmcnt(9)
    v_mfma_f32_16x16x32_bf16 v[144:147], v[16:19], v[40:43], v[144:147]
    v_mfma_f32_16x16x32_bf16 v[148:151], v[20:23], v[40:43], v[148:151]
    buffer_load_dwordx4 v[40:43], v14, s[32:35], s54 offen offset:0
    s_waitcnt vmcnt(9)
    v_mfma_f32_16x16x32_bf16 v[144:147], v[16:19], v[44:47], v[144:147]
    v_mfma_f32_16x16x32_bf16 v[148:151], v[20:23], v[44:47], v[148:151]
    buffer_load_dwordx4 v[44:47], v14, s[32:35], s54 offen offset:1024
    s_waitcnt vmcnt(9)
    v_mfma_f32_16x16x32_bf16 v[144:147], v[16:19], v[48:51], v[144:147]
    v_mfma_f32_16x16x32_bf16 v[148:151], v[20:23], v[48:51], v[148:151]
    buffer_load_dwordx4 v[48:51], v14, s[32:35], s54 offen offset:2048
    s_waitcnt vmcnt(9)
    v_mfma_f32_16x16x32_bf16 v[144:147], v[16:19], v[52:55], v[144:147]
    v_mfma_f32_16x16x32_bf16 v[148:151], v[20:23], v[52:55], v[148:151]
    buffer_load_dwordx4 v[52:55], v14, s[32:35], s54 offen offset:3072
    s_add_u32 s54, s54, 4096
    s_waitcnt vmcnt(9)
    v_mfma_f32_16x16x32_bf16 v[152:155], v[16:19], v[24:27], 0
    v_mfma_f32_16x16x32_bf16 v[156:159], v[20:23], v[24:27], 0
    buffer_load_dwordx4 v[24:27], v14, s[32:35], s54 offen offset:0
    s_waitcnt vmcnt(7)
    v_mfma_f32_16x16x32_bf16 v[152:155], v[16:19], v[28:31], v[152:155]
    v_mfma_f32_16x16x32_bf16 v[156:159], v[20:23], v[28:31], v[156:159]
    buffer_load_dwordx4 v[28:31], v14, s[32:35], s54 offen offset:1024
    s_waitcnt vmcnt(7)
    v_mfma_f32_16x16x32_bf16 v[152:155], v[16:19], v[32:35], v[152:155]
    v_mfma_f32_16x16x32_bf16 v[156:159], v[20:23], v[32:35], v[156:159]
    buffer_load_dwordx4 v[32:35], v14, s[32:35], s54 offen offset:2048
    s_waitcnt vmcnt(7)
    v_mfma_f32_16x16x32_bf16 v[152:155], v[16:19], v[36:39], v[152:155]
    v_mfma_f32_16x16x32_bf16 v[156:159], v[20:23], v[36:39], v[156:159]
    buffer_load_dwordx4 v[36:39], v14, s[32:35], s54 offen offset:3072
    s_add_u32 s54, s54, 4096
    v_cvt_pk_bf16_f32 v144, v144, v145
    v_and_b32 v145, 0xffff0000, v144
    v_lshlrev_b32 v144, 16, v144
    v_cvt_pk_bf16_f32 v146, v146, v147
    v_and_b32 v147, 0xffff0000, v146
    v_lshlrev_b32 v146, 16, v146
    v_cvt_pk_bf16_f32 v148, v148, v149
    v_and_b32 v149, 0xffff0000, v148
    v_lshlrev_b32 v148, 16, v148
    v_cvt_pk_bf16_f32 v150, v150, v151
    v_and_b32 v151, 0xffff0000, v150
    v_lshlrev_b32 v150, 16, v150
    v_mul_f32 v120, s56, v144
    v_mul_f32 v121, s56, v145
    v_mul_f32 v122, s56, v146
    v_mul_f32 v123, s56, v147
    v_mul_f32 v124, s56, v148
    v_mul_f32 v125, s56, v149
    v_mul_f32 v126, s56, v150
    v_mul_f32 v127, s56, v151
    v_exp_f32 v120, v120
    v_exp_f32 v121, v121
    v_exp_f32 v122, v122
    v_exp_f32 v123, v123
    v_exp_f32 v124, v124
    v_exp_f32 v125, v125
    v_exp_f32 v126, v126
    v_exp_f32 v127, v127
    v_add_f32 v120, 1.0, v120
    v_add_f32 v121, 1.0, v121
    v_add_f32 v122, 1.0, v122
    v_add_f32 v123, 1.0, v123
    v_add_f32 v124, 1.0, v124
    v_add_f32 v125, 1.0, v125
    v_add_f32 v126, 1.0, v126
    v_add_f32 v127, 1.0, v127
    v_rcp_f32 v120, v120
    v_rcp_f32 v121, v121
    v_rcp_f32 v122, v122
    v_rcp_f32 v123, v123
    v_rcp_f32 v124, v124
    v_rcp_f32 v125, v125
    v_rcp_f32 v126, v126
    v_rcp_f32 v127, v127
    s_nop 0
    v_mul_f32 v144, v144, v120
    v_mul_f32 v145, v145, v121
    v_mul_f32 v146, v146, v122
    v_mul_f32 v147, v147, v123
    v_mul_f32 v148, v148, v124
    v_mul_f32 v149, v149, v125
    v_mul_f32 v150, v150, v126
    v_mul_f32 v151, v151, v127
    v_cvt_pk_bf16_f32 v144, v144, v145
    v_and_b32 v145, 0xffff0000, v144
    v_lshlrev_b32 v144, 16, v144
    v_cvt_pk_bf16_f32 v146, v146, v147
    v_and_b32 v147, 0xffff0000, v146
    v_lshlrev_b32 v146, 16, v146
    v_cvt_pk_bf16_f32 v148, v148, v149
    v_and_b32 v149, 0xffff0000, v148
    v_lshlrev_b32 v148, 16, v148
    v_cvt_pk_bf16_f32 v150, v150, v151
    v_and_b32 v151, 0xffff0000, v150
    v_lshlrev_b32 v150, 16, v150
    ds_write_b128 v8, v[144:147] offset:2048
    ds_write_b128 v8, v[148:151] offset:3072
    s_waitcnt lgkmcnt(0)
    s_barrier
    ds_read_b128 v[136:139], v8
    ds_read_b128 v[140:143], v8 offset:1024
    s_waitcnt vmcnt(7)
    v_mfma_f32_16x16x32_bf16 v[152:155], v[16:19], v[40:43], v[152:155]
    v_mfma_f32_16x16x32_bf16 v[156:159], v[20:23], v[40:43], v[156:159]
    buffer_load_dwordx4 v[40:43], v14, s[32:35], s54 offen offset:0
    s_waitcnt vmcnt(7)
    v_mfma_f32_16x16x32_bf16 v[152:155], v[16:19], v[44:47], v[152:155]
    v_mfma_f32_16x16x32_bf16 v[156:159], v[20:23], v[44:47], v[156:159]
    buffer_load_dwordx4 v[44:47], v14, s[32:35], s54 offen offset:1024
    s_waitcnt vmcnt(7)
    v_mfma_f32_16x16x32_bf16 v[152:155], v[16:19], v[48:51], v[152:155]
    v_mfma_f32_16x16x32_bf16 v[156:159], v[20:23], v[48:51], v[156:159]
    buffer_load_dwordx4 v[48:51], v14, s[32:35], s54 offen offset:2048
    s_waitcnt vmcnt(7)
    v_mfma_f32_16x16x32_bf16 v[152:155], v[16:19], v[52:55], v[152:155]
    v_mfma_f32_16x16x32_bf16 v[156:159], v[20:23], v[52:55], v[156:159]
    buffer_load_dwordx4 v[52:55], v14, s[32:35], s54 offen offset:3072
    s_add_u32 s54, s54, 4096
    s_waitcnt vmcnt(7)
    v_mfma_f32_16x16x32_bf16 v[152:155], v[16:19], v[24:27], v[152:155]
    v_mfma_f32_16x16x32_bf16 v[156:159], v[20:23], v[24:27], v[156:159]
    s_waitcnt vmcnt(6)
    v_mfma_f32_16x16x32_bf16 v[152:155], v[16:19], v[28:31], v[152:155]
    v_mfma_f32_16x16x32_bf16 v[156:159], v[20:23], v[28:31], v[156:159]
    s_waitcnt vmcnt(5)
    v_mfma_f32_16x16x32_bf16 v[152:155], v[16:19], v[32:35], v[152:155]
    v_mfma_f32_16x16x32_bf16 v[156:159], v[20:23], v[32:35], v[156:159]
    s_waitcnt vmcnt(4)
    v_mfma_f32_16x16x32_bf16 v[152:155], v[16:19], v[36:39], v[152:155]
    v_mfma_f32_16x16x32_bf16 v[156:159], v[20:23], v[36:39], v[156:159]
    s_waitcnt vmcnt(3)
    v_mfma_f32_16x16x32_bf16 v[152:155], v[16:19], v[40:43], v[152:155]
    v_mfma_f32_16x16x32_bf16 v[156:159], v[20:23], v[40:43], v[156:159]
    s_waitcnt vmcnt(2)
    v_mfma_f32_16x16x32_bf16 v[152:155], v[16:19], v[44:47], v[152:155]
    v_mfma_f32_16x16x32_bf16 v[156:159], v[20:23], v[44:47], v[156:159]
    s_waitcnt vmcnt(1)
    v_mfma_f32_16x16x32_bf16 v[152:155], v[16:19], v[48:51], v[152:155]
    v_mfma_f32_16x16x32_bf16 v[156:159], v[20:23], v[48:51], v[156:159]
    s_waitcnt vmcnt(0)
    v_mfma_f32_16x16x32_bf16 v[152:155], v[16:19], v[52:55], v[152:155]
    v_mfma_f32_16x16x32_bf16 v[156:159], v[20:23], v[52:55], v[156:159]
    s_waitcnt vmcnt(0) lgkmcnt(0)
    s_nop 7
    v_cvt_pk_bf16_f32 v152, v152, v153
    v_and_b32 v153, 0xffff0000, v152
    v_lshlrev_b32 v152, 16, v152
    v_cvt_pk_bf16_f32 v154, v154, v155
    v_and_b32 v155, 0xffff0000, v154
    v_lshlrev_b32 v154, 16, v154
    v_cvt_pk_bf16_f32 v156, v156, v157
    v_and_b32 v157, 0xffff0000, v156
    v_lshlrev_b32 v156, 16, v156
    v_cvt_pk_bf16_f32 v158, v158, v159
    v_and_b32 v159, 0xffff0000, v158
    v_lshlrev_b32 v158, 16, v158
    v_mul_f32 v120, s56, v152
    v_mul_f32 v121, s56, v153
    v_mul_f32 v122, s56, v154
    v_mul_f32 v123, s56, v155
    v_mul_f32 v124, s56, v156
    v_mul_f32 v125, s56, v157
    v_mul_f32 v126, s56, v158
    v_mul_f32 v127, s56, v159
    v_exp_f32 v120, v120
    v_exp_f32 v121, v121
    v_exp_f32 v122, v122
    v_exp_f32 v123, v123
    v_exp_f32 v124, v124
    v_exp_f32 v125, v125
    v_exp_f32 v126, v126
    v_exp_f32 v127, v127
    v_add_f32 v120, 1.0, v120
    v_add_f32 v121, 1.0, v121
    v_add_f32 v122, 1.0, v122
    v_add_f32 v123, 1.0, v123
    v_add_f32 v124, 1.0, v124
    v_add_f32 v125, 1.0, v125
    v_add_f32 v126, 1.0, v126
    v_add_f32 v127, 1.0, v127
    v_rcp_f32 v120, v120
    v_rcp_f32 v121, v121
    v_rcp_f32 v122, v122
    v_rcp_f32 v123, v123
    v_rcp_f32 v124, v124
    v_rcp_f32 v125, v125
    v_rcp_f32 v126, v126
    v_rcp_f32 v127, v127
    s_nop 0
    v_mul_f32 v152, v152, v120
    v_mul_f32 v153, v153, v121
    v_mul_f32 v154, v154, v122
    v_mul_f32 v155, v155, v123
    v_mul_f32 v156, v156, v124
    v_mul_f32 v157, v157, v125
    v_mul_f32 v158, v158, v126
    v_mul_f32 v159, v159, v127
    v_cvt_pk_bf16_f32 v152, v152, v153
    v_and_b32 v153, 0xffff0000, v152
    v_lshlrev_b32 v152, 16, v152
    v_cvt_pk_bf16_f32 v154, v154, v155
    v_and_b32 v155, 0xffff0000, v154
    v_lshlrev_b32 v154, 16, v154
    v_cvt_pk_bf16_f32 v156, v156, v157
    v_and_b32 v157, 0xffff0000, v156
    v_lshlrev_b32 v156, 16, v156
    v_cvt_pk_bf16_f32 v158, v158, v159
    v_and_b32 v159, 0xffff0000, v158
    v_lshlrev_b32 v158, 16, v158
K2_FIN:
    v_cvt_pk_bf16_f32 v136, v136, v137
    v_and_b32 v137, 0xffff0000, v136
    v_lshlrev_b32 v136, 16, v136
    v_cvt_pk_bf16_f32 v138, v138, v139
    v_and_b32 v139, 0xffff0000, v138
    v_lshlrev_b32 v138, 16, v138
    v_cvt_pk_bf16_f32 v140, v140, v141
    v_and_b32 v141, 0xffff0000, v140
    v_lshlrev_b32 v140, 16, v140
    v_cvt_pk_bf16_f32 v142, v142, v143
    v_and_b32 v143, 0xffff0000, v142
    v_lshlrev_b32 v142, 16, v142
    v_lshlrev_b32 v24, 16, v160
    v_and_b32 v25, 0xffff0000, v160
    v_lshlrev_b32 v26, 16, v161
    v_and_b32 v27, 0xffff0000, v161
    v_lshlrev_b32 v28, 16, v162
    v_and_b32 v29, 0xffff0000, v162
    v_lshlrev_b32 v30, 16, v163
    v_and_b32 v31, 0xffff0000, v163
    v_mul_f32 v152, v152, v136
    v_mul_f32 v153, v153, v137
    v_mul_f32 v154, v154, v138
    v_mul_f32 v155, v155, v139
    v_mul_f32 v156, v156, v140
    v_mul_f32 v157, v157, v141
    v_mul_f32 v158, v158, v142
    v_mul_f32 v159, v159, v143
    v_cvt_pk_bf16_f32 v152, v152, v153
    v_and_b32 v153, 0xffff0000, v152
    v_lshlrev_b32 v152, 16, v152
    v_cvt_pk_bf16_f32 v154, v154, v155
    v_and_b32 v155, 0xffff0000, v154
    v_lshlrev_b32 v154, 16, v154
    v_cvt_pk_bf16_f32 v156, v156, v157
    v_and_b32 v157, 0xffff0000, v156
    v_lshlrev_b32 v156, 16, v156
    v_cvt_pk_bf16_f32 v158, v158, v159
    v_and_b32 v159, 0xffff0000, v158
    v_lshlrev_b32 v158, 16, v158
    v_add_f32 v152, v152, v24
    v_add_f32 v153, v153, v25
    v_add_f32 v154, v154, v26
    v_add_f32 v155, v155, v27
    v_add_f32 v156, v156, v28
    v_add_f32 v157, v157, v29
    v_add_f32 v158, v158, v30
    v_add_f32 v159, v159, v31
    v_cvt_pk_bf16_f32 v152, v152, v153
    v_cvt_pk_bf16_f32 v153, v154, v155
    v_cvt_pk_bf16_f32 v154, v156, v157
    v_cvt_pk_bf16_f32 v155, v158, v159
    buffer_store_dwordx2 v[152:153], v12, s[60:63], 0 offen
    buffer_store_dwordx2 v[154:155], v12, s[60:63], s58 offen
K2_END:
    s_endpgm
ALL_CODE_END:
.section .rodata,"a"
.p2align 6
.amdhsa_kernel k2_kernel
  .amdhsa_next_free_vgpr 168
  .amdhsa_next_free_sgpr 102
  .amdhsa_accum_offset 168
  .amdhsa_group_segment_fixed_size 0
  .amdhsa_kernarg_size 80
  .amdhsa_user_sgpr_count 2
  .amdhsa_user_sgpr_kernarg_segment_ptr 1
  .amdhsa_system_sgpr_workgroup_id_x 1
  .amdhsa_float_denorm_mode_32 3
.end_amdhsa_kernel
.text
```
